```python
import torch

def _softmax(x, axis=-1):
    return torch.softmax(x, dim=axis)
def _gelu(x):
    return torch.nn.functional.gelu(x, approximate="tanh")
def _silu(x):
    return torch.nn.functional.silu(x)
def _sigmoid(x):
    return torch.sigmoid(x)
def _layernorm(x, axis=-1, eps=1e-5):
    m = x.mean(dim=axis, keepdim=True)
    v = x.var(dim=axis, keepdim=True, unbiased=False)
    return (x - m) / torch.sqrt(v + eps)
def _scatter_add(tgt, idx, src, axis=0):
    return tgt.clone().index_add_(axis, idx, src)
def _segment_sum(src, seg, n):
    out = torch.zeros((n,) + src.shape[1:], dtype=src.dtype)
    return out.index_add_(0, seg, src)
def _pad(x, pw):
    flat = tuple(v for pair in reversed(pw) for v in pair)
    return torch.nn.functional.pad(x, flat)

kernel_name = 'recurrent_scan__sliding_local_dilated__mixer_channel_mlp__prompt'

def setup_inputs():

    _w = (lambda a: (lambda t: t.to(torch.bfloat16) if t.is_floating_point() else t)(torch.as_tensor(a)))
    def _A_setup():
        B, S, D = 1, 2048, 448
        return {
            "x": _w((lambda *s: torch.randn(*s, dtype=torch.bfloat16) * 0.05)(B, S, D)),
            "wqkv": _w((lambda *s: torch.randn(*s, dtype=torch.bfloat16) * 0.05)(D, 3 * D)),
            "wo": _w((lambda *s: torch.randn(*s, dtype=torch.bfloat16) * 0.05)(D, D)),
        }
    _A_in = _A_setup()

    def _B_setup():
        B, S, D, F = 1, 2048, 448, 1792
        return {
            "x": _w((lambda *s: torch.randn(*s, dtype=torch.bfloat16) * 0.05)(B, S, D)),
            "w1": _w((lambda *s: torch.randn(*s, dtype=torch.bfloat16) * 0.8)(D, F) * (D ** -0.5)),
            "b1": _w((lambda *s: torch.randn(*s, dtype=torch.bfloat16) * 0.4)(F)),
            "w2": _w((lambda *s: torch.randn(*s, dtype=torch.bfloat16) * 0.05)(F, D) * (F ** -0.5)),
            "b2": _w((lambda *s: torch.randn(*s, dtype=torch.bfloat16) * 0.05)(D)),
        }
    _B_in = _B_setup()

    return {
        "A_x": _A_in["x"],
        "A_wqkv": _A_in["wqkv"],
        "A_wo": _A_in["wo"],
        "B_x": _B_in["x"],
        "B_w1": _B_in["w1"],
        "B_b1": _B_in["b1"],
        "B_w2": _B_in["w2"],
        "B_b2": _B_in["b2"],
    }

def reference(A_x, A_wqkv, A_wo, B_x, B_w1, B_b1, B_w2, B_b2):
    def _A_ref(x, wqkv, wo):
        B, S, D = x.shape
        H = 16; Dh = D // H
        W, dil = 8, 2
        qkv = (lambda x, *d: x.permute(*d))((x @ wqkv).reshape(B, S, 3, H, Dh), 2, 0, 3, 1, 4)
        q, k, v = qkv[0], qkv[1], qkv[2]
        scale = Dh ** -0.5
        pos = torch.arange(S)
        off = torch.arange(W) * dil
        idx = pos[:, None] - off[None, :]
        mask = idx >= 0
        idx_c = torch.where(mask, idx, 0).reshape(-1)
        kg = k[:, :, idx_c, :].reshape(B, H, S, W, Dh)
        vg = v[:, :, idx_c, :].reshape(B, H, S, W, Dh)
        logits = torch.einsum("bhsd,bhswd->bhsw", q, kg) * scale
        logits = torch.where(mask[None, None, :, :], logits, -1e9)
        attn = _softmax(logits, axis=-1)
        o = torch.einsum("bhsw,bhswd->bhsd", attn, vg)
        return (lambda x, *d: x.permute(*d))(o, 0, 2, 1, 3).reshape(B, S, D) @ wo

    def _B_ref(x, w1, b1, w2, b2):
        y = _layernorm(x, axis=-1)
        h = _gelu(torch.einsum("bsd,df->bsf", y, w1) + b1)
        return torch.einsum("bsf,fd->bsd", h, w2) + b2

    x = A_x
    xn = _layernorm(x, axis=-1)
    s = _A_ref(xn, A_wqkv, A_wo)
    g = _silu(_B_ref(xn, B_w1, B_b1, B_w2, B_b2))
    return x + s * g
```

```asm
; @launch grid=(256,1,1) block=(512,1,1) lds=163840
.amdgcn_target "amdgcn-amd-amdhsa--gfx950"
.text
.globl recurrent_scan__sliding_local_dilated__mixer_channel_mlp__prompt_kernel
.p2align 8
.type recurrent_scan__sliding_local_dilated__mixer_channel_mlp__prompt_kernel,@function
recurrent_scan__sliding_local_dilated__mixer_channel_mlp__prompt_kernel:
    s_cmp_ge_u32 s2, 256
    s_cbranch_scc1 L_END
    s_load_dwordx16 s[4:19], s[0:1], 0
    s_load_dwordx4 s[20:23], s[0:1], 64
    s_load_dwordx2 s[24:25], s[0:1], 80
    v_and_b32 v1, 63, v0
    v_lshrrev_b32 v12, 6, v0
    v_lshlrev_b32 v2, 4, v1
    v_readfirstlane_b32 s60, v12
    s_and_b32 s70, s2, 7
    s_lshr_b32 s69, s2, 3
    s_and_b32 s61, s70, 1
    s_lshl_b32 s61, s61, 3
    s_and_b32 s72, s69, 7
    s_add_u32 s61, s61, s72
    s_and_b32 s62, s70, 6
    s_lshr_b32 s72, s69, 4
    s_add_u32 s62, s62, s72
    s_bfe_u32 s63, s69, 0x10003
    s_lshl_b32 s64, s70, 2
    s_and_b32 s73, s69, 3
    s_add_u32 s64, s64, s73
    s_lshr_b32 s72, s69, 2
    s_lshl_b32 s65, s72, 7
    s_mov_b32 s67, 0x3f803f80
    s_and_b32 s66, s60, 3
    s_lshl_b32 s66, s66, 10
    v_lshrrev_b32 v3, 3, v0
    s_lshl_b32 s70, s60, 3
    v_add_u32 v3, s70, v3
    v_mul_u32_u24 v3, 896, v3
    v_and_b32 v12, 7, v0
    v_lshl_add_u32 v3, v12, 4, v3
    s_mul_i32 s70, s61, 114688
    s_add_u32 s71, s70, 7168
    s_lshl_b32 s72, s61, 7
    s_lshl_b32 s73, s60, 1
    s_add_u32 s72, s72, s73
    s_sub_u32 s72, s72, 16
    s_mul_i32 s72, s72, 896
    v_lshrrev_b32 v12, 5, v1
    v_mul_u32_u24 v12, 896, v12
    v_and_b32 v13, 31, v1
    v_lshl_add_u32 v5, v13, 4, v12
    v_add_u32 v5, s72, v5
    v_mov_b32 v14, 0x80000000
    v_cmp_gt_u32 vcc, 28, v13
    s_nop 1
    v_cndmask_b32 v5, v14, v5, vcc
    s_cmp_eq_u32 s63, 0
    s_waitcnt lgkmcnt(0)
    s_mov_b32 s28, s4
    s_mov_b32 s29, s5
    s_mov_b32 s30, 1835008
    s_mov_b32 s31, 0x20000
    s_cbranch_scc1 L_nohalo
    buffer_load_dwordx4 v[88:91], v5, s[28:31], 0 offen offset:0
    buffer_load_dwordx4 v[92:95], v5, s[28:31], 0 offen offset:448
L_nohalo:
    buffer_load_dwordx4 v[32:35], v3, s[28:31], s70 offen offset:0
    buffer_load_dwordx4 v[36:39], v3, s[28:31], s70 offen offset:128
    buffer_load_dwordx4 v[40:43], v3, s[28:31], s70 offen offset:256
    buffer_load_dwordx4 v[44:47], v3, s[28:31], s70 offen offset:384
    buffer_load_dwordx4 v[48:51], v3, s[28:31], s70 offen offset:512
    buffer_load_dwordx4 v[52:55], v3, s[28:31], s70 offen offset:640
    buffer_load_dwordx4 v[56:59], v3, s[28:31], s70 offen offset:768
    buffer_load_dwordx4 v[60:63], v3, s[28:31], s71 offen offset:0
    buffer_load_dwordx4 v[64:67], v3, s[28:31], s71 offen offset:128
    buffer_load_dwordx4 v[68:71], v3, s[28:31], s71 offen offset:256
    buffer_load_dwordx4 v[72:75], v3, s[28:31], s71 offen offset:384
    buffer_load_dwordx4 v[76:79], v3, s[28:31], s71 offen offset:512
    buffer_load_dwordx4 v[80:83], v3, s[28:31], s71 offen offset:640
    buffer_load_dwordx4 v[84:87], v3, s[28:31], s71 offen offset:768
    s_mov_b64 s[10:11], s[6:7]
    s_cmp_ge_u32 s60, 4
    s_cbranch_scc1 L_B
    s_cmp_eq_u32 s63, 1
    s_cbranch_scc1 L_QA
    s_branch L_HA
L_B:
    s_cmp_eq_u32 s63, 1
    s_cbranch_scc1 L_QB
    s_branch L_HB
L_HA:
    s_mov_b32 s32, s12
    s_mov_b32 s33, s13
    s_mov_b32 s34, 1605632
    s_mov_b32 s35, 0x20000
    s_mov_b32 s4, s14
    s_mov_b32 s5, s15
    s_mov_b32 s6, 3584
    s_mov_b32 s7, 0x20000
    s_lshr_b32 s70, s62, 1
    s_mul_i32 s70, s70, 896
    s_and_b32 s71, s62, 1
    s_lshl_b32 s76, s71, 9
    s_add_u32 s76, s76, s70
    s_lshl_b32 s77, s71, 6
    s_add_u32 s77, s77, s70
    s_add_u32 s77, s77, 384
    v_bfe_u32 v12, v0, 3, 5
    v_mul_u32_u24 v4, 3584, v12
    v_lshrrev_b32 v13, 2, v1
    v_and_b32 v13, 4, v13
    s_and_b32 s70, s60, 1
    s_lshl_b32 s70, s70, 1
    v_or_b32 v13, s70, v13
    v_and_b32 v12, 7, v1
    v_xor_b32 v12, v12, v13
    v_lshl_add_u32 v4, v12, 4, v4
    v_and_b32 v29, 31, v1
    v_lshlrev_b32 v29, 1, v29
    s_mov_b32 s36, s24
    s_mov_b32 s37, s25
    s_mov_b32 s38, 268435456
    s_mov_b32 s39, 0x20000
    s_mov_b32 s40, s22
    s_mov_b32 s41, s23
    s_mov_b32 s42, 256
    s_mov_b32 s43, 0x20000
    s_mov_b32 s44, s16
    s_mov_b32 s45, s17
    s_mov_b32 s46, 1605632
    s_mov_b32 s47, 0x20000
    s_mov_b32 s48, s8
    s_mov_b32 s49, s9
    s_mov_b32 s50, 401408
    s_mov_b32 s51, 0x20000
    s_mov_b32 s52, s20
    s_mov_b32 s53, s21
    s_mov_b32 s54, 1835008
    s_mov_b32 s55, 0x20000
    s_mov_b64 s[58:59], s[18:19]
    s_lshr_b32 s70, s64, 1
    s_sub_u32 s70, s70, s61
    v_and_b32 v23, 1, v1
    v_mul_lo_u32 v23, v23, s70
    v_add_u32 v23, s61, v23
    v_lshlrev_b32 v23, 2, v23
    v_lshlrev_b32 v255, 7, v1
    v_bfe_u32 v12, v0, 3, 5
    v_mul_u32_u24 v31, 896, v12
    v_lshrrev_b32 v13, 2, v1
    v_and_b32 v13, 4, v13
    v_and_b32 v12, 7, v1
    v_xor_b32 v12, v12, v13
    v_lshl_add_u32 v31, v12, 4, v31
    v_bfe_u32 v12, v0, 2, 6
    v_mul_u32_u24 v5, 3584, v12
    v_and_b32 v12, 3, v1
    v_lshl_add_u32 v5, v12, 4, v5
    v_mov_b32 v27, 0xc0135761
    s_mov_b32 s68, 0xbdd2d3e8
    v_cmp_gt_u32 vcc, 32, v1
    v_mov_b32 v12, 0x3f80
    v_mov_b32 v177, 0
    v_cndmask_b32 v176, 0, v12, vcc
    v_mov_b32 v178, 0
    v_mov_b32 v179, 0
    v_mov_b32 v185, 0
    v_mov_b32 v187, 0
    v_mov_b32 v189, 0
    v_mov_b32 v191, 0
    v_mov_b32 v192, 0
    v_mov_b32 v193, 0
    v_and_b32 v12, 31, v1
    s_and_b32 s70, s60, 3
    s_lshl_b32 s70, s70, 5
    v_add_u32 v13, s70, v12
    v_mul_u32_u24 v13, 896, v13
    v_bfe_u32 v12, v1, 1, 3
    v_lshrrev_b32 v14, 5, v1
    v_xor_b32 v12, v12, v14
    v_xor_b32 v14, 0, v12
    v_lshl_add_u32 v8, v14, 4, v13
    v_xor_b32 v14, 2, v12
    v_lshl_add_u32 v9, v14, 4, v13
    v_xor_b32 v14, 4, v12
    v_lshl_add_u32 v10, v14, 4, v13
    v_xor_b32 v14, 6, v12
    v_lshl_add_u32 v11, v14, 4, v13
    v_lshrrev_b32 v12, 5, v1
    v_bfe_u32 v13, v1, 2, 2
    v_lshl_add_u32 v14, v12, 3, v13
    v_bfe_u32 v15, v1, 4, 1
    v_lshlrev_b32 v15, 1, v15
    v_bfe_u32 v16, v1, 1, 1
    v_or_b32 v15, v15, v16
    v_lshrrev_b32 v16, 1, v13
    v_lshlrev_b32 v16, 2, v16
    v_lshl_or_b32 v16, v12, 1, v16
    v_xor_b32 v16, v15, v16
    v_xor_b32 v16, 4, v16
    v_lshlrev_b32 v16, 4, v16
    v_and_b32 v17, 1, v1
    v_lshl_or_b32 v16, v17, 3, v16
    v_lshl_add_u32 v24, v14, 7, v16
    v_add_u32 v25, 49152, v24
    v_add_u32 v24, 106496, v24
    v_lshlrev_b32 v15, 4, v15
    v_lshl_or_b32 v15, v17, 3, v15
    v_lshl_add_u32 v26, v14, 6, v15
    s_and_b32 s70, s60, 3
    s_lshl_b32 s71, s61, 2
    s_add_u32 s71, s71, s70
    s_mul_i32 s71, s71, 148480
    s_add_u32 s71, s71, 1048576
    s_lshl_b32 s79, s76, 5
    s_add_u32 s79, s79, s71
    s_lshl_b32 s80, s77, 5
    s_add_u32 s80, s80, s71
    v_add_u32 v18, s66, v2
    v_add_u32 v19, 0x10000, v18
    v_lshrrev_b32 v12, 3, v1
    s_lshl_b32 s70, s60, 4
    v_add_u32 v12, s70, v12
    v_mul_u32_u24 v12, 896, v12
    v_lshrrev_b32 v13, 4, v1
    v_and_b32 v14, 7, v1
    v_xor_b32 v13, v13, v14
    v_lshl_add_u32 v6, v13, 4, v12
    v_xor_b32 v13, 4, v13
    v_lshl_add_u32 v7, v13, 4, v12
    v_add_u32 v7, 7168, v7
    v_mov_b32 v104, 0
    v_mov_b32 v105, 0
    s_waitcnt vmcnt(13)
    v_dot2c_f32_bf16 v104, s67, v32
    v_dot2c_f32_bf16 v105, v32, v32
    v_dot2c_f32_bf16 v104, s67, v33
    v_dot2c_f32_bf16 v105, v33, v33
    v_dot2c_f32_bf16 v104, s67, v34
    v_dot2c_f32_bf16 v105, v34, v34
    v_dot2c_f32_bf16 v104, s67, v35
    v_dot2c_f32_bf16 v105, v35, v35
    s_waitcnt vmcnt(12)
    v_dot2c_f32_bf16 v104, s67, v36
    v_dot2c_f32_bf16 v105, v36, v36
    v_dot2c_f32_bf16 v104, s67, v37
    v_dot2c_f32_bf16 v105, v37, v37
    v_dot2c_f32_bf16 v104, s67, v38
    v_dot2c_f32_bf16 v105, v38, v38
    v_dot2c_f32_bf16 v104, s67, v39
    v_dot2c_f32_bf16 v105, v39, v39
    s_waitcnt vmcnt(11)
    v_dot2c_f32_bf16 v104, s67, v40
    v_dot2c_f32_bf16 v105, v40, v40
    v_dot2c_f32_bf16 v104, s67, v41
    v_dot2c_f32_bf16 v105, v41, v41
    v_dot2c_f32_bf16 v104, s67, v42
    v_dot2c_f32_bf16 v105, v42, v42
    v_dot2c_f32_bf16 v104, s67, v43
    v_dot2c_f32_bf16 v105, v43, v43
    s_waitcnt vmcnt(10)
    v_dot2c_f32_bf16 v104, s67, v44
    v_dot2c_f32_bf16 v105, v44, v44
    v_dot2c_f32_bf16 v104, s67, v45
    v_dot2c_f32_bf16 v105, v45, v45
    v_dot2c_f32_bf16 v104, s67, v46
    v_dot2c_f32_bf16 v105, v46, v46
    v_dot2c_f32_bf16 v104, s67, v47
    v_dot2c_f32_bf16 v105, v47, v47
    s_waitcnt vmcnt(9)
    v_dot2c_f32_bf16 v104, s67, v48
    v_dot2c_f32_bf16 v105, v48, v48
    v_dot2c_f32_bf16 v104, s67, v49
    v_dot2c_f32_bf16 v105, v49, v49
    v_dot2c_f32_bf16 v104, s67, v50
    v_dot2c_f32_bf16 v105, v50, v50
    v_dot2c_f32_bf16 v104, s67, v51
    v_dot2c_f32_bf16 v105, v51, v51
    s_waitcnt vmcnt(8)
    v_dot2c_f32_bf16 v104, s67, v52
    v_dot2c_f32_bf16 v105, v52, v52
    v_dot2c_f32_bf16 v104, s67, v53
    v_dot2c_f32_bf16 v105, v53, v53
    v_dot2c_f32_bf16 v104, s67, v54
    v_dot2c_f32_bf16 v105, v54, v54
    v_dot2c_f32_bf16 v104, s67, v55
    v_dot2c_f32_bf16 v105, v55, v55
    s_waitcnt vmcnt(7)
    v_dot2c_f32_bf16 v104, s67, v56
    v_dot2c_f32_bf16 v105, v56, v56
    v_dot2c_f32_bf16 v104, s67, v57
    v_dot2c_f32_bf16 v105, v57, v57
    v_dot2c_f32_bf16 v104, s67, v58
    v_dot2c_f32_bf16 v105, v58, v58
    v_dot2c_f32_bf16 v104, s67, v59
    v_dot2c_f32_bf16 v105, v59, v59
    v_mov_b32 v112, 0
    v_mov_b32 v113, 0
    v_add_f32_dpp v104, v104, v104 quad_perm:[1,0,3,2] row_mask:0xf bank_mask:0xf
    s_waitcnt vmcnt(6)
    v_dot2c_f32_bf16 v112, s67, v60
    v_add_f32_dpp v105, v105, v105 quad_perm:[1,0,3,2] row_mask:0xf bank_mask:0xf
    v_dot2c_f32_bf16 v113, v60, v60
    v_dot2c_f32_bf16 v112, s67, v61
    v_add_f32_dpp v104, v104, v104 quad_perm:[2,3,0,1] row_mask:0xf bank_mask:0xf
    v_dot2c_f32_bf16 v113, v61, v61
    v_dot2c_f32_bf16 v112, s67, v62
    v_add_f32_dpp v105, v105, v105 quad_perm:[2,3,0,1] row_mask:0xf bank_mask:0xf
    v_dot2c_f32_bf16 v113, v62, v62
    v_dot2c_f32_bf16 v112, s67, v63
    v_add_f32_dpp v104, v104, v104 row_half_mirror row_mask:0xf bank_mask:0xf
    v_dot2c_f32_bf16 v113, v63, v63
    s_waitcnt vmcnt(5)
    v_add_f32_dpp v105, v105, v105 row_half_mirror row_mask:0xf bank_mask:0xf
    v_dot2c_f32_bf16 v112, s67, v64
    v_dot2c_f32_bf16 v113, v64, v64
    v_mul_f32 v104, 0x3b124925, v104
    v_dot2c_f32_bf16 v112, s67, v65
    v_dot2c_f32_bf16 v113, v65, v65
    v_mul_f32 v105, 0x3b124925, v105
    v_dot2c_f32_bf16 v112, s67, v66
    v_dot2c_f32_bf16 v113, v66, v66
    v_fma_f32 v105, -v104, v104, v105
    v_dot2c_f32_bf16 v112, s67, v67
    v_dot2c_f32_bf16 v113, v67, v67
    v_max_f32 v105, 0, v105
    s_waitcnt vmcnt(4)
    v_dot2c_f32_bf16 v112, s67, v68
    v_add_f32 v106, 0x3727c5ac, v105
    v_dot2c_f32_bf16 v113, v68, v68
    v_dot2c_f32_bf16 v112, s67, v69
    v_rsq_f32 v106, v106
    v_dot2c_f32_bf16 v113, v69, v69
    v_dot2c_f32_bf16 v112, s67, v70
    v_mul_f32 v105, v105, v106
    v_dot2c_f32_bf16 v113, v70, v70
    v_dot2c_f32_bf16 v112, s67, v71
    v_mul_f32 v105, v105, v106
    v_dot2c_f32_bf16 v113, v71, v71
    s_waitcnt vmcnt(3)
    v_add_f32 v105, 0x3727c5ac, v105
    v_dot2c_f32_bf16 v112, s67, v72
    v_dot2c_f32_bf16 v113, v72, v72
    v_rsq_f32 v105, v105
    v_dot2c_f32_bf16 v112, s67, v73
    v_dot2c_f32_bf16 v113, v73, v73
    v_mul_f32 v106, v106, v105
    v_dot2c_f32_bf16 v112, s67, v74
    v_dot2c_f32_bf16 v113, v74, v74
    v_cvt_pk_bf16_f32 v106, v106, 0
    v_dot2c_f32_bf16 v112, s67, v75
    v_dot2c_f32_bf16 v113, v75, v75
    v_lshlrev_b32 v105, 16, v106
    s_waitcnt vmcnt(2)
    v_dot2c_f32_bf16 v112, s67, v76
    v_mul_f32 v107, v104, v105
    v_dot2c_f32_bf16 v113, v76, v76
    v_dot2c_f32_bf16 v112, s67, v77
    v_mov_b32 v104, v106
    v_dot2c_f32_bf16 v113, v77, v77
    v_dot2c_f32_bf16 v112, s67, v78
    v_sub_f32 v106, 0, v107
    v_dot2c_f32_bf16 v113, v78, v78
    v_dot2c_f32_bf16 v112, s67, v79
    v_dot2c_f32_bf16 v113, v79, v79
    s_waitcnt vmcnt(1)
    v_dot2c_f32_bf16 v112, s67, v80
    v_dot2c_f32_bf16 v113, v80, v80
    v_dot2c_f32_bf16 v112, s67, v81
    v_dot2c_f32_bf16 v113, v81, v81
    v_dot2c_f32_bf16 v112, s67, v82
    v_dot2c_f32_bf16 v113, v82, v82
    v_dot2c_f32_bf16 v112, s67, v83
    v_dot2c_f32_bf16 v113, v83, v83
    s_waitcnt vmcnt(0)
    v_dot2c_f32_bf16 v112, s67, v84
    v_dot2c_f32_bf16 v113, v84, v84
    v_dot2c_f32_bf16 v112, s67, v85
    v_dot2c_f32_bf16 v113, v85, v85
    v_dot2c_f32_bf16 v112, s67, v86
    v_dot2c_f32_bf16 v113, v86, v86
    v_dot2c_f32_bf16 v112, s67, v87
    v_dot2c_f32_bf16 v113, v87, v87
    v_dot2_f32_bf16 v120, v32, v104, v106
    v_dot2_f32_bf16 v121, v32, v105, v106
    v_dot2_f32_bf16 v122, v33, v104, v106
    v_add_f32_dpp v112, v112, v112 quad_perm:[1,0,3,2] row_mask:0xf bank_mask:0xf
    v_dot2_f32_bf16 v123, v33, v105, v106
    v_dot2_f32_bf16 v124, v34, v104, v106
    v_dot2_f32_bf16 v125, v34, v105, v106
    v_add_f32_dpp v113, v113, v113 quad_perm:[1,0,3,2] row_mask:0xf bank_mask:0xf
    v_dot2_f32_bf16 v126, v35, v104, v106
    v_dot2_f32_bf16 v127, v35, v105, v106
    v_cvt_pk_bf16_f32 v32, v120, v121
    v_add_f32_dpp v112, v112, v112 quad_perm:[2,3,0,1] row_mask:0xf bank_mask:0xf
    v_cvt_pk_bf16_f32 v33, v122, v123
    v_cvt_pk_bf16_f32 v34, v124, v125
    v_cvt_pk_bf16_f32 v35, v126, v127
    v_add_f32_dpp v113, v113, v113 quad_perm:[2,3,0,1] row_mask:0xf bank_mask:0xf
    ds_write_b128 v6, v[32:35] offset:0
    v_dot2_f32_bf16 v96, v36, v104, v106
    v_dot2_f32_bf16 v97, v36, v105, v106
    v_add_f32_dpp v112, v112, v112 row_half_mirror row_mask:0xf bank_mask:0xf
    v_dot2_f32_bf16 v98, v37, v104, v106
    v_dot2_f32_bf16 v99, v37, v105, v106
    v_dot2_f32_bf16 v100, v38, v104, v106
    v_add_f32_dpp v113, v113, v113 row_half_mirror row_mask:0xf bank_mask:0xf
    v_dot2_f32_bf16 v101, v38, v105, v106
    v_dot2_f32_bf16 v102, v39, v104, v106
    v_dot2_f32_bf16 v103, v39, v105, v106
    v_mul_f32 v112, 0x3b124925, v112
    v_cvt_pk_bf16_f32 v36, v96, v97
    v_cvt_pk_bf16_f32 v37, v98, v99
    v_cvt_pk_bf16_f32 v38, v100, v101
    v_mul_f32 v113, 0x3b124925, v113
    v_cvt_pk_bf16_f32 v39, v102, v103
    ds_write_b128 v6, v[36:39] offset:128
    v_dot2_f32_bf16 v120, v40, v104, v106
    v_fma_f32 v113, -v112, v112, v113
    v_dot2_f32_bf16 v121, v40, v105, v106
    v_dot2_f32_bf16 v122, v41, v104, v106
    v_dot2_f32_bf16 v123, v41, v105, v106
    v_max_f32 v113, 0, v113
    v_dot2_f32_bf16 v124, v42, v104, v106
    v_dot2_f32_bf16 v125, v42, v105, v106
    v_dot2_f32_bf16 v126, v43, v104, v106
    v_add_f32 v114, 0x3727c5ac, v113
    v_dot2_f32_bf16 v127, v43, v105, v106
    v_cvt_pk_bf16_f32 v40, v120, v121
    v_cvt_pk_bf16_f32 v41, v122, v123
    v_rsq_f32 v114, v114
    v_cvt_pk_bf16_f32 v42, v124, v125
    v_cvt_pk_bf16_f32 v43, v126, v127
    ds_write_b128 v6, v[40:43] offset:256
    v_mul_f32 v113, v113, v114
    v_dot2_f32_bf16 v96, v44, v104, v106
    v_dot2_f32_bf16 v97, v44, v105, v106
    v_dot2_f32_bf16 v98, v45, v104, v106
    v_mul_f32 v113, v113, v114
    v_dot2_f32_bf16 v99, v45, v105, v106
    v_dot2_f32_bf16 v100, v46, v104, v106
    v_dot2_f32_bf16 v101, v46, v105, v106
    v_add_f32 v113, 0x3727c5ac, v113
    v_dot2_f32_bf16 v102, v47, v104, v106
    v_dot2_f32_bf16 v103, v47, v105, v106
    v_cvt_pk_bf16_f32 v44, v96, v97
    v_rsq_f32 v113, v113
    v_cvt_pk_bf16_f32 v45, v98, v99
    v_cvt_pk_bf16_f32 v46, v100, v101
    v_cvt_pk_bf16_f32 v47, v102, v103
    v_mul_f32 v114, v114, v113
    ds_write_b128 v6, v[44:47] offset:384
    v_dot2_f32_bf16 v120, v48, v104, v106
    v_dot2_f32_bf16 v121, v48, v105, v106
    v_cvt_pk_bf16_f32 v114, v114, 0
    v_dot2_f32_bf16 v122, v49, v104, v106
    v_dot2_f32_bf16 v123, v49, v105, v106
    v_dot2_f32_bf16 v124, v50, v104, v106
    v_lshlrev_b32 v113, 16, v114
    v_dot2_f32_bf16 v125, v50, v105, v106
    v_dot2_f32_bf16 v126, v51, v104, v106
    v_dot2_f32_bf16 v127, v51, v105, v106
    v_mul_f32 v115, v112, v113
    v_cvt_pk_bf16_f32 v48, v120, v121
    v_cvt_pk_bf16_f32 v49, v122, v123
    v_cvt_pk_bf16_f32 v50, v124, v125
    v_mov_b32 v112, v114
    v_cvt_pk_bf16_f32 v51, v126, v127
    ds_write_b128 v6, v[48:51] offset:512
    v_dot2_f32_bf16 v96, v52, v104, v106
    v_sub_f32 v114, 0, v115
    v_dot2_f32_bf16 v97, v52, v105, v106
    v_dot2_f32_bf16 v98, v53, v104, v106
    v_dot2_f32_bf16 v99, v53, v105, v106
    v_dot2_f32_bf16 v100, v54, v104, v106
    v_dot2_f32_bf16 v101, v54, v105, v106
    v_dot2_f32_bf16 v102, v55, v104, v106
    v_dot2_f32_bf16 v103, v55, v105, v106
    v_cvt_pk_bf16_f32 v52, v96, v97
    v_cvt_pk_bf16_f32 v53, v98, v99
    v_cvt_pk_bf16_f32 v54, v100, v101
    v_cvt_pk_bf16_f32 v55, v102, v103
    ds_write_b128 v6, v[52:55] offset:640
    v_dot2_f32_bf16 v120, v56, v104, v106
    v_dot2_f32_bf16 v121, v56, v105, v106
    v_dot2_f32_bf16 v122, v57, v104, v106
    v_dot2_f32_bf16 v123, v57, v105, v106
    v_dot2_f32_bf16 v124, v58, v104, v106
    v_dot2_f32_bf16 v125, v58, v105, v106
    v_dot2_f32_bf16 v126, v59, v104, v106
    v_dot2_f32_bf16 v127, v59, v105, v106
    v_cvt_pk_bf16_f32 v56, v120, v121
    v_cvt_pk_bf16_f32 v57, v122, v123
    v_cvt_pk_bf16_f32 v58, v124, v125
    v_cvt_pk_bf16_f32 v59, v126, v127
    ds_write_b128 v6, v[56:59] offset:768
    v_dot2_f32_bf16 v120, v60, v112, v114
    v_dot2_f32_bf16 v121, v60, v113, v114
    v_dot2_f32_bf16 v122, v61, v112, v114
    v_dot2_f32_bf16 v123, v61, v113, v114
    v_dot2_f32_bf16 v124, v62, v112, v114
    v_dot2_f32_bf16 v125, v62, v113, v114
    v_dot2_f32_bf16 v126, v63, v112, v114
    v_dot2_f32_bf16 v127, v63, v113, v114
    v_cvt_pk_bf16_f32 v60, v120, v121
    v_cvt_pk_bf16_f32 v61, v122, v123
    v_cvt_pk_bf16_f32 v62, v124, v125
    v_cvt_pk_bf16_f32 v63, v126, v127
    ds_write_b128 v7, v[60:63] offset:0
    v_dot2_f32_bf16 v96, v64, v112, v114
    v_dot2_f32_bf16 v97, v64, v113, v114
    v_dot2_f32_bf16 v98, v65, v112, v114
    v_dot2_f32_bf16 v99, v65, v113, v114
    v_dot2_f32_bf16 v100, v66, v112, v114
    v_dot2_f32_bf16 v101, v66, v113, v114
    v_dot2_f32_bf16 v102, v67, v112, v114
    v_dot2_f32_bf16 v103, v67, v113, v114
    v_cvt_pk_bf16_f32 v64, v96, v97
    v_cvt_pk_bf16_f32 v65, v98, v99
    v_cvt_pk_bf16_f32 v66, v100, v101
    v_cvt_pk_bf16_f32 v67, v102, v103
    ds_write_b128 v7, v[64:67] offset:128
    v_dot2_f32_bf16 v120, v68, v112, v114
    v_dot2_f32_bf16 v121, v68, v113, v114
    v_dot2_f32_bf16 v122, v69, v112, v114
    v_dot2_f32_bf16 v123, v69, v113, v114
    v_dot2_f32_bf16 v124, v70, v112, v114
    v_dot2_f32_bf16 v125, v70, v113, v114
    v_dot2_f32_bf16 v126, v71, v112, v114
    v_dot2_f32_bf16 v127, v71, v113, v114
    v_cvt_pk_bf16_f32 v68, v120, v121
    v_cvt_pk_bf16_f32 v69, v122, v123
    v_cvt_pk_bf16_f32 v70, v124, v125
    v_cvt_pk_bf16_f32 v71, v126, v127
    ds_write_b128 v7, v[68:71] offset:256
    v_dot2_f32_bf16 v96, v72, v112, v114
    v_dot2_f32_bf16 v97, v72, v113, v114
    v_dot2_f32_bf16 v98, v73, v112, v114
    v_dot2_f32_bf16 v99, v73, v113, v114
    v_dot2_f32_bf16 v100, v74, v112, v114
    v_dot2_f32_bf16 v101, v74, v113, v114
    v_dot2_f32_bf16 v102, v75, v112, v114
    v_dot2_f32_bf16 v103, v75, v113, v114
    v_cvt_pk_bf16_f32 v72, v96, v97
    v_cvt_pk_bf16_f32 v73, v98, v99
    v_cvt_pk_bf16_f32 v74, v100, v101
    v_cvt_pk_bf16_f32 v75, v102, v103
    ds_write_b128 v7, v[72:75] offset:384
    v_dot2_f32_bf16 v120, v76, v112, v114
    v_dot2_f32_bf16 v121, v76, v113, v114
    v_dot2_f32_bf16 v122, v77, v112, v114
    v_dot2_f32_bf16 v123, v77, v113, v114
    v_dot2_f32_bf16 v124, v78, v112, v114
    v_dot2_f32_bf16 v125, v78, v113, v114
    v_dot2_f32_bf16 v126, v79, v112, v114
    v_dot2_f32_bf16 v127, v79, v113, v114
    v_cvt_pk_bf16_f32 v76, v120, v121
    v_cvt_pk_bf16_f32 v77, v122, v123
    v_cvt_pk_bf16_f32 v78, v124, v125
    v_cvt_pk_bf16_f32 v79, v126, v127
    ds_write_b128 v7, v[76:79] offset:512
    v_dot2_f32_bf16 v96, v80, v112, v114
    v_dot2_f32_bf16 v97, v80, v113, v114
    v_dot2_f32_bf16 v98, v81, v112, v114
    v_dot2_f32_bf16 v99, v81, v113, v114
    v_dot2_f32_bf16 v100, v82, v112, v114
    v_dot2_f32_bf16 v101, v82, v113, v114
    v_dot2_f32_bf16 v102, v83, v112, v114
    v_dot2_f32_bf16 v103, v83, v113, v114
    v_cvt_pk_bf16_f32 v80, v96, v97
    v_cvt_pk_bf16_f32 v81, v98, v99
    v_cvt_pk_bf16_f32 v82, v100, v101
    v_cvt_pk_bf16_f32 v83, v102, v103
    ds_write_b128 v7, v[80:83] offset:640
    v_dot2_f32_bf16 v120, v84, v112, v114
    v_dot2_f32_bf16 v121, v84, v113, v114
    v_dot2_f32_bf16 v122, v85, v112, v114
    v_dot2_f32_bf16 v123, v85, v113, v114
    v_dot2_f32_bf16 v124, v86, v112, v114
    v_dot2_f32_bf16 v125, v86, v113, v114
    v_dot2_f32_bf16 v126, v87, v112, v114
    v_dot2_f32_bf16 v127, v87, v113, v114
    v_cvt_pk_bf16_f32 v84, v120, v121
    v_cvt_pk_bf16_f32 v85, v122, v123
    v_cvt_pk_bf16_f32 v86, v124, v125
    v_cvt_pk_bf16_f32 v87, v126, v127
    ds_write_b128 v7, v[84:87] offset:768
    s_add_u32 m0, s66, 114688
    s_add_u32 s74, s76, 0
    buffer_load_dwordx4 v4, s[32:35], s74 offen lds
    s_add_u32 m0, s66, 118784
    s_add_u32 s74, s76, 114688
    buffer_load_dwordx4 v4, s[32:35], s74 offen lds
    s_add_u32 m0, s66, 122880
    s_add_u32 s74, s76, 229376
    buffer_load_dwordx4 v4, s[32:35], s74 offen lds
    s_add_u32 m0, s66, 126976
    s_add_u32 s74, s76, 344064
    buffer_load_dwordx4 v4, s[32:35], s74 offen lds
    s_add_u32 m0, s66, 131072
    s_add_u32 s74, s76, 458752
    buffer_load_dwordx4 v4, s[32:35], s74 offen lds
    s_add_u32 m0, s66, 135168
    s_add_u32 s74, s76, 573440
    buffer_load_dwordx4 v4, s[32:35], s74 offen lds
    s_add_u32 m0, s66, 139264
    s_add_u32 s74, s76, 688128
    buffer_load_dwordx4 v4, s[32:35], s74 offen lds
    s_add_u32 m0, s66, 143360
    s_add_u32 s74, s76, 802816
    buffer_load_dwordx4 v4, s[32:35], s74 offen lds
    s_add_u32 m0, s66, 147456
    s_add_u32 s74, s76, 917504
    buffer_load_dwordx4 v4, s[32:35], s74 offen lds
    s_add_u32 m0, s66, 151552
    s_add_u32 s74, s76, 1032192
    buffer_load_dwordx4 v4, s[32:35], s74 offen lds
    s_add_u32 m0, s66, 155648
    s_add_u32 s74, s76, 1146880
    buffer_load_dwordx4 v4, s[32:35], s74 offen lds
    s_add_u32 m0, s66, 159744
    s_add_u32 s74, s76, 1261568
    buffer_load_dwordx4 v4, s[32:35], s74 offen lds
    s_and_b32 s70, s69, 7
    s_mul_i32 s70, s70, 56
    s_mul_i32 s71, s60, 14
    s_add_u32 s70, s70, s71
    s_mul_i32 s70, s70, 3584
    v_lshrrev_b32 v12, 2, v1
    v_min_u32 v12, 13, v12
    v_mul_u32_u24 v12, 3584, v12
    v_and_b32 v13, 3, v1
    s_min_u32 s71, s76, s77
    s_and_b32 s71, s71, 0xffffff80
    s_add_u32 s70, s70, s71
    v_lshl_add_u32 v12, v13, 7, v12
    buffer_load_dword v254, v12, s[32:35], s70 offen
    s_lshl_b32 s78, s62, 3
    s_add_u32 s78, s78, s60
    s_cmp_lg_u32 s78, 3
    s_cbranch_scc1 L_nolead1
    s_lshl_b32 s70, s61, 12
    s_add_u32 s70, s70, 262144
    v_lshlrev_b32 v12, 3, v1
    v_mov_b32 v14, 0
    v_mov_b32 v15, 0
    buffer_store_dwordx2 v[14:15], v12, s[36:39], s70 offen sc1
L_nolead1:
    s_waitcnt vmcnt(9)
    s_waitcnt lgkmcnt(0)
    s_barrier
    ds_read_b128 v[32:35], v8 offset:0
    ds_read_b64_tr_b16 v[208:209], v24 offset:8192
    ds_read_b64_tr_b16 v[210:211], v24 offset:8704
    ds_read_b128 v[36:39], v9 offset:0
    ds_read_b64_tr_b16 v[212:213], v24 offset:10240
    ds_read_b64_tr_b16 v[214:215], v24 offset:10752
    ds_read_b128 v[40:43], v10 offset:0
    ds_read_b64_tr_b16 v[216:217], v24 offset:12288
    ds_read_b64_tr_b16 v[218:219], v24 offset:12800
    ds_read_b128 v[44:47], v11 offset:0
    ds_read_b64_tr_b16 v[220:221], v24 offset:14336
    ds_read_b64_tr_b16 v[222:223], v24 offset:14848
    s_waitcnt lgkmcnt(9)
    v_mfma_f32_32x32x16_bf16 v[144:159], v[208:211], v[32:35], 0
    ds_read_b64_tr_b16 v[224:225], v24 offset:16384
    ds_read_b64_tr_b16 v[226:227], v24 offset:16896
    ds_read_b128 v[48:51], v8 offset:128
    ds_read_b128 v[52:55], v9 offset:128
    ds_read_b128 v[56:59], v10 offset:128
    ds_read_b128 v[60:63], v11 offset:128
    ds_read_b128 v[64:67], v8 offset:256
    s_waitcnt lgkmcnt(13)
    v_mfma_f32_32x32x16_bf16 v[144:159], v[212:215], v[36:39], v[144:159]
    ds_read_b64_tr_b16 v[228:229], v24 offset:18432
    ds_read_b64_tr_b16 v[230:231], v24 offset:18944
    ds_read_b128 v[68:71], v9 offset:256
    ds_read_b128 v[72:75], v10 offset:256
    ds_read_b128 v[76:79], v11 offset:256
    ds_read_b128 v[80:83], v8 offset:384
    ds_read_b128 v[84:87], v9 offset:384
    buffer_load_ushort v184, v29, s[4:7], s76 offen offset:64
    buffer_load_ushort v186, v29, s[4:7], s77 offen offset:0
    buffer_load_ushort v188, v29, s[4:7], s76 offen offset:192
    buffer_load_ushort v190, v29, s[4:7], s76 offen offset:320
    s_waitcnt lgkmcnt(15)
    v_mfma_f32_32x32x16_bf16 v[144:159], v[216:219], v[40:43], v[144:159]
    ds_read_b64_tr_b16 v[208:209], v24 offset:20480
    ds_read_b64_tr_b16 v[210:211], v24 offset:20992
    ds_read_b128 v[88:91], v10 offset:384
    ds_read_b128 v[92:95], v11 offset:384
    ds_read_b128 v[96:99], v8 offset:512
    ds_read_b128 v[100:103], v9 offset:512
    ds_read_b128 v[104:107], v10 offset:512
    s_getpc_b64 s[72:73]
L_pc0:
    s_sub_u32 s72, s72, L_pc0-recurrent_scan__sliding_local_dilated__mixer_channel_mlp__prompt_kernel
    s_subb_u32 s73, s73, 0
    s_lshl_b32 s70, s69, 11
    s_lshr_b32 s71, s66, 1
    s_add_u32 s70, s70, s71
    v_and_b32 v12, 3, v1
    v_lshlrev_b32 v12, 7, v12
    v_add_u32 v12, s70, v12
    s_mov_b32 s70, L_END-recurrent_scan__sliding_local_dilated__mixer_channel_mlp__prompt_kernel
    v_min_u32 v12, s70, v12
    s_mov_b64 exec, 15
    global_load_dword v254, v12, s[72:73]
    s_mov_b64 exec, -1
    s_cmp_eq_u32 s60, 0
    s_cselect_b64 s[72:73], s[12:13], s[72:73]
    s_cselect_b32 s70, 6272, s70
    s_cmp_eq_u32 s60, 1
    s_cselect_b64 s[72:73], s[8:9], s[72:73]
    s_cselect_b32 s70, 1568, s70
    s_cmp_eq_u32 s60, 2
    s_cselect_b64 s[72:73], s[16:17], s[72:73]
    s_cselect_b32 s70, 6272, s70
    s_cmp_eq_u32 s60, 3
    s_cselect_b64 s[72:73], s[10:11], s[72:73]
    s_cselect_b32 s70, 4704, s70
    s_sub_u32 s71, s70, 4
    s_mul_i32 s70, s70, s2
    v_min_u32 v12, s71, v255
    v_add_u32 v12, s70, v12
    global_load_dword v254, v12, s[72:73]
    s_waitcnt lgkmcnt(15)
    v_mfma_f32_32x32x16_bf16 v[144:159], v[220:223], v[44:47], v[144:159]
    ds_read_b64_tr_b16 v[212:213], v24 offset:22528
    ds_read_b64_tr_b16 v[214:215], v24 offset:23040
    ds_read_b128 v[108:111], v11 offset:512
    ds_read_b128 v[112:115], v8 offset:640
    ds_read_b128 v[116:119], v9 offset:640
    ds_read_b128 v[120:123], v10 offset:640
    ds_read_b128 v[124:127], v11 offset:640
    s_waitcnt lgkmcnt(15)
    v_mfma_f32_32x32x16_bf16 v[144:159], v[224:227], v[48:51], v[144:159]
    ds_read_b128 v[128:131], v8 offset:768
    ds_read_b128 v[132:135], v9 offset:768
    ds_read_b128 v[136:139], v10 offset:768
    ds_read_b128 v[140:143], v11 offset:768
    s_waitcnt lgkmcnt(15)
    v_mfma_f32_32x32x16_bf16 v[144:159], v[228:231], v[52:55], v[144:159]
    s_waitcnt lgkmcnt(15)
    v_mfma_f32_32x32x16_bf16 v[144:159], v[208:211], v[56:59], v[144:159]
    s_waitcnt lgkmcnt(0)
    s_waitcnt vmcnt(7)
    s_barrier
    ds_read_b64_tr_b16 v[216:217], v24 offset:24576
    ds_read_b64_tr_b16 v[218:219], v24 offset:25088
    ds_read_b64_tr_b16 v[220:221], v24 offset:26624
    ds_read_b64_tr_b16 v[222:223], v24 offset:27136
    ds_read_b64_tr_b16 v[224:225], v24 offset:28672
    ds_read_b64_tr_b16 v[226:227], v24 offset:29184
    s_add_u32 m0, s66, 106496
    s_add_u32 s74, s76, 1376256
    buffer_load_dwordx4 v4, s[32:35], s74 offen lds
    v_mfma_f32_32x32x16_bf16 v[144:159], v[212:215], v[60:63], v[144:159]
    ds_read_b64_tr_b16 v[228:229], v24 offset:30720
    ds_read_b64_tr_b16 v[230:231], v24 offset:31232
    s_waitcnt lgkmcnt(6)
    v_mfma_f32_32x32x16_bf16 v[144:159], v[216:219], v[64:67], v[144:159]
    ds_read_b64_tr_b16 v[208:209], v24 offset:32768
    ds_read_b64_tr_b16 v[210:211], v24 offset:33280
    s_add_u32 m0, s66, 110592
    s_add_u32 s74, s76, 1490944
    buffer_load_dwordx4 v4, s[32:35], s74 offen lds
    s_waitcnt lgkmcnt(6)
    v_mfma_f32_32x32x16_bf16 v[144:159], v[220:223], v[68:71], v[144:159]
    ds_read_b64_tr_b16 v[212:213], v24 offset:34816
    ds_read_b64_tr_b16 v[214:215], v24 offset:35328
    s_waitcnt lgkmcnt(6)
    v_mfma_f32_32x32x16_bf16 v[144:159], v[224:227], v[72:75], v[144:159]
    ds_read_b64_tr_b16 v[216:217], v24 offset:36864
    ds_read_b64_tr_b16 v[218:219], v24 offset:37376
    s_add_u32 m0, s66, 0
    s_add_u32 s74, s77, 0
    buffer_load_dwordx4 v5, s[32:35], s74 offen lds
    s_waitcnt lgkmcnt(6)
    v_mfma_f32_32x32x16_bf16 v[144:159], v[228:231], v[76:79], v[144:159]
    ds_read_b64_tr_b16 v[220:221], v24 offset:38912
    ds_read_b64_tr_b16 v[222:223], v24 offset:39424
    s_waitcnt lgkmcnt(6)
    v_mfma_f32_32x32x16_bf16 v[144:159], v[208:211], v[80:83], v[144:159]
    ds_read_b64_tr_b16 v[224:225], v24 offset:40960
    ds_read_b64_tr_b16 v[226:227], v24 offset:41472
    s_cmp_lg_u32 s78, 3
    s_cbranch_scc1 L_nolead2
    s_waitcnt vmcnt(9)
    s_lshl_b32 s70, s61, 2
    v_mov_b32 v12, s70
    v_mov_b32 v13, 1
    s_mov_b64 exec, 1
    buffer_store_dword v13, v12, s[40:43], 0 offen offset:64 sc1
    s_mov_b64 exec, -1
L_nolead2:
    s_add_u32 m0, s66, 4096
    s_add_u32 s74, s77, 229376
    buffer_load_dwordx4 v5, s[32:35], s74 offen lds
    s_waitcnt lgkmcnt(6)
    v_mfma_f32_32x32x16_bf16 v[144:159], v[212:215], v[84:87], v[144:159]
    ds_read_b64_tr_b16 v[228:229], v24 offset:43008
    ds_read_b64_tr_b16 v[230:231], v24 offset:43520
    s_waitcnt lgkmcnt(6)
    v_mfma_f32_32x32x16_bf16 v[144:159], v[216:219], v[88:91], v[144:159]
    ds_read_b64_tr_b16 v[208:209], v24 offset:45056
    ds_read_b64_tr_b16 v[210:211], v24 offset:45568
    s_add_u32 m0, s66, 8192
    s_add_u32 s74, s77, 458752
    buffer_load_dwordx4 v5, s[32:35], s74 offen lds
    s_waitcnt lgkmcnt(6)
    v_mfma_f32_32x32x16_bf16 v[144:159], v[220:223], v[92:95], v[144:159]
    ds_read_b64_tr_b16 v[212:213], v24 offset:47104
    ds_read_b64_tr_b16 v[214:215], v24 offset:47616
    s_waitcnt lgkmcnt(6)
    v_mfma_f32_32x32x16_bf16 v[144:159], v[224:227], v[96:99], v[144:159]
    ds_read_b64_tr_b16 v[216:217], v24 offset:49152
    ds_read_b64_tr_b16 v[218:219], v24 offset:49664
    s_add_u32 m0, s66, 12288
    s_add_u32 s74, s77, 688128
    buffer_load_dwordx4 v5, s[32:35], s74 offen lds
    s_waitcnt lgkmcnt(6)
    v_mfma_f32_32x32x16_bf16 v[144:159], v[228:231], v[100:103], v[144:159]
    ds_read_b64_tr_b16 v[220:221], v24 offset:51200
    ds_read_b64_tr_b16 v[222:223], v24 offset:51712
    s_waitcnt lgkmcnt(6)
    v_mfma_f32_32x32x16_bf16 v[144:159], v[208:211], v[104:107], v[144:159]
    ds_read_b64_tr_b16 v[224:225], v24 offset:53248
    ds_read_b64_tr_b16 v[226:227], v24 offset:53760
    s_add_u32 m0, s66, 16384
    s_add_u32 s74, s77, 917504
    buffer_load_dwordx4 v5, s[32:35], s74 offen lds
    s_waitcnt lgkmcnt(6)
    v_mfma_f32_32x32x16_bf16 v[144:159], v[212:215], v[108:111], v[144:159]
    s_waitcnt vmcnt(4)
    s_barrier
    ds_read_b64_tr_b16 v[228:229], v24 offset:55296
    ds_read_b64_tr_b16 v[230:231], v24 offset:55808
    s_waitcnt lgkmcnt(6)
    v_mfma_f32_32x32x16_bf16 v[144:159], v[216:219], v[112:115], v[144:159]
    ds_read_b64_tr_b16 v[208:209], v24 offset:0
    ds_read_b64_tr_b16 v[210:211], v24 offset:512
    s_add_u32 m0, s66, 20480
    s_add_u32 s74, s77, 1146880
    buffer_load_dwordx4 v5, s[32:35], s74 offen lds
    s_waitcnt lgkmcnt(6)
    v_mfma_f32_32x32x16_bf16 v[144:159], v[220:223], v[116:119], v[144:159]
    ds_read_b64_tr_b16 v[212:213], v24 offset:2048
    ds_read_b64_tr_b16 v[214:215], v24 offset:2560
    s_waitcnt lgkmcnt(6)
    v_mfma_f32_32x32x16_bf16 v[144:159], v[224:227], v[120:123], v[144:159]
    ds_read_b64_tr_b16 v[216:217], v24 offset:4096
    ds_read_b64_tr_b16 v[218:219], v24 offset:4608
    s_add_u32 m0, s66, 24576
    s_add_u32 s74, s77, 1376256
    buffer_load_dwordx4 v5, s[32:35], s74 offen lds
    s_waitcnt lgkmcnt(6)
    v_mfma_f32_32x32x16_bf16 v[144:159], v[228:231], v[124:127], v[144:159]
    ds_read_b64_tr_b16 v[220:221], v24 offset:6144
    ds_read_b64_tr_b16 v[222:223], v24 offset:6656
    s_waitcnt lgkmcnt(6)
    v_mfma_f32_32x32x16_bf16 v[144:159], v[208:211], v[128:131], v[144:159]
    ds_read_b64_tr_b16 v[224:225], v26 offset:0
    ds_read_b64_tr_b16 v[226:227], v26 offset:256
    s_waitcnt lgkmcnt(6)
    v_mfma_f32_32x32x16_bf16 v[144:159], v[212:215], v[132:135], v[144:159]
    ds_read_b64_tr_b16 v[228:229], v26 offset:1024
    ds_read_b64_tr_b16 v[230:231], v26 offset:1280
    s_waitcnt lgkmcnt(6)
    v_mfma_f32_32x32x16_bf16 v[144:159], v[216:219], v[136:139], v[144:159]
    v_mfma_f32_32x32x16_bf16 v[144:159], v[184:187], v[176:179], v[144:159]
    ds_read_b64_tr_b16 v[208:209], v26 offset:2048
    ds_read_b64_tr_b16 v[210:211], v26 offset:2304
    s_waitcnt lgkmcnt(6)
    v_mfma_f32_32x32x16_bf16 v[144:159], v[220:223], v[140:143], v[144:159]
    ds_read_b64_tr_b16 v[212:213], v26 offset:3072
    ds_read_b64_tr_b16 v[214:215], v26 offset:3328
    s_waitcnt lgkmcnt(6)
    v_mfma_f32_32x32x16_bf16 v[160:175], v[224:227], v[32:35], 0
    s_waitcnt vmcnt(3)
    s_barrier
    ds_read_b64_tr_b16 v[216:217], v26 offset:4096
    ds_read_b64_tr_b16 v[218:219], v26 offset:4352
    s_add_u32 m0, s66, 114688
    s_add_u32 s74, s76, 256
    buffer_load_dwordx4 v4, s[32:35], s74 offen lds
    s_waitcnt lgkmcnt(6)
    v_mfma_f32_32x32x16_bf16 v[160:175], v[228:231], v[36:39], v[160:175]
    ds_read_b64_tr_b16 v[220:221], v26 offset:5120
    ds_read_b64_tr_b16 v[222:223], v26 offset:5376
    s_add_u32 m0, s66, 118784
    s_add_u32 s74, s76, 114944
    buffer_load_dwordx4 v4, s[32:35], s74 offen lds
    v_mul_f32 v232, v144, v144
    v_fma_f32 v232, v232, s68, v27
    v_mul_f32 v233, v145, v145
    v_mul_f32 v232, v232, v144
    v_fma_f32 v233, v233, s68, v27
    s_waitcnt lgkmcnt(6)
    v_mfma_f32_32x32x16_bf16 v[160:175], v[208:211], v[40:43], v[160:175]
    ds_read_b64_tr_b16 v[224:225], v26 offset:6144
    ds_read_b64_tr_b16 v[226:227], v26 offset:6400
    s_add_u32 m0, s66, 122880
    s_add_u32 s74, s76, 229632
    buffer_load_dwordx4 v4, s[32:35], s74 offen lds
    v_mul_f32 v234, v146, v146
    v_exp_f32 v232, v232
    v_mul_f32 v233, v233, v145
    v_fma_f32 v234, v234, s68, v27
    v_mul_f32 v235, v147, v147
    s_waitcnt lgkmcnt(6)
    v_mfma_f32_32x32x16_bf16 v[160:175], v[212:215], v[44:47], v[160:175]
    ds_read_b64_tr_b16 v[228:229], v26 offset:7168
    ds_read_b64_tr_b16 v[230:231], v26 offset:7424
    s_add_u32 m0, s66, 126976
    s_add_u32 s74, s76, 344320
    buffer_load_dwordx4 v4, s[32:35], s74 offen lds
    v_exp_f32 v233, v233
    v_add_f32 v232, 1.0, v232
    v_mul_f32 v234, v234, v146
    v_fma_f32 v235, v235, s68, v27
    v_mul_f32 v236, v148, v148
    s_waitcnt lgkmcnt(6)
    v_mfma_f32_32x32x16_bf16 v[160:175], v[216:219], v[48:51], v[160:175]
    ds_read_b64_tr_b16 v[208:209], v26 offset:8192
    ds_read_b64_tr_b16 v[210:211], v26 offset:8448
    v_exp_f32 v234, v234
    v_add_f32 v233, 1.0, v233
    v_mul_f32 v235, v235, v147
    v_rcp_f32 v232, v232
    s_waitcnt lgkmcnt(6)
    v_mfma_f32_32x32x16_bf16 v[160:175], v[220:223], v[52:55], v[160:175]
    ds_read_b64_tr_b16 v[212:213], v26 offset:9216
    ds_read_b64_tr_b16 v[214:215], v26 offset:9472
    v_fma_f32 v236, v236, s68, v27
    v_mul_f32 v237, v149, v149
    v_mul_f32 v232, v144, v232
    v_exp_f32 v235, v235
    v_add_f32 v234, 1.0, v234
    s_waitcnt lgkmcnt(6)
    v_mfma_f32_32x32x16_bf16 v[160:175], v[224:227], v[56:59], v[160:175]
    ds_read_b64_tr_b16 v[216:217], v26 offset:10240
    ds_read_b64_tr_b16 v[218:219], v26 offset:10496
    v_mul_f32 v236, v236, v148
    v_rcp_f32 v233, v233
    v_fma_f32 v237, v237, s68, v27
    v_mul_f32 v238, v150, v150
    v_mul_f32 v233, v145, v233
    s_waitcnt lgkmcnt(6)
    v_mfma_f32_32x32x16_bf16 v[160:175], v[228:231], v[60:63], v[160:175]
    ds_read_b64_tr_b16 v[220:221], v26 offset:11264
    ds_read_b64_tr_b16 v[222:223], v26 offset:11520
    v_exp_f32 v236, v236
    v_add_f32 v235, 1.0, v235
    v_mul_f32 v237, v237, v149
    v_rcp_f32 v234, v234
    s_waitcnt lgkmcnt(6)
    v_mfma_f32_32x32x16_bf16 v[160:175], v[208:211], v[64:67], v[160:175]
    ds_read_b64_tr_b16 v[224:225], v26 offset:12288
    ds_read_b64_tr_b16 v[226:227], v26 offset:12544
    v_fma_f32 v238, v238, s68, v27
    v_mul_f32 v239, v151, v151
    v_cvt_pk_bf16_f32 v240, v232, v233
    v_mul_f32 v234, v146, v234
    v_exp_f32 v237, v237
    s_waitcnt lgkmcnt(6)
    v_mfma_f32_32x32x16_bf16 v[160:175], v[212:215], v[68:71], v[160:175]
    ds_read_b64_tr_b16 v[228:229], v26 offset:13312
    ds_read_b64_tr_b16 v[230:231], v26 offset:13568
    v_add_f32 v236, 1.0, v236
    v_mul_f32 v238, v238, v150
    v_rcp_f32 v235, v235
    v_fma_f32 v239, v239, s68, v27
    v_mul_f32 v248, v152, v152
    s_waitcnt lgkmcnt(6)
    v_mfma_f32_32x32x16_bf16 v[160:175], v[216:219], v[72:75], v[160:175]
    s_waitcnt vmcnt(4)
    s_barrier
    ds_read_b64_tr_b16 v[208:209], v26 offset:14336
    ds_read_b64_tr_b16 v[210:211], v26 offset:14592
    v_mul_f32 v235, v147, v235
    v_exp_f32 v238, v238
    v_add_f32 v237, 1.0, v237
    v_mul_f32 v239, v239, v151
    s_waitcnt lgkmcnt(6)
    v_mfma_f32_32x32x16_bf16 v[160:175], v[220:223], v[76:79], v[160:175]
    ds_read_b64_tr_b16 v[212:213], v26 offset:15360
    ds_read_b64_tr_b16 v[214:215], v26 offset:15616
    v_rcp_f32 v236, v236
    v_fma_f32 v248, v248, s68, v27
    v_mul_f32 v249, v153, v153
    v_cvt_pk_bf16_f32 v241, v234, v235
    v_mul_f32 v236, v148, v236
    s_waitcnt lgkmcnt(6)
    v_mfma_f32_32x32x16_bf16 v[160:175], v[224:227], v[80:83], v[160:175]
    ds_read_b64_tr_b16 v[216:217], v26 offset:16384
    ds_read_b64_tr_b16 v[218:219], v26 offset:16640
    v_exp_f32 v239, v239
    v_add_f32 v238, 1.0, v238
    v_mul_f32 v248, v248, v152
    v_rcp_f32 v237, v237
    v_fma_f32 v249, v249, s68, v27
    s_waitcnt lgkmcnt(6)
    v_mfma_f32_32x32x16_bf16 v[160:175], v[228:231], v[84:87], v[160:175]
    ds_read_b64_tr_b16 v[220:221], v26 offset:17408
    ds_read_b64_tr_b16 v[222:223], v26 offset:17664
    v_mul_f32 v232, v154, v154
    v_mul_f32 v237, v149, v237
    v_exp_f32 v248, v248
    v_add_f32 v239, 1.0, v239
    s_waitcnt lgkmcnt(6)
    v_mfma_f32_32x32x16_bf16 v[160:175], v[208:211], v[88:91], v[160:175]
    ds_read_b64_tr_b16 v[224:225], v26 offset:18432
    ds_read_b64_tr_b16 v[226:227], v26 offset:18688
    s_add_u32 m0, s66, 32768
    s_add_u32 s74, s65, 1376256
    buffer_load_dwordx4 v31, s[44:47], s74 offen lds
    v_mul_f32 v249, v249, v153
    v_rcp_f32 v238, v238
    v_fma_f32 v232, v232, s68, v27
    v_mul_f32 v233, v155, v155
    v_cvt_pk_bf16_f32 v242, v236, v237
    s_waitcnt lgkmcnt(6)
    v_mfma_f32_32x32x16_bf16 v[160:175], v[212:215], v[92:95], v[160:175]
    ds_read_b64_tr_b16 v[228:229], v26 offset:19456
    ds_read_b64_tr_b16 v[230:231], v26 offset:19712
    v_mul_f32 v238, v150, v238
    v_exp_f32 v249, v249
    v_add_f32 v248, 1.0, v248
    v_mul_f32 v232, v232, v154
    v_rcp_f32 v239, v239
    s_waitcnt lgkmcnt(6)
    v_mfma_f32_32x32x16_bf16 v[160:175], v[216:219], v[96:99], v[160:175]
    ds_read_b64_tr_b16 v[208:209], v26 offset:20480
    ds_read_b64_tr_b16 v[210:211], v26 offset:20736
    v_fma_f32 v233, v233, s68, v27
    v_mul_f32 v234, v156, v156
    v_mul_f32 v239, v151, v239
    v_exp_f32 v232, v232
    v_add_f32 v249, 1.0, v249
    s_waitcnt lgkmcnt(6)
    v_mfma_f32_32x32x16_bf16 v[160:175], v[220:223], v[100:103], v[160:175]
    ds_read_b64_tr_b16 v[212:213], v26 offset:21504
    ds_read_b64_tr_b16 v[214:215], v26 offset:21760
    s_add_u32 m0, s66, 36864
    s_add_u32 s74, s65, 1404928
    buffer_load_dwordx4 v31, s[44:47], s74 offen lds
    v_mul_f32 v233, v233, v155
    v_rcp_f32 v248, v248
    v_fma_f32 v234, v234, s68, v27
    v_mul_f32 v235, v157, v157
    s_waitcnt lgkmcnt(6)
    v_mfma_f32_32x32x16_bf16 v[160:175], v[224:227], v[104:107], v[160:175]
    ds_read_b64_tr_b16 v[216:217], v26 offset:22528
    ds_read_b64_tr_b16 v[218:219], v26 offset:22784
    v_cvt_pk_bf16_f32 v243, v238, v239
    s_add_u32 s75, s79, 2048
    buffer_store_dwordx4 v[240:243], v2, s[36:39], s75 offen sc1
    v_mul_f32 v248, v152, v248
    v_exp_f32 v233, v233
    v_add_f32 v232, 1.0, v232
    s_waitcnt lgkmcnt(6)
    v_mfma_f32_32x32x16_bf16 v[160:175], v[228:231], v[108:111], v[160:175]
    ds_read_b64_tr_b16 v[220:221], v26 offset:23552
    ds_read_b64_tr_b16 v[222:223], v26 offset:23808
    v_mul_f32 v234, v234, v156
    v_rcp_f32 v249, v249
    v_fma_f32 v235, v235, s68, v27
    v_mul_f32 v236, v158, v158
    v_mul_f32 v249, v153, v249
    s_waitcnt lgkmcnt(6)
    v_mfma_f32_32x32x16_bf16 v[160:175], v[208:211], v[112:115], v[160:175]
    ds_read_b64_tr_b16 v[224:225], v26 offset:24576
    ds_read_b64_tr_b16 v[226:227], v26 offset:24832
    v_exp_f32 v234, v234
    v_add_f32 v233, 1.0, v233
    v_mul_f32 v235, v235, v157
    v_rcp_f32 v232, v232
    s_waitcnt lgkmcnt(6)
    v_mfma_f32_32x32x16_bf16 v[160:175], v[212:215], v[116:119], v[160:175]
    ds_read_b64_tr_b16 v[228:229], v26 offset:25600
    ds_read_b64_tr_b16 v[230:231], v26 offset:25856
    v_fma_f32 v236, v236, s68, v27
    v_mul_f32 v237, v159, v159
    v_cvt_pk_bf16_f32 v244, v248, v249
    v_mul_f32 v232, v154, v232
    v_exp_f32 v235, v235
    s_waitcnt lgkmcnt(6)
    v_mfma_f32_32x32x16_bf16 v[160:175], v[216:219], v[120:123], v[160:175]
    ds_read_b64_tr_b16 v[208:209], v26 offset:26624
    ds_read_b64_tr_b16 v[210:211], v26 offset:26880
    v_add_f32 v234, 1.0, v234
    v_mul_f32 v236, v236, v158
    v_rcp_f32 v233, v233
    v_fma_f32 v237, v237, s68, v27
    v_mul_f32 v233, v155, v233
    s_waitcnt lgkmcnt(6)
    v_mfma_f32_32x32x16_bf16 v[160:175], v[220:223], v[124:127], v[160:175]
    s_waitcnt vmcnt(3)
    s_barrier
    ds_read_b64_tr_b16 v[212:213], v26 offset:27648
    ds_read_b64_tr_b16 v[214:215], v26 offset:27904
    v_exp_f32 v236, v236
    v_add_f32 v235, 1.0, v235
    v_mul_f32 v237, v237, v159
    v_rcp_f32 v234, v234
    s_waitcnt lgkmcnt(6)
    v_mfma_f32_32x32x16_bf16 v[160:175], v[224:227], v[128:131], v[160:175]
    ds_read_b64_tr_b16 v[216:217], v25 offset:0
    ds_read_b64_tr_b16 v[218:219], v25 offset:512
    v_mul_u32_u24 v251, 7, v255
    s_and_b32 s75, s64, 3
    s_lshl_b32 s75, s75, 3
    s_add_u32 s75, s75, s60
    s_lshl_b32 s74, s75, 5
    s_cmp_ge_u32 s75, 12
    s_cselect_b32 s73, 256, 0
    s_add_u32 s74, s74, s73
    s_cmp_ge_u32 s75, 22
    s_cselect_b32 s73, 256, 0
    s_add_u32 s74, s74, s73
    s_mul_i32 s74, s74, 896
    s_add_u32 s74, s74, s65
    s_mov_b64 exec, 0xffffffff
    buffer_load_dword v254, v251, s[44:47], s74 offen sc1
    s_mul_i32 s74, s75, 7168
    s_add_u32 s74, s74, s65
    s_mov_b64 exec, 0xff
    buffer_load_dword v254, v251, s[48:51], s74 offen sc1
    s_mov_b64 exec, -1
    v_cvt_pk_bf16_f32 v245, v232, v233
    v_mul_f32 v234, v156, v234
    v_exp_f32 v237, v237
    v_add_f32 v236, 1.0, v236
    v_rcp_f32 v235, v235
    s_waitcnt lgkmcnt(6)
    v_mfma_f32_32x32x16_bf16 v[160:175], v[228:231], v[132:135], v[160:175]
    ds_read_b64_tr_b16 v[220:221], v25 offset:2048
    ds_read_b64_tr_b16 v[222:223], v25 offset:2560
    v_mul_f32 v235, v157, v235
    v_add_f32 v237, 1.0, v237
    v_rcp_f32 v236, v236
    v_cvt_pk_bf16_f32 v246, v234, v235
    v_mul_f32 v236, v158, v236
    s_waitcnt lgkmcnt(6)
    v_mfma_f32_32x32x16_bf16 v[160:175], v[208:211], v[136:139], v[160:175]
    v_mfma_f32_32x32x16_bf16 v[160:175], v[186:189], v[176:179], v[160:175]
    ds_read_b64_tr_b16 v[224:225], v25 offset:4096
    ds_read_b64_tr_b16 v[226:227], v25 offset:4608
    v_rcp_f32 v237, v237
    s_nop 0
    v_mul_f32 v237, v159, v237
    v_cvt_pk_bf16_f32 v247, v236, v237
    s_add_u32 s75, s79, 3072
    buffer_store_dwordx4 v[244:247], v2, s[36:39], s75 offen sc1
    s_waitcnt lgkmcnt(6)
    v_mfma_f32_32x32x16_bf16 v[160:175], v[212:215], v[140:143], v[160:175]
    ds_read_b64_tr_b16 v[228:229], v25 offset:6144
    ds_read_b64_tr_b16 v[230:231], v25 offset:6656
    s_waitcnt lgkmcnt(6)
    v_mfma_f32_32x32x16_bf16 v[144:159], v[216:219], v[32:35], 0
    ds_read_b64_tr_b16 v[208:209], v25 offset:8192
    ds_read_b64_tr_b16 v[210:211], v25 offset:8704
    s_waitcnt lgkmcnt(6)
    v_mfma_f32_32x32x16_bf16 v[144:159], v[220:223], v[36:39], v[144:159]
    s_barrier
    ds_read_b64_tr_b16 v[212:213], v25 offset:10240
    ds_read_b64_tr_b16 v[214:215], v25 offset:10752
    s_add_u32 m0, s66, 0
    s_add_u32 s74, s65, 344064
    buffer_load_dwordx4 v31, s[44:47], s74 offen lds
    v_mul_f32 v232, v160, v160
    v_fma_f32 v232, v232, s68, v27
    v_mul_f32 v233, v161, v161
    v_mul_f32 v232, v232, v160
    v_fma_f32 v233, v233, s68, v27
    s_waitcnt lgkmcnt(6)
    v_mfma_f32_32x32x16_bf16 v[144:159], v[224:227], v[40:43], v[144:159]
    ds_read_b64_tr_b16 v[216:217], v25 offset:12288
    ds_read_b64_tr_b16 v[218:219], v25 offset:12800
    v_mul_f32 v234, v162, v162
    v_exp_f32 v232, v232
    v_mul_f32 v233, v233, v161
    v_fma_f32 v234, v234, s68, v27
    v_mul_f32 v235, v163, v163
    s_waitcnt lgkmcnt(6)
    v_mfma_f32_32x32x16_bf16 v[144:159], v[228:231], v[44:47], v[144:159]
    ds_read_b64_tr_b16 v[220:221], v25 offset:14336
    ds_read_b64_tr_b16 v[222:223], v25 offset:14848
    v_exp_f32 v233, v233
    v_add_f32 v232, 1.0, v232
    v_mul_f32 v234, v234, v162
    v_fma_f32 v235, v235, s68, v27
    v_mul_f32 v236, v164, v164
    s_waitcnt lgkmcnt(6)
    v_mfma_f32_32x32x16_bf16 v[144:159], v[208:211], v[48:51], v[144:159]
    ds_read_b64_tr_b16 v[224:225], v25 offset:16384
    ds_read_b64_tr_b16 v[226:227], v25 offset:16896
    v_exp_f32 v234, v234
    v_add_f32 v233, 1.0, v233
    v_mul_f32 v235, v235, v163
    v_rcp_f32 v232, v232
    s_waitcnt lgkmcnt(6)
    v_mfma_f32_32x32x16_bf16 v[144:159], v[212:215], v[52:55], v[144:159]
    ds_read_b64_tr_b16 v[228:229], v25 offset:18432
    ds_read_b64_tr_b16 v[230:231], v25 offset:18944
    v_fma_f32 v236, v236, s68, v27
    v_mul_f32 v237, v165, v165
    v_mul_f32 v232, v160, v232
    v_exp_f32 v235, v235
    v_add_f32 v234, 1.0, v234
    s_waitcnt lgkmcnt(6)
    v_mfma_f32_32x32x16_bf16 v[144:159], v[216:219], v[56:59], v[144:159]
    ds_read_b64_tr_b16 v[208:209], v25 offset:20480
    ds_read_b64_tr_b16 v[210:211], v25 offset:20992
    v_mul_f32 v236, v236, v164
    v_rcp_f32 v233, v233
    v_fma_f32 v237, v237, s68, v27
    v_mul_f32 v238, v166, v166
    v_mul_f32 v233, v161, v233
    s_waitcnt lgkmcnt(6)
    v_mfma_f32_32x32x16_bf16 v[144:159], v[220:223], v[60:63], v[144:159]
    ds_read_b64_tr_b16 v[212:213], v25 offset:22528
    ds_read_b64_tr_b16 v[214:215], v25 offset:23040
    v_exp_f32 v236, v236
    v_add_f32 v235, 1.0, v235
    v_mul_f32 v237, v237, v165
    v_rcp_f32 v234, v234
    s_waitcnt lgkmcnt(6)
    v_mfma_f32_32x32x16_bf16 v[144:159], v[224:227], v[64:67], v[144:159]
    ds_read_b64_tr_b16 v[216:217], v25 offset:24576
    ds_read_b64_tr_b16 v[218:219], v25 offset:25088
    v_fma_f32 v238, v238, s68, v27
    v_mul_f32 v239, v167, v167
    v_cvt_pk_bf16_f32 v240, v232, v233
    v_mul_f32 v234, v162, v234
    v_exp_f32 v237, v237
    s_waitcnt lgkmcnt(6)
    v_mfma_f32_32x32x16_bf16 v[144:159], v[228:231], v[68:71], v[144:159]
    ds_read_b64_tr_b16 v[220:221], v25 offset:26624
    ds_read_b64_tr_b16 v[222:223], v25 offset:27136
    v_add_f32 v236, 1.0, v236
    v_mul_f32 v238, v238, v166
    v_rcp_f32 v235, v235
    v_fma_f32 v239, v239, s68, v27
    v_mul_f32 v248, v168, v168
    s_waitcnt lgkmcnt(6)
    v_mfma_f32_32x32x16_bf16 v[144:159], v[208:211], v[72:75], v[144:159]
    ds_read_b64_tr_b16 v[224:225], v25 offset:28672
    ds_read_b64_tr_b16 v[226:227], v25 offset:29184
    s_add_u32 m0, s66, 4096
    s_add_u32 s74, s65, 372736
    buffer_load_dwordx4 v31, s[44:47], s74 offen lds
    v_mul_f32 v235, v163, v235
    v_exp_f32 v238, v238
    v_add_f32 v237, 1.0, v237
    v_mul_f32 v239, v239, v167
    s_waitcnt lgkmcnt(6)
    v_mfma_f32_32x32x16_bf16 v[144:159], v[212:215], v[76:79], v[144:159]
    ds_read_b64_tr_b16 v[228:229], v25 offset:30720
    ds_read_b64_tr_b16 v[230:231], v25 offset:31232
    v_rcp_f32 v236, v236
    v_fma_f32 v248, v248, s68, v27
    v_mul_f32 v249, v169, v169
    v_cvt_pk_bf16_f32 v241, v234, v235
    v_mul_f32 v236, v164, v236
    s_waitcnt lgkmcnt(6)
    v_mfma_f32_32x32x16_bf16 v[144:159], v[216:219], v[80:83], v[144:159]
    ds_read_b64_tr_b16 v[208:209], v25 offset:32768
    ds_read_b64_tr_b16 v[210:211], v25 offset:33280
    v_exp_f32 v239, v239
    v_add_f32 v238, 1.0, v238
    v_mul_f32 v248, v248, v168
    v_rcp_f32 v237, v237
    v_fma_f32 v249, v249, s68, v27
    s_waitcnt lgkmcnt(6)
    v_mfma_f32_32x32x16_bf16 v[144:159], v[220:223], v[84:87], v[144:159]
    ds_read_b64_tr_b16 v[212:213], v25 offset:34816
    ds_read_b64_tr_b16 v[214:215], v25 offset:35328
    v_mul_f32 v232, v170, v170
    v_mul_f32 v237, v165, v237
    v_exp_f32 v248, v248
    v_add_f32 v239, 1.0, v239
    s_waitcnt lgkmcnt(6)
    v_mfma_f32_32x32x16_bf16 v[144:159], v[224:227], v[88:91], v[144:159]
    ds_read_b64_tr_b16 v[216:217], v25 offset:36864
    ds_read_b64_tr_b16 v[218:219], v25 offset:37376
    v_mul_f32 v249, v249, v169
    v_rcp_f32 v238, v238
    v_fma_f32 v232, v232, s68, v27
    v_mul_f32 v233, v171, v171
    v_cvt_pk_bf16_f32 v242, v236, v237
    s_waitcnt lgkmcnt(6)
    v_mfma_f32_32x32x16_bf16 v[144:159], v[228:231], v[92:95], v[144:159]
    ds_read_b64_tr_b16 v[220:221], v25 offset:38912
    ds_read_b64_tr_b16 v[222:223], v25 offset:39424
    v_mul_f32 v238, v166, v238
    v_exp_f32 v249, v249
    v_add_f32 v248, 1.0, v248
    v_mul_f32 v232, v232, v170
    v_rcp_f32 v239, v239
    s_waitcnt lgkmcnt(6)
    v_mfma_f32_32x32x16_bf16 v[144:159], v[208:211], v[96:99], v[144:159]
    ds_read_b64_tr_b16 v[224:225], v25 offset:40960
    ds_read_b64_tr_b16 v[226:227], v25 offset:41472
    v_fma_f32 v233, v233, s68, v27
    v_mul_f32 v234, v172, v172
    v_mul_f32 v239, v167, v239
    v_exp_f32 v232, v232
    v_add_f32 v249, 1.0, v249
    s_waitcnt lgkmcnt(6)
    v_mfma_f32_32x32x16_bf16 v[144:159], v[212:215], v[100:103], v[144:159]
    ds_read_b64_tr_b16 v[228:229], v25 offset:43008
    ds_read_b64_tr_b16 v[230:231], v25 offset:43520
    v_mul_f32 v233, v233, v171
    v_rcp_f32 v248, v248
    v_fma_f32 v234, v234, s68, v27
    v_mul_f32 v235, v173, v173
    s_waitcnt lgkmcnt(6)
    v_mfma_f32_32x32x16_bf16 v[144:159], v[216:219], v[104:107], v[144:159]
    ds_read_b64_tr_b16 v[208:209], v25 offset:45056
    ds_read_b64_tr_b16 v[210:211], v25 offset:45568
    v_cvt_pk_bf16_f32 v243, v238, v239
    s_add_u32 s75, s80, 0
    buffer_store_dwordx4 v[240:243], v2, s[36:39], s75 offen sc1
    v_mul_f32 v248, v168, v248
    v_exp_f32 v233, v233
    v_add_f32 v232, 1.0, v232
    s_waitcnt lgkmcnt(6)
    v_mfma_f32_32x32x16_bf16 v[144:159], v[220:223], v[108:111], v[144:159]
    ds_read_b64_tr_b16 v[212:213], v25 offset:47104
    ds_read_b64_tr_b16 v[214:215], v25 offset:47616
    v_mul_f32 v234, v234, v172
    v_rcp_f32 v249, v249
    v_fma_f32 v235, v235, s68, v27
    v_mul_f32 v236, v174, v174
    v_mul_f32 v249, v169, v249
    s_waitcnt lgkmcnt(6)
    v_mfma_f32_32x32x16_bf16 v[144:159], v[224:227], v[112:115], v[144:159]
    ds_read_b64_tr_b16 v[216:217], v25 offset:49152
    ds_read_b64_tr_b16 v[218:219], v25 offset:49664
    v_exp_f32 v234, v234
    v_add_f32 v233, 1.0, v233
    v_mul_f32 v235, v235, v173
    v_rcp_f32 v232, v232
    s_waitcnt lgkmcnt(6)
    v_mfma_f32_32x32x16_bf16 v[144:159], v[228:231], v[116:119], v[144:159]
    ds_read_b64_tr_b16 v[220:221], v25 offset:51200
    ds_read_b64_tr_b16 v[222:223], v25 offset:51712
    v_fma_f32 v236, v236, s68, v27
    v_mul_f32 v237, v175, v175
    v_cvt_pk_bf16_f32 v244, v248, v249
    v_mul_f32 v232, v170, v232
    v_exp_f32 v235, v235
    s_waitcnt lgkmcnt(6)
    v_mfma_f32_32x32x16_bf16 v[144:159], v[208:211], v[120:123], v[144:159]
    ds_read_b64_tr_b16 v[224:225], v25 offset:53248
    ds_read_b64_tr_b16 v[226:227], v25 offset:53760
    v_add_f32 v234, 1.0, v234
    v_mul_f32 v236, v236, v174
    v_rcp_f32 v233, v233
    v_fma_f32 v237, v237, s68, v27
    v_mul_f32 v233, v171, v233
    s_waitcnt lgkmcnt(6)
    v_mfma_f32_32x32x16_bf16 v[144:159], v[212:215], v[124:127], v[144:159]
    ds_read_b64_tr_b16 v[228:229], v25 offset:55296
    ds_read_b64_tr_b16 v[230:231], v25 offset:55808
    v_exp_f32 v236, v236
    v_add_f32 v235, 1.0, v235
    v_mul_f32 v237, v237, v175
    v_rcp_f32 v234, v234
    s_waitcnt lgkmcnt(6)
    v_mfma_f32_32x32x16_bf16 v[144:159], v[216:219], v[128:131], v[144:159]
    ds_read_b64_tr_b16 v[208:209], v24 offset:8192
    ds_read_b64_tr_b16 v[210:211], v24 offset:8704
    s_cmp_lg_u32 s60, 0
    s_cbranch_scc1 L_ncHA
    buffer_load_dword v30, v23, s[40:43], 0 offen offset:64 sc1
L_ncHA:
    v_cvt_pk_bf16_f32 v245, v232, v233
    v_mul_f32 v234, v172, v234
    v_exp_f32 v237, v237
    v_add_f32 v236, 1.0, v236
    v_rcp_f32 v235, v235
    s_waitcnt lgkmcnt(6)
    v_mfma_f32_32x32x16_bf16 v[144:159], v[220:223], v[132:135], v[144:159]
    ds_read_b64_tr_b16 v[212:213], v24 offset:10240
    ds_read_b64_tr_b16 v[214:215], v24 offset:10752
    v_mul_f32 v235, v173, v235
    v_add_f32 v237, 1.0, v237
    v_rcp_f32 v236, v236
    v_cvt_pk_bf16_f32 v246, v234, v235
    v_mul_f32 v236, v174, v236
    s_waitcnt lgkmcnt(6)
    v_mfma_f32_32x32x16_bf16 v[144:159], v[224:227], v[136:139], v[144:159]
    v_mfma_f32_32x32x16_bf16 v[144:159], v[188:191], v[176:179], v[144:159]
    ds_read_b64_tr_b16 v[216:217], v24 offset:12288
    ds_read_b64_tr_b16 v[218:219], v24 offset:12800
    v_rcp_f32 v237, v237
    s_nop 0
    v_mul_f32 v237, v175, v237
    v_cvt_pk_bf16_f32 v247, v236, v237
    s_add_u32 s75, s80, 1024
    buffer_store_dwordx4 v[244:247], v2, s[36:39], s75 offen sc1
    s_waitcnt lgkmcnt(6)
    v_mfma_f32_32x32x16_bf16 v[144:159], v[228:231], v[140:143], v[144:159]
    ds_read_b64_tr_b16 v[220:221], v24 offset:14336
    ds_read_b64_tr_b16 v[222:223], v24 offset:14848
    s_waitcnt lgkmcnt(6)
    v_mfma_f32_32x32x16_bf16 v[160:175], v[208:211], v[32:35], 0
    ds_read_b64_tr_b16 v[224:225], v24 offset:16384
    ds_read_b64_tr_b16 v[226:227], v24 offset:16896
    s_waitcnt lgkmcnt(6)
    v_mfma_f32_32x32x16_bf16 v[160:175], v[212:215], v[36:39], v[160:175]
    s_barrier
    ds_read_b64_tr_b16 v[228:229], v24 offset:18432
    ds_read_b64_tr_b16 v[230:231], v24 offset:18944
    s_nop 0
    v_mul_f32 v232, v144, v144
    v_fma_f32 v232, v232, s68, v27
    v_mul_f32 v233, v145, v145
    v_mul_f32 v232, v232, v144
    v_fma_f32 v233, v233, s68, v27
    s_waitcnt lgkmcnt(6)
    v_mfma_f32_32x32x16_bf16 v[160:175], v[216:219], v[40:43], v[160:175]
    ds_read_b64_tr_b16 v[208:209], v24 offset:20480
    ds_read_b64_tr_b16 v[210:211], v24 offset:20992
    s_add_u32 m0, s66, 49152
    s_add_u32 s74, s65, 200704
    buffer_load_dwordx4 v31, s[48:51], s74 offen lds
    v_mul_f32 v234, v146, v146
    v_exp_f32 v232, v232
    v_mul_f32 v233, v233, v145
    v_fma_f32 v234, v234, s68, v27
    v_mul_f32 v235, v147, v147
    s_waitcnt lgkmcnt(6)
    v_mfma_f32_32x32x16_bf16 v[160:175], v[220:223], v[44:47], v[160:175]
    ds_read_b64_tr_b16 v[212:213], v24 offset:22528
    ds_read_b64_tr_b16 v[214:215], v24 offset:23040
    v_exp_f32 v233, v233
    v_add_f32 v232, 1.0, v232
    v_mul_f32 v234, v234, v146
    v_fma_f32 v235, v235, s68, v27
    v_mul_f32 v236, v148, v148
    s_waitcnt lgkmcnt(6)
    v_mfma_f32_32x32x16_bf16 v[160:175], v[224:227], v[48:51], v[160:175]
    ds_read_b64_tr_b16 v[216:217], v24 offset:24576
    ds_read_b64_tr_b16 v[218:219], v24 offset:25088
    v_exp_f32 v234, v234
    v_add_f32 v233, 1.0, v233
    v_mul_f32 v235, v235, v147
    v_rcp_f32 v232, v232
    s_waitcnt lgkmcnt(6)
    v_mfma_f32_32x32x16_bf16 v[160:175], v[228:231], v[52:55], v[160:175]
    ds_read_b64_tr_b16 v[220:221], v24 offset:26624
    ds_read_b64_tr_b16 v[222:223], v24 offset:27136
    s_add_u32 m0, s66, 53248
    s_add_u32 s74, s65, 229376
    buffer_load_dwordx4 v31, s[48:51], s74 offen lds
    v_fma_f32 v236, v236, s68, v27
    v_mul_f32 v237, v149, v149
    v_mul_f32 v232, v144, v232
    v_exp_f32 v235, v235
    v_add_f32 v234, 1.0, v234
    s_waitcnt lgkmcnt(6)
    v_mfma_f32_32x32x16_bf16 v[160:175], v[208:211], v[56:59], v[160:175]
    ds_read_b64_tr_b16 v[224:225], v24 offset:28672
    ds_read_b64_tr_b16 v[226:227], v24 offset:29184
    v_mul_f32 v236, v236, v148
    v_rcp_f32 v233, v233
    v_fma_f32 v237, v237, s68, v27
    v_mul_f32 v238, v150, v150
    v_mul_f32 v233, v145, v233
    s_waitcnt lgkmcnt(6)
    v_mfma_f32_32x32x16_bf16 v[160:175], v[212:215], v[60:63], v[160:175]
    ds_read_b64_tr_b16 v[228:229], v24 offset:30720
    ds_read_b64_tr_b16 v[230:231], v24 offset:31232
    v_exp_f32 v236, v236
    v_add_f32 v235, 1.0, v235
    v_mul_f32 v237, v237, v149
    v_rcp_f32 v234, v234
    s_waitcnt lgkmcnt(6)
    v_mfma_f32_32x32x16_bf16 v[160:175], v[216:219], v[64:67], v[160:175]
    ds_read_b64_tr_b16 v[208:209], v24 offset:32768
    ds_read_b64_tr_b16 v[210:211], v24 offset:33280
    s_add_u32 m0, s66, 57344
    s_add_u32 s74, s65, 250880
    buffer_load_dwordx4 v31, s[48:51], s74 offen lds
    v_fma_f32 v238, v238, s68, v27
    v_mul_f32 v239, v151, v151
    v_cvt_pk_bf16_f32 v240, v232, v233
    v_mul_f32 v234, v146, v234
    v_exp_f32 v237, v237
    s_waitcnt lgkmcnt(6)
    v_mfma_f32_32x32x16_bf16 v[160:175], v[220:223], v[68:71], v[160:175]
    ds_read_b64_tr_b16 v[212:213], v24 offset:34816
    ds_read_b64_tr_b16 v[214:215], v24 offset:35328
    v_add_f32 v236, 1.0, v236
    v_mul_f32 v238, v238, v150
    v_rcp_f32 v235, v235
    v_fma_f32 v239, v239, s68, v27
    v_mul_f32 v248, v152, v152
    s_waitcnt lgkmcnt(6)
    v_mfma_f32_32x32x16_bf16 v[160:175], v[224:227], v[72:75], v[160:175]
    ds_read_b64_tr_b16 v[216:217], v24 offset:36864
    ds_read_b64_tr_b16 v[218:219], v24 offset:37376
    v_mul_f32 v235, v147, v235
    v_exp_f32 v238, v238
    v_add_f32 v237, 1.0, v237
    v_mul_f32 v239, v239, v151
    s_waitcnt lgkmcnt(6)
    v_mfma_f32_32x32x16_bf16 v[160:175], v[228:231], v[76:79], v[160:175]
    ds_read_b64_tr_b16 v[220:221], v24 offset:38912
    ds_read_b64_tr_b16 v[222:223], v24 offset:39424
    s_add_u32 m0, s66, 61440
    s_add_u32 s74, s65, 279552
    buffer_load_dwordx4 v31, s[48:51], s74 offen lds
    v_rcp_f32 v236, v236
    v_fma_f32 v248, v248, s68, v27
    v_mul_f32 v249, v153, v153
    v_cvt_pk_bf16_f32 v241, v234, v235
    v_mul_f32 v236, v148, v236
    s_waitcnt lgkmcnt(6)
    v_mfma_f32_32x32x16_bf16 v[160:175], v[208:211], v[80:83], v[160:175]
    ds_read_b64_tr_b16 v[224:225], v24 offset:40960
    ds_read_b64_tr_b16 v[226:227], v24 offset:41472
    v_exp_f32 v239, v239
    v_add_f32 v238, 1.0, v238
    v_mul_f32 v248, v248, v152
    v_rcp_f32 v237, v237
    v_fma_f32 v249, v249, s68, v27
    s_waitcnt lgkmcnt(6)
    v_mfma_f32_32x32x16_bf16 v[160:175], v[212:215], v[84:87], v[160:175]
    ds_read_b64_tr_b16 v[228:229], v24 offset:43008
    ds_read_b64_tr_b16 v[230:231], v24 offset:43520
    v_mul_f32 v232, v154, v154
    v_mul_f32 v237, v149, v237
    v_exp_f32 v248, v248
    v_add_f32 v239, 1.0, v239
    s_waitcnt lgkmcnt(6)
    v_mfma_f32_32x32x16_bf16 v[160:175], v[216:219], v[88:91], v[160:175]
    ds_read_b64_tr_b16 v[208:209], v24 offset:45056
    ds_read_b64_tr_b16 v[210:211], v24 offset:45568
    v_mul_f32 v249, v249, v153
    v_rcp_f32 v238, v238
    v_fma_f32 v232, v232, s68, v27
    v_mul_f32 v233, v155, v155
    v_cvt_pk_bf16_f32 v242, v236, v237
    s_waitcnt lgkmcnt(6)
    v_mfma_f32_32x32x16_bf16 v[160:175], v[220:223], v[92:95], v[160:175]
    ds_read_b64_tr_b16 v[212:213], v24 offset:47104
    ds_read_b64_tr_b16 v[214:215], v24 offset:47616
    v_mul_f32 v238, v150, v238
    v_exp_f32 v249, v249
    v_add_f32 v248, 1.0, v248
    v_mul_f32 v232, v232, v154
    v_rcp_f32 v239, v239
    s_waitcnt lgkmcnt(6)
    v_mfma_f32_32x32x16_bf16 v[160:175], v[224:227], v[96:99], v[160:175]
    s_waitcnt vmcnt(5)
    s_cmp_lg_u32 s60, 0
    s_cbranch_scc1 L_cokHA
    s_mov_b32 s71, 0
L_certHA:
    v_cmp_eq_u32 vcc, 0, v30
    s_nop 1
    s_cbranch_vccz L_cokHA
    s_add_u32 s71, s71, 1
    s_cmp_ge_u32 s71, 0x40000
    s_cbranch_scc1 L_cokHA
    s_sleep 2
    buffer_load_dword v30, v23, s[40:43], 0 offen offset:64 sc1
    s_waitcnt vmcnt(0)
    s_branch L_certHA
L_cokHA:
    s_barrier
    ds_read_b64_tr_b16 v[216:217], v24 offset:49152
    ds_read_b64_tr_b16 v[218:219], v24 offset:49664
    v_fma_f32 v233, v233, s68, v27
    v_mul_f32 v234, v156, v156
    v_mul_f32 v239, v151, v239
    v_exp_f32 v232, v232
    v_add_f32 v249, 1.0, v249
    s_waitcnt lgkmcnt(6)
    v_mfma_f32_32x32x16_bf16 v[160:175], v[228:231], v[100:103], v[160:175]
    ds_read_b64_tr_b16 v[220:221], v24 offset:51200
    ds_read_b64_tr_b16 v[222:223], v24 offset:51712
    v_mul_f32 v233, v233, v155
    v_rcp_f32 v248, v248
    v_fma_f32 v234, v234, s68, v27
    v_mul_f32 v235, v157, v157
    s_waitcnt lgkmcnt(6)
    v_mfma_f32_32x32x16_bf16 v[160:175], v[208:211], v[104:107], v[160:175]
    ds_read_b64_tr_b16 v[224:225], v24 offset:53248
    ds_read_b64_tr_b16 v[226:227], v24 offset:53760
    v_cvt_pk_bf16_f32 v243, v238, v239
    s_add_u32 s75, s79, 6144
    buffer_store_dwordx4 v[240:243], v2, s[36:39], s75 offen sc1
    v_mul_f32 v248, v152, v248
    v_exp_f32 v233, v233
    v_add_f32 v232, 1.0, v232
    s_waitcnt lgkmcnt(6)
    v_mfma_f32_32x32x16_bf16 v[160:175], v[212:215], v[108:111], v[160:175]
    ds_read_b64_tr_b16 v[228:229], v24 offset:55296
    ds_read_b64_tr_b16 v[230:231], v24 offset:55808
    v_mul_f32 v234, v234, v156
    v_rcp_f32 v249, v249
    v_fma_f32 v235, v235, s68, v27
    v_mul_f32 v236, v158, v158
    v_mul_f32 v249, v153, v249
    s_waitcnt lgkmcnt(6)
    v_mfma_f32_32x32x16_bf16 v[160:175], v[216:219], v[112:115], v[160:175]
    ds_read_b64_tr_b16 v[208:209], v24 offset:0
    ds_read_b64_tr_b16 v[210:211], v24 offset:512
    v_exp_f32 v234, v234
    v_add_f32 v233, 1.0, v233
    v_mul_f32 v235, v235, v157
    v_rcp_f32 v232, v232
    s_waitcnt lgkmcnt(6)
    v_mfma_f32_32x32x16_bf16 v[160:175], v[220:223], v[116:119], v[160:175]
    ds_read_b64_tr_b16 v[212:213], v24 offset:2048
    ds_read_b64_tr_b16 v[214:215], v24 offset:2560
    v_fma_f32 v236, v236, s68, v27
    v_mul_f32 v237, v159, v159
    v_cvt_pk_bf16_f32 v244, v248, v249
    v_mul_f32 v232, v154, v232
    v_exp_f32 v235, v235
    s_waitcnt lgkmcnt(6)
    v_mfma_f32_32x32x16_bf16 v[160:175], v[224:227], v[120:123], v[160:175]
    ds_read_b64_tr_b16 v[216:217], v24 offset:4096
    ds_read_b64_tr_b16 v[218:219], v24 offset:4608
    v_add_f32 v234, 1.0, v234
    v_mul_f32 v236, v236, v158
    v_rcp_f32 v233, v233
    v_fma_f32 v237, v237, s68, v27
    v_mul_f32 v233, v155, v233
    s_waitcnt lgkmcnt(6)
    v_mfma_f32_32x32x16_bf16 v[160:175], v[228:231], v[124:127], v[160:175]
    ds_read_b64_tr_b16 v[220:221], v24 offset:6144
    ds_read_b64_tr_b16 v[222:223], v24 offset:6656
    v_exp_f32 v236, v236
    v_add_f32 v235, 1.0, v235
    v_mul_f32 v237, v237, v159
    v_rcp_f32 v234, v234
    s_waitcnt lgkmcnt(6)
    v_mfma_f32_32x32x16_bf16 v[160:175], v[208:211], v[128:131], v[160:175]
    v_cvt_pk_bf16_f32 v245, v232, v233
    v_mul_f32 v234, v156, v234
    v_exp_f32 v237, v237
    v_add_f32 v236, 1.0, v236
    v_rcp_f32 v235, v235
    s_waitcnt lgkmcnt(4)
    v_mfma_f32_32x32x16_bf16 v[160:175], v[212:215], v[132:135], v[160:175]
    v_mul_f32 v235, v157, v235
    v_add_f32 v237, 1.0, v237
    v_rcp_f32 v236, v236
    v_cvt_pk_bf16_f32 v246, v234, v235
    v_mul_f32 v236, v158, v236
    s_waitcnt lgkmcnt(2)
    v_mfma_f32_32x32x16_bf16 v[160:175], v[216:219], v[136:139], v[160:175]
    v_mfma_f32_32x32x16_bf16 v[160:175], v[190:193], v[176:179], v[160:175]
    v_rcp_f32 v237, v237
    s_nop 0
    v_mul_f32 v237, v159, v237
    v_cvt_pk_bf16_f32 v247, v236, v237
    s_add_u32 s75, s79, 7168
    buffer_store_dwordx4 v[244:247], v2, s[36:39], s75 offen sc1
    s_waitcnt lgkmcnt(0)
    v_mfma_f32_32x32x16_bf16 v[160:175], v[220:223], v[140:143], v[160:175]
    s_waitcnt vmcnt(2)
    s_barrier
    s_lshl_b32 s72, s61, 12
    s_lshl_b32 s73, s63, 8
    s_add_u32 s72, s72, s73
    s_lshl_b32 s73, s62, 5
    s_add_u32 s72, s72, s73
    s_lshl_b32 s73, s60, 2
    s_add_u32 s72, s72, s73
    s_add_u32 s72, s72, 262144
    s_nop 1
    v_mul_f32 v232, v160, v160
    v_fma_f32 v232, v232, s68, v27
    v_mul_f32 v233, v161, v161
    v_mul_f32 v232, v232, v160
    v_fma_f32 v233, v233, s68, v27
    v_mul_f32 v234, v162, v162
    v_exp_f32 v232, v232
    v_mul_f32 v233, v233, v161
    v_fma_f32 v234, v234, s68, v27
    v_mul_f32 v235, v163, v163
    v_exp_f32 v233, v233
    v_add_f32 v232, 1.0, v232
    v_mul_f32 v234, v234, v162
    v_fma_f32 v235, v235, s68, v27
    v_mul_f32 v236, v164, v164
    v_exp_f32 v234, v234
    v_add_f32 v233, 1.0, v233
    v_mul_f32 v235, v235, v163
    v_rcp_f32 v232, v232
    v_fma_f32 v236, v236, s68, v27
    v_mul_f32 v237, v165, v165
    v_mul_f32 v232, v160, v232
    v_exp_f32 v235, v235
    v_add_f32 v234, 1.0, v234
    v_mul_f32 v236, v236, v164
    v_rcp_f32 v233, v233
    v_fma_f32 v237, v237, s68, v27
    v_mul_f32 v238, v166, v166
    v_mul_f32 v233, v161, v233
    v_exp_f32 v236, v236
    v_add_f32 v235, 1.0, v235
    v_mul_f32 v237, v237, v165
    v_rcp_f32 v234, v234
    v_fma_f32 v238, v238, s68, v27
    v_mul_f32 v239, v167, v167
    v_cvt_pk_bf16_f32 v240, v232, v233
    v_mul_f32 v234, v162, v234
    v_exp_f32 v237, v237
    v_add_f32 v236, 1.0, v236
    v_mul_f32 v238, v238, v166
    v_rcp_f32 v235, v235
    v_fma_f32 v239, v239, s68, v27
    v_mul_f32 v248, v168, v168
    v_mul_f32 v235, v163, v235
    v_exp_f32 v238, v238
    v_add_f32 v237, 1.0, v237
    v_mul_f32 v239, v239, v167
    v_rcp_f32 v236, v236
    v_fma_f32 v248, v248, s68, v27
    v_mul_f32 v249, v169, v169
    v_cvt_pk_bf16_f32 v241, v234, v235
    v_mul_f32 v236, v164, v236
    v_exp_f32 v239, v239
    v_add_f32 v238, 1.0, v238
    v_mul_f32 v248, v248, v168
    v_rcp_f32 v237, v237
    v_fma_f32 v249, v249, s68, v27
    v_mul_f32 v232, v170, v170
    v_mul_f32 v237, v165, v237
    v_exp_f32 v248, v248
    v_add_f32 v239, 1.0, v239
    v_mul_f32 v249, v249, v169
    v_rcp_f32 v238, v238
    v_fma_f32 v232, v232, s68, v27
    v_mul_f32 v233, v171, v171
    v_cvt_pk_bf16_f32 v242, v236, v237
    v_mul_f32 v238, v166, v238
    v_exp_f32 v249, v249
    v_add_f32 v248, 1.0, v248
    v_mul_f32 v232, v232, v170
    v_rcp_f32 v239, v239
    v_fma_f32 v233, v233, s68, v27
    v_mul_f32 v234, v172, v172
    v_mul_f32 v239, v167, v239
    v_exp_f32 v232, v232
    v_add_f32 v249, 1.0, v249
    v_mul_f32 v233, v233, v171
    v_rcp_f32 v248, v248
    v_fma_f32 v234, v234, s68, v27
    v_mul_f32 v235, v173, v173
    v_cvt_pk_bf16_f32 v243, v238, v239
    s_add_u32 s75, s79, 10240
    buffer_store_dwordx4 v[240:243], v2, s[36:39], s75 offen sc1
    v_mul_f32 v248, v168, v248
    v_exp_f32 v233, v233
    v_add_f32 v232, 1.0, v232
    v_mul_f32 v234, v234, v172
    v_rcp_f32 v249, v249
    v_fma_f32 v235, v235, s68, v27
    v_mul_f32 v236, v174, v174
    v_mul_f32 v249, v169, v249
    v_exp_f32 v234, v234
    v_add_f32 v233, 1.0, v233
    v_mul_f32 v235, v235, v173
    v_rcp_f32 v232, v232
    v_fma_f32 v236, v236, s68, v27
    v_mul_f32 v237, v175, v175
    v_cvt_pk_bf16_f32 v244, v248, v249
    v_mul_f32 v232, v170, v232
    v_exp_f32 v235, v235
    v_add_f32 v234, 1.0, v234
    v_mul_f32 v236, v236, v174
    v_rcp_f32 v233, v233
    v_fma_f32 v237, v237, s68, v27
    v_mul_f32 v233, v171, v233
    v_exp_f32 v236, v236
    v_add_f32 v235, 1.0, v235
    v_mul_f32 v237, v237, v175
    v_rcp_f32 v234, v234
    v_cvt_pk_bf16_f32 v245, v232, v233
    v_mul_f32 v234, v172, v234
    v_exp_f32 v237, v237
    v_add_f32 v236, 1.0, v236
    v_rcp_f32 v235, v235
    s_nop 0
    v_mul_f32 v235, v173, v235
    v_add_f32 v237, 1.0, v237
    v_rcp_f32 v236, v236
    v_cvt_pk_bf16_f32 v246, v234, v235
    v_mul_f32 v236, v174, v236
    v_rcp_f32 v237, v237
    s_nop 0
    v_mul_f32 v237, v175, v237
    v_cvt_pk_bf16_f32 v247, v236, v237
    s_add_u32 s75, s79, 11264
    buffer_store_dwordx4 v[244:247], v2, s[36:39], s75 offen sc1
    s_branch L_P2
L_HB:
    s_mov_b32 s32, s12
    s_mov_b32 s33, s13
    s_mov_b32 s34, 1605632
    s_mov_b32 s35, 0x20000
    s_mov_b32 s4, s14
    s_mov_b32 s5, s15
    s_mov_b32 s6, 3584
    s_mov_b32 s7, 0x20000
    s_lshr_b32 s70, s62, 1
    s_mul_i32 s70, s70, 896
    s_and_b32 s71, s62, 1
    s_lshl_b32 s76, s71, 9
    s_add_u32 s76, s76, s70
    s_lshl_b32 s77, s71, 6
    s_add_u32 s77, s77, s70
    s_add_u32 s77, s77, 384
    v_bfe_u32 v12, v0, 3, 5
    v_mul_u32_u24 v4, 3584, v12
    v_lshrrev_b32 v13, 2, v1
    v_and_b32 v13, 4, v13
    s_and_b32 s70, s60, 1
    s_lshl_b32 s70, s70, 1
    v_or_b32 v13, s70, v13
    v_and_b32 v12, 7, v1
    v_xor_b32 v12, v12, v13
    v_lshl_add_u32 v4, v12, 4, v4
    v_and_b32 v29, 31, v1
    v_lshlrev_b32 v29, 1, v29
    s_mov_b32 s36, s24
    s_mov_b32 s37, s25
    s_mov_b32 s38, 268435456
    s_mov_b32 s39, 0x20000
    s_mov_b32 s40, s22
    s_mov_b32 s41, s23
    s_mov_b32 s42, 256
    s_mov_b32 s43, 0x20000
    s_mov_b32 s44, s16
    s_mov_b32 s45, s17
    s_mov_b32 s46, 1605632
    s_mov_b32 s47, 0x20000
    s_mov_b32 s48, s8
    s_mov_b32 s49, s9
    s_mov_b32 s50, 401408
    s_mov_b32 s51, 0x20000
    s_mov_b32 s52, s20
    s_mov_b32 s53, s21
    s_mov_b32 s54, 1835008
    s_mov_b32 s55, 0x20000
    s_mov_b64 s[58:59], s[18:19]
    s_lshr_b32 s70, s64, 1
    s_sub_u32 s70, s70, s61
    v_and_b32 v23, 1, v1
    v_mul_lo_u32 v23, v23, s70
    v_add_u32 v23, s61, v23
    v_lshlrev_b32 v23, 2, v23
    v_lshlrev_b32 v255, 7, v1
    v_bfe_u32 v12, v0, 3, 5
    v_mul_u32_u24 v31, 896, v12
    v_lshrrev_b32 v13, 2, v1
    v_and_b32 v13, 4, v13
    v_and_b32 v12, 7, v1
    v_xor_b32 v12, v12, v13
    v_lshl_add_u32 v31, v12, 4, v31
    v_bfe_u32 v12, v0, 2, 6
    v_mul_u32_u24 v5, 3584, v12
    v_and_b32 v12, 3, v1
    v_lshl_add_u32 v5, v12, 4, v5
    v_mov_b32 v27, 0xc0135761
    s_mov_b32 s68, 0xbdd2d3e8
    v_cmp_gt_u32 vcc, 32, v1
    v_mov_b32 v12, 0x3f80
    v_mov_b32 v177, 0
    v_cndmask_b32 v176, 0, v12, vcc
    v_mov_b32 v178, 0
    v_mov_b32 v179, 0
    v_mov_b32 v185, 0
    v_mov_b32 v187, 0
    v_mov_b32 v189, 0
    v_mov_b32 v191, 0
    v_mov_b32 v192, 0
    v_mov_b32 v193, 0
    v_mov_b32 v190, 0
    v_and_b32 v12, 31, v1
    s_and_b32 s70, s60, 3
    s_lshl_b32 s70, s70, 5
    v_add_u32 v13, s70, v12
    v_mul_u32_u24 v13, 896, v13
    v_bfe_u32 v12, v1, 1, 3
    v_lshrrev_b32 v14, 5, v1
    v_xor_b32 v12, v12, v14
    v_xor_b32 v14, 0, v12
    v_lshl_add_u32 v8, v14, 4, v13
    v_xor_b32 v14, 2, v12
    v_lshl_add_u32 v9, v14, 4, v13
    v_xor_b32 v14, 4, v12
    v_lshl_add_u32 v10, v14, 4, v13
    v_xor_b32 v14, 6, v12
    v_lshl_add_u32 v11, v14, 4, v13
    v_lshrrev_b32 v12, 5, v1
    v_bfe_u32 v13, v1, 2, 2
    v_lshl_add_u32 v14, v12, 3, v13
    v_bfe_u32 v15, v1, 4, 1
    v_lshlrev_b32 v15, 1, v15
    v_bfe_u32 v16, v1, 1, 1
    v_or_b32 v15, v15, v16
    v_lshrrev_b32 v16, 1, v13
    v_lshlrev_b32 v16, 2, v16
    v_lshl_or_b32 v16, v12, 1, v16
    v_xor_b32 v16, v15, v16
    v_xor_b32 v16, 0, v16
    v_lshlrev_b32 v16, 4, v16
    v_and_b32 v17, 1, v1
    v_lshl_or_b32 v16, v17, 3, v16
    v_lshl_add_u32 v24, v14, 7, v16
    v_add_u32 v25, 49152, v24
    v_add_u32 v24, 106496, v24
    v_lshlrev_b32 v15, 4, v15
    v_lshl_or_b32 v15, v17, 3, v15
    v_lshl_add_u32 v26, v14, 6, v15
    s_and_b32 s70, s60, 3
    s_lshl_b32 s71, s61, 2
    s_add_u32 s71, s71, s70
    s_mul_i32 s71, s71, 148480
    s_add_u32 s71, s71, 1048576
    s_lshl_b32 s79, s76, 5
    s_add_u32 s79, s79, s71
    s_lshl_b32 s80, s77, 5
    s_add_u32 s80, s80, s71
    v_lshrrev_b32 v12, 3, v1
    s_lshl_b32 s70, s60, 4
    v_add_u32 v12, s70, v12
    v_mul_u32_u24 v12, 896, v12
    v_lshrrev_b32 v13, 4, v1
    v_and_b32 v14, 7, v1
    v_xor_b32 v13, v13, v14
    v_lshl_add_u32 v6, v13, 4, v12
    v_xor_b32 v13, 4, v13
    v_lshl_add_u32 v7, v13, 4, v12
    v_add_u32 v7, 7168, v7
    v_mov_b32 v104, 0
    v_mov_b32 v105, 0
    s_waitcnt vmcnt(13)
    v_dot2c_f32_bf16 v104, s67, v32
    v_dot2c_f32_bf16 v105, v32, v32
    v_dot2c_f32_bf16 v104, s67, v33
    v_dot2c_f32_bf16 v105, v33, v33
    v_dot2c_f32_bf16 v104, s67, v34
    v_dot2c_f32_bf16 v105, v34, v34
    v_dot2c_f32_bf16 v104, s67, v35
    v_dot2c_f32_bf16 v105, v35, v35
    s_waitcnt vmcnt(12)
    v_dot2c_f32_bf16 v104, s67, v36
    v_dot2c_f32_bf16 v105, v36, v36
    v_dot2c_f32_bf16 v104, s67, v37
    v_dot2c_f32_bf16 v105, v37, v37
    v_dot2c_f32_bf16 v104, s67, v38
    v_dot2c_f32_bf16 v105, v38, v38
    v_dot2c_f32_bf16 v104, s67, v39
    v_dot2c_f32_bf16 v105, v39, v39
    s_waitcnt vmcnt(11)
    v_dot2c_f32_bf16 v104, s67, v40
    v_dot2c_f32_bf16 v105, v40, v40
    v_dot2c_f32_bf16 v104, s67, v41
    v_dot2c_f32_bf16 v105, v41, v41
    v_dot2c_f32_bf16 v104, s67, v42
    v_dot2c_f32_bf16 v105, v42, v42
    v_dot2c_f32_bf16 v104, s67, v43
    v_dot2c_f32_bf16 v105, v43, v43
    s_waitcnt vmcnt(10)
    v_dot2c_f32_bf16 v104, s67, v44
    v_dot2c_f32_bf16 v105, v44, v44
    v_dot2c_f32_bf16 v104, s67, v45
    v_dot2c_f32_bf16 v105, v45, v45
    v_dot2c_f32_bf16 v104, s67, v46
    v_dot2c_f32_bf16 v105, v46, v46
    v_dot2c_f32_bf16 v104, s67, v47
    v_dot2c_f32_bf16 v105, v47, v47
    s_waitcnt vmcnt(9)
    v_dot2c_f32_bf16 v104, s67, v48
    v_dot2c_f32_bf16 v105, v48, v48
    v_dot2c_f32_bf16 v104, s67, v49
    v_dot2c_f32_bf16 v105, v49, v49
    v_dot2c_f32_bf16 v104, s67, v50
    v_dot2c_f32_bf16 v105, v50, v50
    v_dot2c_f32_bf16 v104, s67, v51
    v_dot2c_f32_bf16 v105, v51, v51
    s_waitcnt vmcnt(8)
    v_dot2c_f32_bf16 v104, s67, v52
    v_dot2c_f32_bf16 v105, v52, v52
    v_dot2c_f32_bf16 v104, s67, v53
    v_dot2c_f32_bf16 v105, v53, v53
    v_dot2c_f32_bf16 v104, s67, v54
    v_dot2c_f32_bf16 v105, v54, v54
    v_dot2c_f32_bf16 v104, s67, v55
    v_dot2c_f32_bf16 v105, v55, v55
    s_waitcnt vmcnt(7)
    v_dot2c_f32_bf16 v104, s67, v56
    v_dot2c_f32_bf16 v105, v56, v56
    v_dot2c_f32_bf16 v104, s67, v57
    v_dot2c_f32_bf16 v105, v57, v57
    v_dot2c_f32_bf16 v104, s67, v58
    v_dot2c_f32_bf16 v105, v58, v58
    v_dot2c_f32_bf16 v104, s67, v59
    v_dot2c_f32_bf16 v105, v59, v59
    v_mov_b32 v112, 0
    v_mov_b32 v113, 0
    v_add_f32_dpp v104, v104, v104 quad_perm:[1,0,3,2] row_mask:0xf bank_mask:0xf
    s_waitcnt vmcnt(6)
    v_dot2c_f32_bf16 v112, s67, v60
    v_add_f32_dpp v105, v105, v105 quad_perm:[1,0,3,2] row_mask:0xf bank_mask:0xf
    v_dot2c_f32_bf16 v113, v60, v60
    v_dot2c_f32_bf16 v112, s67, v61
    v_add_f32_dpp v104, v104, v104 quad_perm:[2,3,0,1] row_mask:0xf bank_mask:0xf
    v_dot2c_f32_bf16 v113, v61, v61
    v_dot2c_f32_bf16 v112, s67, v62
    v_add_f32_dpp v105, v105, v105 quad_perm:[2,3,0,1] row_mask:0xf bank_mask:0xf
    v_dot2c_f32_bf16 v113, v62, v62
    v_dot2c_f32_bf16 v112, s67, v63
    v_add_f32_dpp v104, v104, v104 row_half_mirror row_mask:0xf bank_mask:0xf
    v_dot2c_f32_bf16 v113, v63, v63
    s_waitcnt vmcnt(5)
    v_add_f32_dpp v105, v105, v105 row_half_mirror row_mask:0xf bank_mask:0xf
    v_dot2c_f32_bf16 v112, s67, v64
    v_dot2c_f32_bf16 v113, v64, v64
    v_mul_f32 v104, 0x3b124925, v104
    v_dot2c_f32_bf16 v112, s67, v65
    v_dot2c_f32_bf16 v113, v65, v65
    v_mul_f32 v105, 0x3b124925, v105
    v_dot2c_f32_bf16 v112, s67, v66
    v_dot2c_f32_bf16 v113, v66, v66
    v_fma_f32 v105, -v104, v104, v105
    v_dot2c_f32_bf16 v112, s67, v67
    v_dot2c_f32_bf16 v113, v67, v67
    v_max_f32 v105, 0, v105
    s_waitcnt vmcnt(4)
    v_dot2c_f32_bf16 v112, s67, v68
    v_add_f32 v106, 0x3727c5ac, v105
    v_dot2c_f32_bf16 v113, v68, v68
    v_dot2c_f32_bf16 v112, s67, v69
    v_rsq_f32 v106, v106
    v_dot2c_f32_bf16 v113, v69, v69
    v_dot2c_f32_bf16 v112, s67, v70
    v_mul_f32 v105, v105, v106
    v_dot2c_f32_bf16 v113, v70, v70
    v_dot2c_f32_bf16 v112, s67, v71
    v_mul_f32 v105, v105, v106
    v_dot2c_f32_bf16 v113, v71, v71
    s_waitcnt vmcnt(3)
    v_add_f32 v105, 0x3727c5ac, v105
    v_dot2c_f32_bf16 v112, s67, v72
    v_dot2c_f32_bf16 v113, v72, v72
    v_rsq_f32 v105, v105
    v_dot2c_f32_bf16 v112, s67, v73
    v_dot2c_f32_bf16 v113, v73, v73
    v_mul_f32 v106, v106, v105
    v_dot2c_f32_bf16 v112, s67, v74
    v_dot2c_f32_bf16 v113, v74, v74
    v_cvt_pk_bf16_f32 v106, v106, 0
    v_dot2c_f32_bf16 v112, s67, v75
    v_dot2c_f32_bf16 v113, v75, v75
    v_lshlrev_b32 v105, 16, v106
    s_waitcnt vmcnt(2)
    v_dot2c_f32_bf16 v112, s67, v76
    v_mul_f32 v107, v104, v105
    v_dot2c_f32_bf16 v113, v76, v76
    v_dot2c_f32_bf16 v112, s67, v77
    v_mov_b32 v104, v106
    v_dot2c_f32_bf16 v113, v77, v77
    v_dot2c_f32_bf16 v112, s67, v78
    v_sub_f32 v106, 0, v107
    v_dot2c_f32_bf16 v113, v78, v78
    v_dot2c_f32_bf16 v112, s67, v79
    v_dot2c_f32_bf16 v113, v79, v79
    s_waitcnt vmcnt(1)
    v_dot2c_f32_bf16 v112, s67, v80
    v_dot2c_f32_bf16 v113, v80, v80
    v_dot2c_f32_bf16 v112, s67, v81
    v_dot2c_f32_bf16 v113, v81, v81
    v_dot2c_f32_bf16 v112, s67, v82
    v_dot2c_f32_bf16 v113, v82, v82
    v_dot2c_f32_bf16 v112, s67, v83
    v_dot2c_f32_bf16 v113, v83, v83
    s_waitcnt vmcnt(0)
    v_dot2c_f32_bf16 v112, s67, v84
    v_dot2c_f32_bf16 v113, v84, v84
    v_dot2c_f32_bf16 v112, s67, v85
    v_dot2c_f32_bf16 v113, v85, v85
    v_dot2c_f32_bf16 v112, s67, v86
    v_dot2c_f32_bf16 v113, v86, v86
    v_dot2c_f32_bf16 v112, s67, v87
    v_dot2c_f32_bf16 v113, v87, v87
    v_dot2_f32_bf16 v120, v32, v104, v106
    v_dot2_f32_bf16 v121, v32, v105, v106
    v_dot2_f32_bf16 v122, v33, v104, v106
    v_add_f32_dpp v112, v112, v112 quad_perm:[1,0,3,2] row_mask:0xf bank_mask:0xf
    v_dot2_f32_bf16 v123, v33, v105, v106
    v_dot2_f32_bf16 v124, v34, v104, v106
    v_dot2_f32_bf16 v125, v34, v105, v106
    v_add_f32_dpp v113, v113, v113 quad_perm:[1,0,3,2] row_mask:0xf bank_mask:0xf
    v_dot2_f32_bf16 v126, v35, v104, v106
    v_dot2_f32_bf16 v127, v35, v105, v106
    v_cvt_pk_bf16_f32 v32, v120, v121
    v_add_f32_dpp v112, v112, v112 quad_perm:[2,3,0,1] row_mask:0xf bank_mask:0xf
    v_cvt_pk_bf16_f32 v33, v122, v123
    v_cvt_pk_bf16_f32 v34, v124, v125
    v_cvt_pk_bf16_f32 v35, v126, v127
    v_add_f32_dpp v113, v113, v113 quad_perm:[2,3,0,1] row_mask:0xf bank_mask:0xf
    ds_write_b128 v6, v[32:35] offset:0
    v_dot2_f32_bf16 v96, v36, v104, v106
    v_dot2_f32_bf16 v97, v36, v105, v106
    v_add_f32_dpp v112, v112, v112 row_half_mirror row_mask:0xf bank_mask:0xf
    v_dot2_f32_bf16 v98, v37, v104, v106
    v_dot2_f32_bf16 v99, v37, v105, v106
    v_dot2_f32_bf16 v100, v38, v104, v106
    v_add_f32_dpp v113, v113, v113 row_half_mirror row_mask:0xf bank_mask:0xf
    v_dot2_f32_bf16 v101, v38, v105, v106
    v_dot2_f32_bf16 v102, v39, v104, v106
    v_dot2_f32_bf16 v103, v39, v105, v106
    v_mul_f32 v112, 0x3b124925, v112
    v_cvt_pk_bf16_f32 v36, v96, v97
    v_cvt_pk_bf16_f32 v37, v98, v99
    v_cvt_pk_bf16_f32 v38, v100, v101
    v_mul_f32 v113, 0x3b124925, v113
    v_cvt_pk_bf16_f32 v39, v102, v103
    ds_write_b128 v6, v[36:39] offset:128
    v_dot2_f32_bf16 v120, v40, v104, v106
    v_fma_f32 v113, -v112, v112, v113
    v_dot2_f32_bf16 v121, v40, v105, v106
    v_dot2_f32_bf16 v122, v41, v104, v106
    v_dot2_f32_bf16 v123, v41, v105, v106
    v_max_f32 v113, 0, v113
    v_dot2_f32_bf16 v124, v42, v104, v106
    v_dot2_f32_bf16 v125, v42, v105, v106
    v_dot2_f32_bf16 v126, v43, v104, v106
    v_add_f32 v114, 0x3727c5ac, v113
    v_dot2_f32_bf16 v127, v43, v105, v106
    v_cvt_pk_bf16_f32 v40, v120, v121
    v_cvt_pk_bf16_f32 v41, v122, v123
    v_rsq_f32 v114, v114
    v_cvt_pk_bf16_f32 v42, v124, v125
    v_cvt_pk_bf16_f32 v43, v126, v127
    ds_write_b128 v6, v[40:43] offset:256
    v_mul_f32 v113, v113, v114
    v_dot2_f32_bf16 v96, v44, v104, v106
    v_dot2_f32_bf16 v97, v44, v105, v106
    v_dot2_f32_bf16 v98, v45, v104, v106
    v_mul_f32 v113, v113, v114
    v_dot2_f32_bf16 v99, v45, v105, v106
    v_dot2_f32_bf16 v100, v46, v104, v106
    v_dot2_f32_bf16 v101, v46, v105, v106
    v_add_f32 v113, 0x3727c5ac, v113
    v_dot2_f32_bf16 v102, v47, v104, v106
    v_dot2_f32_bf16 v103, v47, v105, v106
    v_cvt_pk_bf16_f32 v44, v96, v97
    v_rsq_f32 v113, v113
    v_cvt_pk_bf16_f32 v45, v98, v99
    v_cvt_pk_bf16_f32 v46, v100, v101
    v_cvt_pk_bf16_f32 v47, v102, v103
    v_mul_f32 v114, v114, v113
    ds_write_b128 v6, v[44:47] offset:384
    v_dot2_f32_bf16 v120, v48, v104, v106
    v_dot2_f32_bf16 v121, v48, v105, v106
    v_cvt_pk_bf16_f32 v114, v114, 0
    v_dot2_f32_bf16 v122, v49, v104, v106
    v_dot2_f32_bf16 v123, v49, v105, v106
    v_dot2_f32_bf16 v124, v50, v104, v106
    v_lshlrev_b32 v113, 16, v114
    v_dot2_f32_bf16 v125, v50, v105, v106
    v_dot2_f32_bf16 v126, v51, v104, v106
    v_dot2_f32_bf16 v127, v51, v105, v106
    v_mul_f32 v115, v112, v113
    v_cvt_pk_bf16_f32 v48, v120, v121
    v_cvt_pk_bf16_f32 v49, v122, v123
    v_cvt_pk_bf16_f32 v50, v124, v125
    v_mov_b32 v112, v114
    v_cvt_pk_bf16_f32 v51, v126, v127
    ds_write_b128 v6, v[48:51] offset:512
    v_dot2_f32_bf16 v96, v52, v104, v106
    v_sub_f32 v114, 0, v115
    v_dot2_f32_bf16 v97, v52, v105, v106
    v_dot2_f32_bf16 v98, v53, v104, v106
    v_dot2_f32_bf16 v99, v53, v105, v106
    v_dot2_f32_bf16 v100, v54, v104, v106
    v_dot2_f32_bf16 v101, v54, v105, v106
    v_dot2_f32_bf16 v102, v55, v104, v106
    v_dot2_f32_bf16 v103, v55, v105, v106
    v_cvt_pk_bf16_f32 v52, v96, v97
    v_cvt_pk_bf16_f32 v53, v98, v99
    v_cvt_pk_bf16_f32 v54, v100, v101
    v_cvt_pk_bf16_f32 v55, v102, v103
    ds_write_b128 v6, v[52:55] offset:640
    v_dot2_f32_bf16 v120, v56, v104, v106
    v_dot2_f32_bf16 v121, v56, v105, v106
    v_dot2_f32_bf16 v122, v57, v104, v106
    v_dot2_f32_bf16 v123, v57, v105, v106
    v_dot2_f32_bf16 v124, v58, v104, v106
    v_dot2_f32_bf16 v125, v58, v105, v106
    v_dot2_f32_bf16 v126, v59, v104, v106
    v_dot2_f32_bf16 v127, v59, v105, v106
    v_cvt_pk_bf16_f32 v56, v120, v121
    v_cvt_pk_bf16_f32 v57, v122, v123
    v_cvt_pk_bf16_f32 v58, v124, v125
    v_cvt_pk_bf16_f32 v59, v126, v127
    ds_write_b128 v6, v[56:59] offset:768
    v_dot2_f32_bf16 v120, v60, v112, v114
    v_dot2_f32_bf16 v121, v60, v113, v114
    v_dot2_f32_bf16 v122, v61, v112, v114
    v_dot2_f32_bf16 v123, v61, v113, v114
    v_dot2_f32_bf16 v124, v62, v112, v114
    v_dot2_f32_bf16 v125, v62, v113, v114
    v_dot2_f32_bf16 v126, v63, v112, v114
    v_dot2_f32_bf16 v127, v63, v113, v114
    v_cvt_pk_bf16_f32 v60, v120, v121
    v_cvt_pk_bf16_f32 v61, v122, v123
    v_cvt_pk_bf16_f32 v62, v124, v125
    v_cvt_pk_bf16_f32 v63, v126, v127
    ds_write_b128 v7, v[60:63] offset:0
    v_dot2_f32_bf16 v96, v64, v112, v114
    v_dot2_f32_bf16 v97, v64, v113, v114
    v_dot2_f32_bf16 v98, v65, v112, v114
    v_dot2_f32_bf16 v99, v65, v113, v114
    v_dot2_f32_bf16 v100, v66, v112, v114
    v_dot2_f32_bf16 v101, v66, v113, v114
    v_dot2_f32_bf16 v102, v67, v112, v114
    v_dot2_f32_bf16 v103, v67, v113, v114
    v_cvt_pk_bf16_f32 v64, v96, v97
    v_cvt_pk_bf16_f32 v65, v98, v99
    v_cvt_pk_bf16_f32 v66, v100, v101
    v_cvt_pk_bf16_f32 v67, v102, v103
    ds_write_b128 v7, v[64:67] offset:128
    v_dot2_f32_bf16 v120, v68, v112, v114
    v_dot2_f32_bf16 v121, v68, v113, v114
    v_dot2_f32_bf16 v122, v69, v112, v114
    v_dot2_f32_bf16 v123, v69, v113, v114
    v_dot2_f32_bf16 v124, v70, v112, v114
    v_dot2_f32_bf16 v125, v70, v113, v114
    v_dot2_f32_bf16 v126, v71, v112, v114
    v_dot2_f32_bf16 v127, v71, v113, v114
    v_cvt_pk_bf16_f32 v68, v120, v121
    v_cvt_pk_bf16_f32 v69, v122, v123
    v_cvt_pk_bf16_f32 v70, v124, v125
    v_cvt_pk_bf16_f32 v71, v126, v127
    ds_write_b128 v7, v[68:71] offset:256
    v_dot2_f32_bf16 v96, v72, v112, v114
    v_dot2_f32_bf16 v97, v72, v113, v114
    v_dot2_f32_bf16 v98, v73, v112, v114
    v_dot2_f32_bf16 v99, v73, v113, v114
    v_dot2_f32_bf16 v100, v74, v112, v114
    v_dot2_f32_bf16 v101, v74, v113, v114
    v_dot2_f32_bf16 v102, v75, v112, v114
    v_dot2_f32_bf16 v103, v75, v113, v114
    v_cvt_pk_bf16_f32 v72, v96, v97
    v_cvt_pk_bf16_f32 v73, v98, v99
    v_cvt_pk_bf16_f32 v74, v100, v101
    v_cvt_pk_bf16_f32 v75, v102, v103
    ds_write_b128 v7, v[72:75] offset:384
    v_dot2_f32_bf16 v120, v76, v112, v114
    v_dot2_f32_bf16 v121, v76, v113, v114
    v_dot2_f32_bf16 v122, v77, v112, v114
    v_dot2_f32_bf16 v123, v77, v113, v114
    v_dot2_f32_bf16 v124, v78, v112, v114
    v_dot2_f32_bf16 v125, v78, v113, v114
    v_dot2_f32_bf16 v126, v79, v112, v114
    v_dot2_f32_bf16 v127, v79, v113, v114
    v_cvt_pk_bf16_f32 v76, v120, v121
    v_cvt_pk_bf16_f32 v77, v122, v123
    v_cvt_pk_bf16_f32 v78, v124, v125
    v_cvt_pk_bf16_f32 v79, v126, v127
    ds_write_b128 v7, v[76:79] offset:512
    v_dot2_f32_bf16 v96, v80, v112, v114
    v_dot2_f32_bf16 v97, v80, v113, v114
    v_dot2_f32_bf16 v98, v81, v112, v114
    v_dot2_f32_bf16 v99, v81, v113, v114
    v_dot2_f32_bf16 v100, v82, v112, v114
    v_dot2_f32_bf16 v101, v82, v113, v114
    v_dot2_f32_bf16 v102, v83, v112, v114
    v_dot2_f32_bf16 v103, v83, v113, v114
    v_cvt_pk_bf16_f32 v80, v96, v97
    v_cvt_pk_bf16_f32 v81, v98, v99
    v_cvt_pk_bf16_f32 v82, v100, v101
    v_cvt_pk_bf16_f32 v83, v102, v103
    ds_write_b128 v7, v[80:83] offset:640
    v_dot2_f32_bf16 v120, v84, v112, v114
    v_dot2_f32_bf16 v121, v84, v113, v114
    v_dot2_f32_bf16 v122, v85, v112, v114
    v_dot2_f32_bf16 v123, v85, v113, v114
    v_dot2_f32_bf16 v124, v86, v112, v114
    v_dot2_f32_bf16 v125, v86, v113, v114
    v_dot2_f32_bf16 v126, v87, v112, v114
    v_dot2_f32_bf16 v127, v87, v113, v114
    v_cvt_pk_bf16_f32 v84, v120, v121
    v_cvt_pk_bf16_f32 v85, v122, v123
    v_cvt_pk_bf16_f32 v86, v124, v125
    v_cvt_pk_bf16_f32 v87, v126, v127
    ds_write_b128 v7, v[84:87] offset:768
    s_waitcnt lgkmcnt(0)
    s_barrier
    ds_read_b128 v[32:35], v8 offset:0
    ds_read_b64_tr_b16 v[208:209], v24 offset:8192
    ds_read_b64_tr_b16 v[210:211], v24 offset:8704
    ds_read_b128 v[36:39], v9 offset:0
    ds_read_b64_tr_b16 v[212:213], v24 offset:10240
    ds_read_b64_tr_b16 v[214:215], v24 offset:10752
    ds_read_b128 v[40:43], v10 offset:0
    ds_read_b64_tr_b16 v[216:217], v24 offset:12288
    ds_read_b64_tr_b16 v[218:219], v24 offset:12800
    ds_read_b128 v[44:47], v11 offset:0
    ds_read_b64_tr_b16 v[220:221], v24 offset:14336
    ds_read_b64_tr_b16 v[222:223], v24 offset:14848
    s_waitcnt lgkmcnt(9)
    v_mfma_f32_32x32x16_bf16 v[144:159], v[208:211], v[32:35], 0
    ds_read_b64_tr_b16 v[224:225], v24 offset:16384
    ds_read_b64_tr_b16 v[226:227], v24 offset:16896
    ds_read_b128 v[48:51], v8 offset:128
    ds_read_b128 v[52:55], v9 offset:128
    ds_read_b128 v[56:59], v10 offset:128
    ds_read_b128 v[60:63], v11 offset:128
    ds_read_b128 v[64:67], v8 offset:256
    s_waitcnt lgkmcnt(13)
    v_mfma_f32_32x32x16_bf16 v[144:159], v[212:215], v[36:39], v[144:159]
    ds_read_b64_tr_b16 v[228:229], v24 offset:18432
    ds_read_b64_tr_b16 v[230:231], v24 offset:18944
    ds_read_b128 v[68:71], v9 offset:256
    ds_read_b128 v[72:75], v10 offset:256
    ds_read_b128 v[76:79], v11 offset:256
    ds_read_b128 v[80:83], v8 offset:384
    ds_read_b128 v[84:87], v9 offset:384
    buffer_load_ushort v184, v29, s[4:7], s76 offen offset:0
    buffer_load_ushort v186, v29, s[4:7], s76 offen offset:128
    buffer_load_ushort v188, v29, s[4:7], s76 offen offset:256
    s_waitcnt lgkmcnt(15)
    v_mfma_f32_32x32x16_bf16 v[144:159], v[216:219], v[40:43], v[144:159]
    ds_read_b64_tr_b16 v[208:209], v24 offset:20480
    ds_read_b64_tr_b16 v[210:211], v24 offset:20992
    ds_read_b128 v[88:91], v10 offset:384
    ds_read_b128 v[92:95], v11 offset:384
    ds_read_b128 v[96:99], v8 offset:512
    ds_read_b128 v[100:103], v9 offset:512
    ds_read_b128 v[104:107], v10 offset:512
    s_waitcnt lgkmcnt(15)
    v_mfma_f32_32x32x16_bf16 v[144:159], v[220:223], v[44:47], v[144:159]
    ds_read_b64_tr_b16 v[212:213], v24 offset:22528
    ds_read_b64_tr_b16 v[214:215], v24 offset:23040
    ds_read_b128 v[108:111], v11 offset:512
    ds_read_b128 v[112:115], v8 offset:640
    ds_read_b128 v[116:119], v9 offset:640
    ds_read_b128 v[120:123], v10 offset:640
    ds_read_b128 v[124:127], v11 offset:640
    s_waitcnt lgkmcnt(15)
    v_mfma_f32_32x32x16_bf16 v[144:159], v[224:227], v[48:51], v[144:159]
    ds_read_b128 v[128:131], v8 offset:768
    ds_read_b128 v[132:135], v9 offset:768
    ds_read_b128 v[136:139], v10 offset:768
    ds_read_b128 v[140:143], v11 offset:768
    s_waitcnt lgkmcnt(15)
    v_mfma_f32_32x32x16_bf16 v[144:159], v[228:231], v[52:55], v[144:159]
    s_waitcnt lgkmcnt(15)
    v_mfma_f32_32x32x16_bf16 v[144:159], v[208:211], v[56:59], v[144:159]
    s_waitcnt lgkmcnt(0)
    s_barrier
    ds_read_b64_tr_b16 v[216:217], v24 offset:24576
    ds_read_b64_tr_b16 v[218:219], v24 offset:25088
    ds_read_b64_tr_b16 v[220:221], v24 offset:26624
    ds_read_b64_tr_b16 v[222:223], v24 offset:27136
    ds_read_b64_tr_b16 v[224:225], v24 offset:28672
    ds_read_b64_tr_b16 v[226:227], v24 offset:29184
    s_add_u32 m0, s66, 49152
    s_add_u32 s74, s76, 128
    buffer_load_dwordx4 v4, s[32:35], s74 offen lds
    v_mfma_f32_32x32x16_bf16 v[144:159], v[212:215], v[60:63], v[144:159]
    ds_read_b64_tr_b16 v[228:229], v24 offset:30720
    ds_read_b64_tr_b16 v[230:231], v24 offset:31232
    s_add_u32 m0, s66, 53248
    s_add_u32 s74, s76, 114816
    buffer_load_dwordx4 v4, s[32:35], s74 offen lds
    s_waitcnt lgkmcnt(6)
    v_mfma_f32_32x32x16_bf16 v[144:159], v[216:219], v[64:67], v[144:159]
    ds_read_b64_tr_b16 v[208:209], v24 offset:32768
    ds_read_b64_tr_b16 v[210:211], v24 offset:33280
    s_add_u32 m0, s66, 57344
    s_add_u32 s74, s76, 229504
    buffer_load_dwordx4 v4, s[32:35], s74 offen lds
    s_waitcnt lgkmcnt(6)
    v_mfma_f32_32x32x16_bf16 v[144:159], v[220:223], v[68:71], v[144:159]
    ds_read_b64_tr_b16 v[212:213], v24 offset:34816
    ds_read_b64_tr_b16 v[214:215], v24 offset:35328
    s_add_u32 m0, s66, 61440
    s_add_u32 s74, s76, 344192
    buffer_load_dwordx4 v4, s[32:35], s74 offen lds
    s_waitcnt lgkmcnt(6)
    v_mfma_f32_32x32x16_bf16 v[144:159], v[224:227], v[72:75], v[144:159]
    ds_read_b64_tr_b16 v[216:217], v24 offset:36864
    ds_read_b64_tr_b16 v[218:219], v24 offset:37376
    s_waitcnt lgkmcnt(6)
    v_mfma_f32_32x32x16_bf16 v[144:159], v[228:231], v[76:79], v[144:159]
    ds_read_b64_tr_b16 v[220:221], v24 offset:38912
    ds_read_b64_tr_b16 v[222:223], v24 offset:39424
    s_add_u32 m0, s66, 65536
    s_add_u32 s74, s76, 458880
    buffer_load_dwordx4 v4, s[32:35], s74 offen lds
    s_waitcnt lgkmcnt(6)
    v_mfma_f32_32x32x16_bf16 v[144:159], v[208:211], v[80:83], v[144:159]
    ds_read_b64_tr_b16 v[224:225], v24 offset:40960
    ds_read_b64_tr_b16 v[226:227], v24 offset:41472
    s_add_u32 m0, s66, 69632
    s_add_u32 s74, s76, 573568
    buffer_load_dwordx4 v4, s[32:35], s74 offen lds
    s_waitcnt lgkmcnt(6)
    v_mfma_f32_32x32x16_bf16 v[144:159], v[212:215], v[84:87], v[144:159]
    ds_read_b64_tr_b16 v[228:229], v24 offset:43008
    ds_read_b64_tr_b16 v[230:231], v24 offset:43520
    s_add_u32 m0, s66, 73728
    s_add_u32 s74, s76, 688256
    buffer_load_dwordx4 v4, s[32:35], s74 offen lds
    s_waitcnt lgkmcnt(6)
    v_mfma_f32_32x32x16_bf16 v[144:159], v[216:219], v[88:91], v[144:159]
    ds_read_b64_tr_b16 v[208:209], v24 offset:45056
    ds_read_b64_tr_b16 v[210:211], v24 offset:45568
    s_waitcnt lgkmcnt(6)
    v_mfma_f32_32x32x16_bf16 v[144:159], v[220:223], v[92:95], v[144:159]
    ds_read_b64_tr_b16 v[212:213], v24 offset:47104
    ds_read_b64_tr_b16 v[214:215], v24 offset:47616
    s_add_u32 m0, s66, 77824
    s_add_u32 s74, s76, 802944
    buffer_load_dwordx4 v4, s[32:35], s74 offen lds
    s_waitcnt lgkmcnt(6)
    v_mfma_f32_32x32x16_bf16 v[144:159], v[224:227], v[96:99], v[144:159]
    ds_read_b64_tr_b16 v[216:217], v24 offset:49152
    ds_read_b64_tr_b16 v[218:219], v24 offset:49664
    s_add_u32 m0, s66, 81920
    s_add_u32 s74, s76, 917632
    buffer_load_dwordx4 v4, s[32:35], s74 offen lds
    s_waitcnt lgkmcnt(6)
    v_mfma_f32_32x32x16_bf16 v[144:159], v[228:231], v[100:103], v[144:159]
    ds_read_b64_tr_b16 v[220:221], v24 offset:51200
    ds_read_b64_tr_b16 v[222:223], v24 offset:51712
    s_add_u32 m0, s66, 86016
    s_add_u32 s74, s76, 1032320
    buffer_load_dwordx4 v4, s[32:35], s74 offen lds
    s_waitcnt lgkmcnt(6)
    v_mfma_f32_32x32x16_bf16 v[144:159], v[208:211], v[104:107], v[144:159]
    ds_read_b64_tr_b16 v[224:225], v24 offset:53248
    ds_read_b64_tr_b16 v[226:227], v24 offset:53760
    s_add_u32 m0, s66, 90112
    s_add_u32 s74, s76, 1147008
    buffer_load_dwordx4 v4, s[32:35], s74 offen lds
    s_waitcnt lgkmcnt(6)
    v_mfma_f32_32x32x16_bf16 v[144:159], v[212:215], v[108:111], v[144:159]
    s_waitcnt vmcnt(9)
    s_barrier
    ds_read_b64_tr_b16 v[228:229], v24 offset:55296
    ds_read_b64_tr_b16 v[230:231], v24 offset:55808
    s_waitcnt lgkmcnt(6)
    v_mfma_f32_32x32x16_bf16 v[144:159], v[216:219], v[112:115], v[144:159]
    ds_read_b64_tr_b16 v[208:209], v24 offset:0
    ds_read_b64_tr_b16 v[210:211], v24 offset:512
    s_add_u32 m0, s66, 94208
    s_add_u32 s74, s76, 1261696
    buffer_load_dwordx4 v4, s[32:35], s74 offen lds
    s_waitcnt lgkmcnt(6)
    v_mfma_f32_32x32x16_bf16 v[144:159], v[220:223], v[116:119], v[144:159]
    ds_read_b64_tr_b16 v[212:213], v24 offset:2048
    ds_read_b64_tr_b16 v[214:215], v24 offset:2560
    s_add_u32 m0, s66, 98304
    s_add_u32 s74, s76, 1376384
    buffer_load_dwordx4 v4, s[32:35], s74 offen lds
    s_waitcnt lgkmcnt(6)
    v_mfma_f32_32x32x16_bf16 v[144:159], v[224:227], v[120:123], v[144:159]
    ds_read_b64_tr_b16 v[216:217], v24 offset:4096
    ds_read_b64_tr_b16 v[218:219], v24 offset:4608
    s_add_u32 m0, s66, 102400
    s_add_u32 s74, s76, 1491072
    buffer_load_dwordx4 v4, s[32:35], s74 offen lds
    s_waitcnt lgkmcnt(6)
    v_mfma_f32_32x32x16_bf16 v[144:159], v[228:231], v[124:127], v[144:159]
    ds_read_b64_tr_b16 v[220:221], v24 offset:6144
    ds_read_b64_tr_b16 v[222:223], v24 offset:6656
    s_waitcnt lgkmcnt(6)
    v_mfma_f32_32x32x16_bf16 v[144:159], v[208:211], v[128:131], v[144:159]
    ds_read_b64_tr_b16 v[224:225], v25 offset:0
    ds_read_b64_tr_b16 v[226:227], v25 offset:512
    s_waitcnt lgkmcnt(6)
    v_mfma_f32_32x32x16_bf16 v[144:159], v[212:215], v[132:135], v[144:159]
    ds_read_b64_tr_b16 v[228:229], v25 offset:2048
    ds_read_b64_tr_b16 v[230:231], v25 offset:2560
    s_waitcnt lgkmcnt(6)
    v_mfma_f32_32x32x16_bf16 v[144:159], v[216:219], v[136:139], v[144:159]
    v_mfma_f32_32x32x16_bf16 v[144:159], v[184:187], v[176:179], v[144:159]
    ds_read_b64_tr_b16 v[208:209], v25 offset:4096
    ds_read_b64_tr_b16 v[210:211], v25 offset:4608
    s_waitcnt lgkmcnt(6)
    v_mfma_f32_32x32x16_bf16 v[144:159], v[220:223], v[140:143], v[144:159]
    ds_read_b64_tr_b16 v[212:213], v25 offset:6144
    ds_read_b64_tr_b16 v[214:215], v25 offset:6656
    s_waitcnt lgkmcnt(6)
    v_mfma_f32_32x32x16_bf16 v[160:175], v[224:227], v[32:35], 0
    s_waitcnt vmcnt(6)
    s_barrier
    ds_read_b64_tr_b16 v[216:217], v25 offset:8192
    ds_read_b64_tr_b16 v[218:219], v25 offset:8704
    s_add_u32 m0, s66, 131072
    s_add_u32 s74, s76, 459008
    buffer_load_dwordx4 v4, s[32:35], s74 offen lds
    s_waitcnt lgkmcnt(6)
    v_mfma_f32_32x32x16_bf16 v[160:175], v[228:231], v[36:39], v[160:175]
    ds_read_b64_tr_b16 v[220:221], v25 offset:10240
    ds_read_b64_tr_b16 v[222:223], v25 offset:10752
    s_add_u32 m0, s66, 135168
    s_add_u32 s74, s76, 573696
    buffer_load_dwordx4 v4, s[32:35], s74 offen lds
    v_mul_f32 v232, v144, v144
    v_fma_f32 v232, v232, s68, v27
    v_mul_f32 v233, v145, v145
    v_mul_f32 v232, v232, v144
    v_fma_f32 v233, v233, s68, v27
    s_waitcnt lgkmcnt(6)
    v_mfma_f32_32x32x16_bf16 v[160:175], v[208:211], v[40:43], v[160:175]
    ds_read_b64_tr_b16 v[224:225], v25 offset:12288
    ds_read_b64_tr_b16 v[226:227], v25 offset:12800
    s_add_u32 m0, s66, 139264
    s_add_u32 s74, s76, 688384
    buffer_load_dwordx4 v4, s[32:35], s74 offen lds
    v_mul_f32 v234, v146, v146
    v_exp_f32 v232, v232
    v_mul_f32 v233, v233, v145
    v_fma_f32 v234, v234, s68, v27
    v_mul_f32 v235, v147, v147
    s_waitcnt lgkmcnt(6)
    v_mfma_f32_32x32x16_bf16 v[160:175], v[212:215], v[44:47], v[160:175]
    ds_read_b64_tr_b16 v[228:229], v25 offset:14336
    ds_read_b64_tr_b16 v[230:231], v25 offset:14848
    s_add_u32 m0, s66, 143360
    s_add_u32 s74, s76, 803072
    buffer_load_dwordx4 v4, s[32:35], s74 offen lds
    v_exp_f32 v233, v233
    v_add_f32 v232, 1.0, v232
    v_mul_f32 v234, v234, v146
    v_fma_f32 v235, v235, s68, v27
    v_mul_f32 v236, v148, v148
    s_waitcnt lgkmcnt(6)
    v_mfma_f32_32x32x16_bf16 v[160:175], v[216:219], v[48:51], v[160:175]
    ds_read_b64_tr_b16 v[208:209], v25 offset:16384
    ds_read_b64_tr_b16 v[210:211], v25 offset:16896
    s_add_u32 m0, s66, 147456
    s_add_u32 s74, s76, 917760
    buffer_load_dwordx4 v4, s[32:35], s74 offen lds
    v_exp_f32 v234, v234
    v_add_f32 v233, 1.0, v233
    v_mul_f32 v235, v235, v147
    v_rcp_f32 v232, v232
    s_waitcnt lgkmcnt(6)
    v_mfma_f32_32x32x16_bf16 v[160:175], v[220:223], v[52:55], v[160:175]
    ds_read_b64_tr_b16 v[212:213], v25 offset:18432
    ds_read_b64_tr_b16 v[214:215], v25 offset:18944
    s_add_u32 m0, s66, 151552
    s_add_u32 s74, s76, 1032448
    buffer_load_dwordx4 v4, s[32:35], s74 offen lds
    v_fma_f32 v236, v236, s68, v27
    v_mul_f32 v237, v149, v149
    v_mul_f32 v232, v144, v232
    v_exp_f32 v235, v235
    v_add_f32 v234, 1.0, v234
    s_waitcnt lgkmcnt(6)
    v_mfma_f32_32x32x16_bf16 v[160:175], v[224:227], v[56:59], v[160:175]
    ds_read_b64_tr_b16 v[216:217], v25 offset:20480
    ds_read_b64_tr_b16 v[218:219], v25 offset:20992
    s_add_u32 m0, s66, 155648
    s_add_u32 s74, s76, 1147136
    buffer_load_dwordx4 v4, s[32:35], s74 offen lds
    v_mul_f32 v236, v236, v148
    v_rcp_f32 v233, v233
    v_fma_f32 v237, v237, s68, v27
    v_mul_f32 v238, v150, v150
    v_mul_f32 v233, v145, v233
    s_waitcnt lgkmcnt(6)
    v_mfma_f32_32x32x16_bf16 v[160:175], v[228:231], v[60:63], v[160:175]
    ds_read_b64_tr_b16 v[220:221], v25 offset:22528
    ds_read_b64_tr_b16 v[222:223], v25 offset:23040
    s_add_u32 m0, s66, 159744
    s_add_u32 s74, s76, 1261824
    buffer_load_dwordx4 v4, s[32:35], s74 offen lds
    v_exp_f32 v236, v236
    v_add_f32 v235, 1.0, v235
    v_mul_f32 v237, v237, v149
    v_rcp_f32 v234, v234
    s_waitcnt lgkmcnt(6)
    v_mfma_f32_32x32x16_bf16 v[160:175], v[208:211], v[64:67], v[160:175]
    ds_read_b64_tr_b16 v[224:225], v25 offset:24576
    ds_read_b64_tr_b16 v[226:227], v25 offset:25088
    s_add_u32 m0, s66, 106496
    s_add_u32 s74, s76, 1376512
    buffer_load_dwordx4 v4, s[32:35], s74 offen lds
    v_fma_f32 v238, v238, s68, v27
    v_mul_f32 v239, v151, v151
    v_cvt_pk_bf16_f32 v240, v232, v233
    v_mul_f32 v234, v146, v234
    v_exp_f32 v237, v237
    s_waitcnt lgkmcnt(6)
    v_mfma_f32_32x32x16_bf16 v[160:175], v[212:215], v[68:71], v[160:175]
    ds_read_b64_tr_b16 v[228:229], v25 offset:26624
    ds_read_b64_tr_b16 v[230:231], v25 offset:27136
    s_add_u32 m0, s66, 110592
    s_add_u32 s74, s76, 1491200
    buffer_load_dwordx4 v4, s[32:35], s74 offen lds
    v_add_f32 v236, 1.0, v236
    v_mul_f32 v238, v238, v150
    v_rcp_f32 v235, v235
    v_fma_f32 v239, v239, s68, v27
    v_mul_f32 v248, v152, v152
    s_waitcnt lgkmcnt(6)
    v_mfma_f32_32x32x16_bf16 v[160:175], v[216:219], v[72:75], v[160:175]
    s_waitcnt vmcnt(10)
    s_barrier
    ds_read_b64_tr_b16 v[208:209], v25 offset:28672
    ds_read_b64_tr_b16 v[210:211], v25 offset:29184
    v_mul_f32 v235, v147, v235
    v_exp_f32 v238, v238
    v_add_f32 v237, 1.0, v237
    v_mul_f32 v239, v239, v151
    s_waitcnt lgkmcnt(6)
    v_mfma_f32_32x32x16_bf16 v[160:175], v[220:223], v[76:79], v[160:175]
    ds_read_b64_tr_b16 v[212:213], v25 offset:30720
    ds_read_b64_tr_b16 v[214:215], v25 offset:31232
    v_rcp_f32 v236, v236
    v_fma_f32 v248, v248, s68, v27
    v_mul_f32 v249, v153, v153
    v_cvt_pk_bf16_f32 v241, v234, v235
    v_mul_f32 v236, v148, v236
    s_waitcnt lgkmcnt(6)
    v_mfma_f32_32x32x16_bf16 v[160:175], v[224:227], v[80:83], v[160:175]
    ds_read_b64_tr_b16 v[216:217], v25 offset:32768
    ds_read_b64_tr_b16 v[218:219], v25 offset:33280
    v_exp_f32 v239, v239
    v_add_f32 v238, 1.0, v238
    v_mul_f32 v248, v248, v152
    v_rcp_f32 v237, v237
    v_fma_f32 v249, v249, s68, v27
    s_waitcnt lgkmcnt(6)
    v_mfma_f32_32x32x16_bf16 v[160:175], v[228:231], v[84:87], v[160:175]
    ds_read_b64_tr_b16 v[220:221], v25 offset:34816
    ds_read_b64_tr_b16 v[222:223], v25 offset:35328
    v_mul_f32 v232, v154, v154
    v_mul_f32 v237, v149, v237
    v_exp_f32 v248, v248
    v_add_f32 v239, 1.0, v239
    s_waitcnt lgkmcnt(6)
    v_mfma_f32_32x32x16_bf16 v[160:175], v[208:211], v[88:91], v[160:175]
    ds_read_b64_tr_b16 v[224:225], v25 offset:36864
    ds_read_b64_tr_b16 v[226:227], v25 offset:37376
    s_add_u32 m0, s66, 40960
    s_add_u32 s74, s65, 1433600
    buffer_load_dwordx4 v31, s[44:47], s74 offen lds
    v_mul_f32 v249, v249, v153
    v_rcp_f32 v238, v238
    v_fma_f32 v232, v232, s68, v27
    v_mul_f32 v233, v155, v155
    v_cvt_pk_bf16_f32 v242, v236, v237
    s_waitcnt lgkmcnt(6)
    v_mfma_f32_32x32x16_bf16 v[160:175], v[212:215], v[92:95], v[160:175]
    ds_read_b64_tr_b16 v[228:229], v25 offset:38912
    ds_read_b64_tr_b16 v[230:231], v25 offset:39424
    v_mul_f32 v238, v150, v238
    v_exp_f32 v249, v249
    v_add_f32 v248, 1.0, v248
    v_mul_f32 v232, v232, v154
    v_rcp_f32 v239, v239
    s_waitcnt lgkmcnt(6)
    v_mfma_f32_32x32x16_bf16 v[160:175], v[216:219], v[96:99], v[160:175]
    ds_read_b64_tr_b16 v[208:209], v25 offset:40960
    ds_read_b64_tr_b16 v[210:211], v25 offset:41472
    v_fma_f32 v233, v233, s68, v27
    v_mul_f32 v234, v156, v156
    v_mul_f32 v239, v151, v239
    v_exp_f32 v232, v232
    v_add_f32 v249, 1.0, v249
    s_waitcnt lgkmcnt(6)
    v_mfma_f32_32x32x16_bf16 v[160:175], v[220:223], v[100:103], v[160:175]
    ds_read_b64_tr_b16 v[212:213], v25 offset:43008
    ds_read_b64_tr_b16 v[214:215], v25 offset:43520
    s_add_u32 m0, s66, 45056
    s_add_u32 s74, s65, 1462272
    buffer_load_dwordx4 v31, s[44:47], s74 offen lds
    v_mul_f32 v233, v233, v155
    v_rcp_f32 v248, v248
    v_fma_f32 v234, v234, s68, v27
    v_mul_f32 v235, v157, v157
    s_waitcnt lgkmcnt(6)
    v_mfma_f32_32x32x16_bf16 v[160:175], v[224:227], v[104:107], v[160:175]
    ds_read_b64_tr_b16 v[216:217], v25 offset:45056
    ds_read_b64_tr_b16 v[218:219], v25 offset:45568
    v_cvt_pk_bf16_f32 v243, v238, v239
    s_add_u32 s75, s79, 0
    buffer_store_dwordx4 v[240:243], v2, s[36:39], s75 offen sc1
    v_mul_f32 v248, v152, v248
    v_exp_f32 v233, v233
    v_add_f32 v232, 1.0, v232
    s_waitcnt lgkmcnt(6)
    v_mfma_f32_32x32x16_bf16 v[160:175], v[228:231], v[108:111], v[160:175]
    ds_read_b64_tr_b16 v[220:221], v25 offset:47104
    ds_read_b64_tr_b16 v[222:223], v25 offset:47616
    v_mul_f32 v234, v234, v156
    v_rcp_f32 v249, v249
    v_fma_f32 v235, v235, s68, v27
    v_mul_f32 v236, v158, v158
    v_mul_f32 v249, v153, v249
    s_waitcnt lgkmcnt(6)
    v_mfma_f32_32x32x16_bf16 v[160:175], v[208:211], v[112:115], v[160:175]
    ds_read_b64_tr_b16 v[224:225], v25 offset:49152
    ds_read_b64_tr_b16 v[226:227], v25 offset:49664
    v_exp_f32 v234, v234
    v_add_f32 v233, 1.0, v233
    v_mul_f32 v235, v235, v157
    v_rcp_f32 v232, v232
    s_waitcnt lgkmcnt(6)
    v_mfma_f32_32x32x16_bf16 v[160:175], v[212:215], v[116:119], v[160:175]
    ds_read_b64_tr_b16 v[228:229], v25 offset:51200
    ds_read_b64_tr_b16 v[230:231], v25 offset:51712
    v_fma_f32 v236, v236, s68, v27
    v_mul_f32 v237, v159, v159
    v_cvt_pk_bf16_f32 v244, v248, v249
    v_mul_f32 v232, v154, v232
    v_exp_f32 v235, v235
    s_waitcnt lgkmcnt(6)
    v_mfma_f32_32x32x16_bf16 v[160:175], v[216:219], v[120:123], v[160:175]
    ds_read_b64_tr_b16 v[208:209], v25 offset:53248
    ds_read_b64_tr_b16 v[210:211], v25 offset:53760
    v_add_f32 v234, 1.0, v234
    v_mul_f32 v236, v236, v158
    v_rcp_f32 v233, v233
    v_fma_f32 v237, v237, s68, v27
    v_mul_f32 v233, v155, v233
    s_waitcnt lgkmcnt(6)
    v_mfma_f32_32x32x16_bf16 v[160:175], v[220:223], v[124:127], v[160:175]
    s_waitcnt vmcnt(3)
    s_barrier
    ds_read_b64_tr_b16 v[212:213], v25 offset:55296
    ds_read_b64_tr_b16 v[214:215], v25 offset:55808
    v_exp_f32 v236, v236
    v_add_f32 v235, 1.0, v235
    v_mul_f32 v237, v237, v159
    v_rcp_f32 v234, v234
    s_waitcnt lgkmcnt(6)
    v_mfma_f32_32x32x16_bf16 v[160:175], v[224:227], v[128:131], v[160:175]
    ds_read_b64_tr_b16 v[216:217], v24 offset:8192
    ds_read_b64_tr_b16 v[218:219], v24 offset:8704
    v_mul_u32_u24 v251, 7, v255
    s_and_b32 s75, s64, 3
    s_lshl_b32 s75, s75, 3
    s_add_u32 s75, s75, s60
    s_lshl_b32 s74, s75, 5
    s_cmp_ge_u32 s75, 12
    s_cselect_b32 s73, 256, 0
    s_add_u32 s74, s74, s73
    s_cmp_ge_u32 s75, 22
    s_cselect_b32 s73, 256, 0
    s_add_u32 s74, s74, s73
    s_mul_i32 s74, s74, 896
    s_add_u32 s74, s74, s65
    s_mov_b64 exec, 0xffffffff
    buffer_load_dword v254, v251, s[44:47], s74 offen sc1
    s_mul_i32 s74, s75, 7168
    s_add_u32 s74, s74, s65
    s_mov_b64 exec, 0xff
    buffer_load_dword v254, v251, s[48:51], s74 offen sc1
    s_mov_b64 exec, -1
    v_cvt_pk_bf16_f32 v245, v232, v233
    v_mul_f32 v234, v156, v234
    v_exp_f32 v237, v237
    v_add_f32 v236, 1.0, v236
    v_rcp_f32 v235, v235
    s_waitcnt lgkmcnt(6)
    v_mfma_f32_32x32x16_bf16 v[160:175], v[228:231], v[132:135], v[160:175]
    ds_read_b64_tr_b16 v[220:221], v24 offset:10240
    ds_read_b64_tr_b16 v[222:223], v24 offset:10752
    v_mul_f32 v235, v157, v235
    v_add_f32 v237, 1.0, v237
    v_rcp_f32 v236, v236
    v_cvt_pk_bf16_f32 v246, v234, v235
    v_mul_f32 v236, v158, v236
    s_waitcnt lgkmcnt(6)
    v_mfma_f32_32x32x16_bf16 v[160:175], v[208:211], v[136:139], v[160:175]
    v_mfma_f32_32x32x16_bf16 v[160:175], v[186:189], v[176:179], v[160:175]
    ds_read_b64_tr_b16 v[224:225], v24 offset:12288
    ds_read_b64_tr_b16 v[226:227], v24 offset:12800
    v_rcp_f32 v237, v237
    s_nop 0
    v_mul_f32 v237, v159, v237
    v_cvt_pk_bf16_f32 v247, v236, v237
    s_add_u32 s75, s79, 1024
    buffer_store_dwordx4 v[244:247], v2, s[36:39], s75 offen sc1
    s_waitcnt lgkmcnt(6)
    v_mfma_f32_32x32x16_bf16 v[160:175], v[212:215], v[140:143], v[160:175]
    ds_read_b64_tr_b16 v[228:229], v24 offset:14336
    ds_read_b64_tr_b16 v[230:231], v24 offset:14848
    s_waitcnt lgkmcnt(6)
    v_mfma_f32_32x32x16_bf16 v[144:159], v[216:219], v[32:35], 0
    ds_read_b64_tr_b16 v[208:209], v24 offset:16384
    ds_read_b64_tr_b16 v[210:211], v24 offset:16896
    s_waitcnt lgkmcnt(6)
    v_mfma_f32_32x32x16_bf16 v[144:159], v[220:223], v[36:39], v[144:159]
    s_barrier
    ds_read_b64_tr_b16 v[212:213], v24 offset:18432
    ds_read_b64_tr_b16 v[214:215], v24 offset:18944
    s_add_u32 m0, s66, 8192
    s_add_u32 s74, s65, 401408
    buffer_load_dwordx4 v31, s[44:47], s74 offen lds
    v_mul_f32 v232, v160, v160
    v_fma_f32 v232, v232, s68, v27
    v_mul_f32 v233, v161, v161
    v_mul_f32 v232, v232, v160
    v_fma_f32 v233, v233, s68, v27
    s_waitcnt lgkmcnt(6)
    v_mfma_f32_32x32x16_bf16 v[144:159], v[224:227], v[40:43], v[144:159]
    ds_read_b64_tr_b16 v[216:217], v24 offset:20480
    ds_read_b64_tr_b16 v[218:219], v24 offset:20992
    v_mul_f32 v234, v162, v162
    v_exp_f32 v232, v232
    v_mul_f32 v233, v233, v161
    v_fma_f32 v234, v234, s68, v27
    v_mul_f32 v235, v163, v163
    s_waitcnt lgkmcnt(6)
    v_mfma_f32_32x32x16_bf16 v[144:159], v[228:231], v[44:47], v[144:159]
    ds_read_b64_tr_b16 v[220:221], v24 offset:22528
    ds_read_b64_tr_b16 v[222:223], v24 offset:23040
    v_exp_f32 v233, v233
    v_add_f32 v232, 1.0, v232
    v_mul_f32 v234, v234, v162
    v_fma_f32 v235, v235, s68, v27
    v_mul_f32 v236, v164, v164
    s_waitcnt lgkmcnt(6)
    v_mfma_f32_32x32x16_bf16 v[144:159], v[208:211], v[48:51], v[144:159]
    ds_read_b64_tr_b16 v[224:225], v24 offset:24576
    ds_read_b64_tr_b16 v[226:227], v24 offset:25088
    s_add_u32 m0, s66, 12288
    s_add_u32 s74, s65, 430080
    buffer_load_dwordx4 v31, s[44:47], s74 offen lds
    v_exp_f32 v234, v234
    v_add_f32 v233, 1.0, v233
    v_mul_f32 v235, v235, v163
    v_rcp_f32 v232, v232
    s_waitcnt lgkmcnt(6)
    v_mfma_f32_32x32x16_bf16 v[144:159], v[212:215], v[52:55], v[144:159]
    ds_read_b64_tr_b16 v[228:229], v24 offset:26624
    ds_read_b64_tr_b16 v[230:231], v24 offset:27136
    v_fma_f32 v236, v236, s68, v27
    v_mul_f32 v237, v165, v165
    v_mul_f32 v232, v160, v232
    v_exp_f32 v235, v235
    v_add_f32 v234, 1.0, v234
    s_waitcnt lgkmcnt(6)
    v_mfma_f32_32x32x16_bf16 v[144:159], v[216:219], v[56:59], v[144:159]
    ds_read_b64_tr_b16 v[208:209], v24 offset:28672
    ds_read_b64_tr_b16 v[210:211], v24 offset:29184
    v_mul_f32 v236, v236, v164
    v_rcp_f32 v233, v233
    v_fma_f32 v237, v237, s68, v27
    v_mul_f32 v238, v166, v166
    v_mul_f32 v233, v161, v233
    s_waitcnt lgkmcnt(6)
    v_mfma_f32_32x32x16_bf16 v[144:159], v[220:223], v[60:63], v[144:159]
    ds_read_b64_tr_b16 v[212:213], v24 offset:30720
    ds_read_b64_tr_b16 v[214:215], v24 offset:31232
    s_add_u32 m0, s66, 16384
    s_add_u32 s74, s65, 860160
    buffer_load_dwordx4 v31, s[44:47], s74 offen lds
    v_exp_f32 v236, v236
    v_add_f32 v235, 1.0, v235
    v_mul_f32 v237, v237, v165
    v_rcp_f32 v234, v234
    s_waitcnt lgkmcnt(6)
    v_mfma_f32_32x32x16_bf16 v[144:159], v[224:227], v[64:67], v[144:159]
    ds_read_b64_tr_b16 v[216:217], v24 offset:32768
    ds_read_b64_tr_b16 v[218:219], v24 offset:33280
    v_fma_f32 v238, v238, s68, v27
    v_mul_f32 v239, v167, v167
    v_cvt_pk_bf16_f32 v240, v232, v233
    v_mul_f32 v234, v162, v234
    v_exp_f32 v237, v237
    s_waitcnt lgkmcnt(6)
    v_mfma_f32_32x32x16_bf16 v[144:159], v[228:231], v[68:71], v[144:159]
    ds_read_b64_tr_b16 v[220:221], v24 offset:34816
    ds_read_b64_tr_b16 v[222:223], v24 offset:35328
    v_add_f32 v236, 1.0, v236
    v_mul_f32 v238, v238, v166
    v_rcp_f32 v235, v235
    v_fma_f32 v239, v239, s68, v27
    v_mul_f32 v248, v168, v168
    s_waitcnt lgkmcnt(6)
    v_mfma_f32_32x32x16_bf16 v[144:159], v[208:211], v[72:75], v[144:159]
    ds_read_b64_tr_b16 v[224:225], v24 offset:36864
    ds_read_b64_tr_b16 v[226:227], v24 offset:37376
    s_add_u32 m0, s66, 20480
    s_add_u32 s74, s65, 888832
    buffer_load_dwordx4 v31, s[44:47], s74 offen lds
    v_mul_f32 v235, v163, v235
    v_exp_f32 v238, v238
    v_add_f32 v237, 1.0, v237
    v_mul_f32 v239, v239, v167
    s_waitcnt lgkmcnt(6)
    v_mfma_f32_32x32x16_bf16 v[144:159], v[212:215], v[76:79], v[144:159]
    ds_read_b64_tr_b16 v[228:229], v24 offset:38912
    ds_read_b64_tr_b16 v[230:231], v24 offset:39424
    v_rcp_f32 v236, v236
    v_fma_f32 v248, v248, s68, v27
    v_mul_f32 v249, v169, v169
    v_cvt_pk_bf16_f32 v241, v234, v235
    v_mul_f32 v236, v164, v236
    s_waitcnt lgkmcnt(6)
    v_mfma_f32_32x32x16_bf16 v[144:159], v[216:219], v[80:83], v[144:159]
    ds_read_b64_tr_b16 v[208:209], v24 offset:40960
    ds_read_b64_tr_b16 v[210:211], v24 offset:41472
    v_exp_f32 v239, v239
    v_add_f32 v238, 1.0, v238
    v_mul_f32 v248, v248, v168
    v_rcp_f32 v237, v237
    v_fma_f32 v249, v249, s68, v27
    s_waitcnt lgkmcnt(6)
    v_mfma_f32_32x32x16_bf16 v[144:159], v[220:223], v[84:87], v[144:159]
    ds_read_b64_tr_b16 v[212:213], v24 offset:43008
    ds_read_b64_tr_b16 v[214:215], v24 offset:43520
    s_add_u32 m0, s66, 24576
    s_add_u32 s74, s65, 917504
    buffer_load_dwordx4 v31, s[44:47], s74 offen lds
    v_mul_f32 v232, v170, v170
    v_mul_f32 v237, v165, v237
    v_exp_f32 v248, v248
    v_add_f32 v239, 1.0, v239
    s_waitcnt lgkmcnt(6)
    v_mfma_f32_32x32x16_bf16 v[144:159], v[224:227], v[88:91], v[144:159]
    ds_read_b64_tr_b16 v[216:217], v24 offset:45056
    ds_read_b64_tr_b16 v[218:219], v24 offset:45568
    v_mul_f32 v249, v249, v169
    v_rcp_f32 v238, v238
    v_fma_f32 v232, v232, s68, v27
    v_mul_f32 v233, v171, v171
    v_cvt_pk_bf16_f32 v242, v236, v237
    s_waitcnt lgkmcnt(6)
    v_mfma_f32_32x32x16_bf16 v[144:159], v[228:231], v[92:95], v[144:159]
    ds_read_b64_tr_b16 v[220:221], v24 offset:47104
    ds_read_b64_tr_b16 v[222:223], v24 offset:47616
    v_mul_f32 v238, v166, v238
    v_exp_f32 v249, v249
    v_add_f32 v248, 1.0, v248
    v_mul_f32 v232, v232, v170
    v_rcp_f32 v239, v239
    s_waitcnt lgkmcnt(6)
    v_mfma_f32_32x32x16_bf16 v[144:159], v[208:211], v[96:99], v[144:159]
    ds_read_b64_tr_b16 v[224:225], v24 offset:49152
    ds_read_b64_tr_b16 v[226:227], v24 offset:49664
    s_add_u32 m0, s66, 28672
    s_add_u32 s74, s65, 946176
    buffer_load_dwordx4 v31, s[44:47], s74 offen lds
    v_fma_f32 v233, v233, s68, v27
    v_mul_f32 v234, v172, v172
    v_mul_f32 v239, v167, v239
    v_exp_f32 v232, v232
    v_add_f32 v249, 1.0, v249
    s_waitcnt lgkmcnt(6)
    v_mfma_f32_32x32x16_bf16 v[144:159], v[212:215], v[100:103], v[144:159]
    ds_read_b64_tr_b16 v[228:229], v24 offset:51200
    ds_read_b64_tr_b16 v[230:231], v24 offset:51712
    v_mul_f32 v233, v233, v171
    v_rcp_f32 v248, v248
    v_fma_f32 v234, v234, s68, v27
    v_mul_f32 v235, v173, v173
    s_waitcnt lgkmcnt(6)
    v_mfma_f32_32x32x16_bf16 v[144:159], v[216:219], v[104:107], v[144:159]
    ds_read_b64_tr_b16 v[208:209], v24 offset:53248
    ds_read_b64_tr_b16 v[210:211], v24 offset:53760
    v_cvt_pk_bf16_f32 v243, v238, v239
    s_add_u32 s75, s79, 4096
    buffer_store_dwordx4 v[240:243], v2, s[36:39], s75 offen sc1
    v_mul_f32 v248, v168, v248
    v_exp_f32 v233, v233
    v_add_f32 v232, 1.0, v232
    s_waitcnt lgkmcnt(6)
    v_mfma_f32_32x32x16_bf16 v[144:159], v[220:223], v[108:111], v[144:159]
    ds_read_b64_tr_b16 v[212:213], v24 offset:55296
    ds_read_b64_tr_b16 v[214:215], v24 offset:55808
    v_mul_f32 v234, v234, v172
    v_rcp_f32 v249, v249
    v_fma_f32 v235, v235, s68, v27
    v_mul_f32 v236, v174, v174
    v_mul_f32 v249, v169, v249
    s_waitcnt lgkmcnt(6)
    v_mfma_f32_32x32x16_bf16 v[144:159], v[224:227], v[112:115], v[144:159]
    ds_read_b64_tr_b16 v[216:217], v24 offset:0
    ds_read_b64_tr_b16 v[218:219], v24 offset:512
    v_exp_f32 v234, v234
    v_add_f32 v233, 1.0, v233
    v_mul_f32 v235, v235, v173
    v_rcp_f32 v232, v232
    s_waitcnt lgkmcnt(6)
    v_mfma_f32_32x32x16_bf16 v[144:159], v[228:231], v[116:119], v[144:159]
    ds_read_b64_tr_b16 v[220:221], v24 offset:2048
    ds_read_b64_tr_b16 v[222:223], v24 offset:2560
    v_fma_f32 v236, v236, s68, v27
    v_mul_f32 v237, v175, v175
    v_cvt_pk_bf16_f32 v244, v248, v249
    v_mul_f32 v232, v170, v232
    v_exp_f32 v235, v235
    s_waitcnt lgkmcnt(6)
    v_mfma_f32_32x32x16_bf16 v[144:159], v[208:211], v[120:123], v[144:159]
    ds_read_b64_tr_b16 v[224:225], v24 offset:4096
    ds_read_b64_tr_b16 v[226:227], v24 offset:4608
    v_add_f32 v234, 1.0, v234
    v_mul_f32 v236, v236, v174
    v_rcp_f32 v233, v233
    v_fma_f32 v237, v237, s68, v27
    v_mul_f32 v233, v171, v233
    s_waitcnt lgkmcnt(6)
    v_mfma_f32_32x32x16_bf16 v[144:159], v[212:215], v[124:127], v[144:159]
    ds_read_b64_tr_b16 v[228:229], v24 offset:6144
    ds_read_b64_tr_b16 v[230:231], v24 offset:6656
    v_exp_f32 v236, v236
    v_add_f32 v235, 1.0, v235
    v_mul_f32 v237, v237, v175
    v_rcp_f32 v234, v234
    s_waitcnt lgkmcnt(6)
    v_mfma_f32_32x32x16_bf16 v[144:159], v[216:219], v[128:131], v[144:159]
    v_cvt_pk_bf16_f32 v245, v232, v233
    v_mul_f32 v234, v172, v234
    v_exp_f32 v237, v237
    v_add_f32 v236, 1.0, v236
    v_rcp_f32 v235, v235
    s_waitcnt lgkmcnt(4)
    v_mfma_f32_32x32x16_bf16 v[144:159], v[220:223], v[132:135], v[144:159]
    v_mul_f32 v235, v173, v235
    v_add_f32 v237, 1.0, v237
    v_rcp_f32 v236, v236
    v_cvt_pk_bf16_f32 v246, v234, v235
    v_mul_f32 v236, v174, v236
    s_waitcnt lgkmcnt(2)
    v_mfma_f32_32x32x16_bf16 v[144:159], v[224:227], v[136:139], v[144:159]
    v_mfma_f32_32x32x16_bf16 v[144:159], v[188:191], v[176:179], v[144:159]
    v_rcp_f32 v237, v237
    s_nop 0
    v_mul_f32 v237, v175, v237
    v_cvt_pk_bf16_f32 v247, v236, v237
    s_add_u32 s75, s79, 5120
    buffer_store_dwordx4 v[244:247], v2, s[36:39], s75 offen sc1
    s_waitcnt lgkmcnt(0)
    v_mfma_f32_32x32x16_bf16 v[144:159], v[228:231], v[140:143], v[144:159]
    s_barrier
    s_lshl_b32 s72, s61, 12
    s_lshl_b32 s73, s63, 8
    s_add_u32 s72, s72, s73
    s_lshl_b32 s73, s62, 5
    s_add_u32 s72, s72, s73
    s_lshl_b32 s73, s60, 2
    s_add_u32 s72, s72, s73
    s_add_u32 s72, s72, 262144
    s_add_u32 m0, s66, 65536
    s_add_u32 s74, s65, 458752
    buffer_load_dwordx4 v31, s[44:47], s74 offen lds
    v_mul_f32 v232, v144, v144
    v_fma_f32 v232, v232, s68, v27
    v_mul_f32 v233, v145, v145
    v_mul_f32 v232, v232, v144
    v_fma_f32 v233, v233, s68, v27
    v_mul_f32 v234, v146, v146
    v_exp_f32 v232, v232
    v_mul_f32 v233, v233, v145
    v_fma_f32 v234, v234, s68, v27
    v_mul_f32 v235, v147, v147
    v_exp_f32 v233, v233
    v_add_f32 v232, 1.0, v232
    v_mul_f32 v234, v234, v146
    v_fma_f32 v235, v235, s68, v27
    v_mul_f32 v236, v148, v148
    v_exp_f32 v234, v234
    v_add_f32 v233, 1.0, v233
    s_add_u32 m0, s66, 69632
    s_add_u32 s74, s65, 487424
    buffer_load_dwordx4 v31, s[44:47], s74 offen lds
    v_mul_f32 v235, v235, v147
    v_rcp_f32 v232, v232
    v_fma_f32 v236, v236, s68, v27
    v_mul_f32 v237, v149, v149
    v_mul_f32 v232, v144, v232
    v_exp_f32 v235, v235
    v_add_f32 v234, 1.0, v234
    v_mul_f32 v236, v236, v148
    v_rcp_f32 v233, v233
    v_fma_f32 v237, v237, s68, v27
    v_mul_f32 v238, v150, v150
    v_mul_f32 v233, v145, v233
    v_exp_f32 v236, v236
    v_add_f32 v235, 1.0, v235
    v_mul_f32 v237, v237, v149
    v_rcp_f32 v234, v234
    v_fma_f32 v238, v238, s68, v27
    s_add_u32 m0, s66, 73728
    s_add_u32 s74, s65, 516096
    buffer_load_dwordx4 v31, s[44:47], s74 offen lds
    v_mul_f32 v239, v151, v151
    v_cvt_pk_bf16_f32 v240, v232, v233
    v_mul_f32 v234, v146, v234
    v_exp_f32 v237, v237
    v_add_f32 v236, 1.0, v236
    v_mul_f32 v238, v238, v150
    v_rcp_f32 v235, v235
    v_fma_f32 v239, v239, s68, v27
    v_mul_f32 v248, v152, v152
    v_mul_f32 v235, v147, v235
    v_exp_f32 v238, v238
    v_add_f32 v237, 1.0, v237
    v_mul_f32 v239, v239, v151
    v_rcp_f32 v236, v236
    v_fma_f32 v248, v248, s68, v27
    v_mul_f32 v249, v153, v153
    v_cvt_pk_bf16_f32 v241, v234, v235
    s_add_u32 m0, s66, 77824
    s_add_u32 s74, s65, 544768
    buffer_load_dwordx4 v31, s[44:47], s74 offen lds
    v_mul_f32 v236, v148, v236
    v_exp_f32 v239, v239
    v_add_f32 v238, 1.0, v238
    v_mul_f32 v248, v248, v152
    v_rcp_f32 v237, v237
    v_fma_f32 v249, v249, s68, v27
    v_mul_f32 v232, v154, v154
    v_mul_f32 v237, v149, v237
    v_exp_f32 v248, v248
    v_add_f32 v239, 1.0, v239
    v_mul_f32 v249, v249, v153
    v_rcp_f32 v238, v238
    v_fma_f32 v232, v232, s68, v27
    v_mul_f32 v233, v155, v155
    v_cvt_pk_bf16_f32 v242, v236, v237
    v_mul_f32 v238, v150, v238
    v_exp_f32 v249, v249
    v_add_f32 v248, 1.0, v248
    v_mul_f32 v232, v232, v154
    v_rcp_f32 v239, v239
    v_fma_f32 v233, v233, s68, v27
    v_mul_f32 v234, v156, v156
    s_barrier
    s_add_u32 m0, s66, 81920
    s_add_u32 s74, s65, 974848
    buffer_load_dwordx4 v31, s[44:47], s74 offen lds
    v_mul_f32 v239, v151, v239
    v_exp_f32 v232, v232
    v_add_f32 v249, 1.0, v249
    v_mul_f32 v233, v233, v155
    v_rcp_f32 v248, v248
    v_fma_f32 v234, v234, s68, v27
    v_mul_f32 v235, v157, v157
    v_cvt_pk_bf16_f32 v243, v238, v239
    s_add_u32 s75, s79, 8192
    buffer_store_dwordx4 v[240:243], v2, s[36:39], s75 offen sc1
    v_mul_f32 v248, v152, v248
    v_exp_f32 v233, v233
    v_add_f32 v232, 1.0, v232
    v_mul_f32 v234, v234, v156
    v_rcp_f32 v249, v249
    v_fma_f32 v235, v235, s68, v27
    s_add_u32 m0, s66, 86016
    s_add_u32 s74, s65, 1003520
    buffer_load_dwordx4 v31, s[44:47], s74 offen lds
    v_mul_f32 v236, v158, v158
    v_mul_f32 v249, v153, v249
    v_exp_f32 v234, v234
    v_add_f32 v233, 1.0, v233
    v_mul_f32 v235, v235, v157
    v_rcp_f32 v232, v232
    v_fma_f32 v236, v236, s68, v27
    v_mul_f32 v237, v159, v159
    v_cvt_pk_bf16_f32 v244, v248, v249
    v_mul_f32 v232, v154, v232
    v_exp_f32 v235, v235
    v_add_f32 v234, 1.0, v234
    v_mul_f32 v236, v236, v158
    v_rcp_f32 v233, v233
    v_fma_f32 v237, v237, s68, v27
    s_add_u32 m0, s66, 90112
    s_add_u32 s74, s65, 1032192
    buffer_load_dwordx4 v31, s[44:47], s74 offen lds
    v_mul_f32 v233, v155, v233
    v_exp_f32 v236, v236
    v_add_f32 v235, 1.0, v235
    v_mul_f32 v237, v237, v159
    v_rcp_f32 v234, v234
    v_cvt_pk_bf16_f32 v245, v232, v233
    v_mul_f32 v234, v156, v234
    v_exp_f32 v237, v237
    v_add_f32 v236, 1.0, v236
    v_rcp_f32 v235, v235
    s_nop 0
    v_mul_f32 v235, v157, v235
    v_add_f32 v237, 1.0, v237
    v_rcp_f32 v236, v236
    v_cvt_pk_bf16_f32 v246, v234, v235
    v_mul_f32 v236, v158, v236
    v_rcp_f32 v237, v237
    s_nop 0
    v_mul_f32 v237, v159, v237
    v_cvt_pk_bf16_f32 v247, v236, v237
    s_add_u32 s75, s79, 9216
    buffer_store_dwordx4 v[244:247], v2, s[36:39], s75 offen sc1
    s_add_u32 m0, s66, 94208
    s_add_u32 s74, s65, 1060864
    buffer_load_dwordx4 v31, s[44:47], s74 offen lds
    s_add_u32 m0, s66, 98304
    s_add_u32 s74, s65, 1490944
    buffer_load_dwordx4 v31, s[44:47], s74 offen lds
    s_add_u32 m0, s66, 102400
    s_add_u32 s74, s65, 1519616
    buffer_load_dwordx4 v31, s[44:47], s74 offen lds
    s_add_u32 m0, s66, 114688
    s_add_u32 s74, s65, 301056
    buffer_load_dwordx4 v31, s[48:51], s74 offen lds
    s_add_u32 m0, s66, 118784
    s_add_u32 s74, s65, 329728
    buffer_load_dwordx4 v31, s[48:51], s74 offen lds
    s_waitcnt vmcnt(16)
    s_barrier
    v_mov_b32 v16, 1
    v_mov_b32 v17, 0
    s_mov_b64 exec, 1
    s_waitcnt vmcnt(5)
    buffer_store_dword v16, v17, s[36:39], s72 offen sc1
    s_mov_b64 exec, -1
    s_add_u32 m0, s66, 122880
    s_add_u32 s74, s65, 351232
    buffer_load_dwordx4 v31, s[48:51], s74 offen lds
    s_add_u32 m0, s66, 126976
    s_add_u32 s74, s65, 379904
    buffer_load_dwordx4 v31, s[48:51], s74 offen lds
    s_add_u32 m0, s66, 131072
    s_add_u32 s74, s65, 0
    buffer_load_dwordx4 v31, s[44:47], s74 offen lds
    s_add_u32 m0, s66, 135168
    s_add_u32 s74, s65, 28672
    buffer_load_dwordx4 v31, s[44:47], s74 offen lds
    s_add_u32 m0, s66, 139264
    s_add_u32 s74, s65, 573440
    buffer_load_dwordx4 v31, s[44:47], s74 offen lds
    s_add_u32 m0, s66, 143360
    s_add_u32 s74, s65, 602112
    buffer_load_dwordx4 v31, s[44:47], s74 offen lds
    s_add_u32 m0, s66, 147456
    s_add_u32 s74, s65, 1089536
    buffer_load_dwordx4 v31, s[44:47], s74 offen lds
    s_add_u32 m0, s66, 151552
    s_add_u32 s74, s65, 1118208
    buffer_load_dwordx4 v31, s[44:47], s74 offen lds
    s_add_u32 m0, s66, 155648
    s_add_u32 s74, s65, 0
    buffer_load_dwordx4 v31, s[48:51], s74 offen lds
    s_add_u32 m0, s66, 159744
    s_add_u32 s74, s65, 28672
    buffer_load_dwordx4 v31, s[48:51], s74 offen lds
    s_add_u32 m0, s66, 106496
    s_add_u32 s74, s65, 1548288
    buffer_load_dwordx4 v31, s[44:47], s74 offen lds
    s_add_u32 m0, s66, 110592
    s_add_u32 s74, s65, 1576960
    buffer_load_dwordx4 v31, s[44:47], s74 offen lds
    s_branch L_P2
L_QA:
    s_mov_b32 s32, s6
    s_mov_b32 s33, s7
    s_mov_b32 s34, 1204224
    s_mov_b32 s35, 0x20000
    v_bfe_u32 v12, v0, 3, 5
    v_mul_u32_u24 v4, 2688, v12
    v_lshrrev_b32 v13, 2, v1
    v_and_b32 v13, 4, v13
    s_and_b32 s70, s60, 1
    s_lshl_b32 s70, s70, 1
    v_or_b32 v13, s70, v13
    v_and_b32 v12, 7, v1
    v_xor_b32 v12, v12, v13
    v_lshl_add_u32 v4, v12, 4, v4
    s_mul_i32 s76, s62, 112
    s_mov_b32 s36, s24
    s_mov_b32 s37, s25
    s_mov_b32 s38, 268435456
    s_mov_b32 s39, 0x20000
    s_mov_b32 s40, s22
    s_mov_b32 s41, s23
    s_mov_b32 s42, 256
    s_mov_b32 s43, 0x20000
    s_mov_b32 s44, s16
    s_mov_b32 s45, s17
    s_mov_b32 s46, 1605632
    s_mov_b32 s47, 0x20000
    s_mov_b32 s48, s8
    s_mov_b32 s49, s9
    s_mov_b32 s50, 401408
    s_mov_b32 s51, 0x20000
    s_mov_b32 s52, s20
    s_mov_b32 s53, s21
    s_mov_b32 s54, 1835008
    s_mov_b32 s55, 0x20000
    s_mov_b64 s[58:59], s[18:19]
    s_lshr_b32 s70, s64, 1
    s_sub_u32 s70, s70, s61
    v_and_b32 v23, 1, v1
    v_mul_lo_u32 v23, v23, s70
    v_add_u32 v23, s61, v23
    v_lshlrev_b32 v23, 2, v23
    v_lshlrev_b32 v255, 7, v1
    v_bfe_u32 v12, v0, 3, 5
    v_mul_u32_u24 v31, 896, v12
    v_lshrrev_b32 v13, 2, v1
    v_and_b32 v13, 4, v13
    v_and_b32 v12, 7, v1
    v_xor_b32 v12, v12, v13
    v_lshl_add_u32 v31, v12, 4, v31
    s_and_b32 s81, s60, 1
    s_add_u32 s81, s81, 0
    s_bfe_u32 s80, s60, 0x10001
    s_lshl_b32 s70, s81, 5
    s_add_u32 s70, s70, 0
    s_mul_i32 s70, s70, 896
    v_and_b32 v12, 15, v1
    v_mul_u32_u24 v13, 896, v12
    v_bfe_u32 v12, v1, 1, 3
    v_lshrrev_b32 v14, 4, v1
    v_xor_b32 v12, v12, v14
    v_lshl_add_u32 v10, v12, 4, v13
    v_xor_b32 v12, 4, v12
    v_lshl_add_u32 v11, v12, 4, v13
    v_add_u32 v8, s70, v10
    v_add_u32 v9, s70, v11
    v_add_u32 v10, 57344, v10
    v_add_u32 v11, 57344, v11
    s_mul_i32 s70, s80, 56
    v_lshrrev_b32 v12, 4, v1
    v_bfe_u32 v13, v1, 2, 2
    v_lshl_add_u32 v14, v12, 3, v13
    v_lshlrev_b32 v14, 7, v14
    v_lshrrev_b32 v13, 1, v13
    v_lshlrev_b32 v13, 6, v13
    v_and_b32 v12, 1, v12
    v_lshl_or_b32 v13, v12, 5, v13
    v_and_b32 v12, 3, v1
    v_lshlrev_b32 v12, 3, v12
    v_add_u32 v12, s70, v12
    v_xor_b32 v15, v12, v13
    v_add_u32 v24, v14, v15
    v_add_u32 v12, 32, v12
    v_xor_b32 v15, v12, v13
    v_add_u32 v25, v14, v15
    v_add_u32 v26, 106496, v24
    v_add_u32 v27, 106496, v25
    v_lshrrev_b32 v12, 5, v1
    s_lshl_b32 s70, s60, 1
    v_add_u32 v12, s70, v12
    v_bfe_u32 v13, v12, 1, 3
    v_mul_u32_u24 v12, 896, v12
    v_add_u32 v12, 57344, v12
    v_and_b32 v14, 31, v1
    v_xor_b32 v15, v14, v13
    v_lshl_add_u32 v16, v15, 4, v12
    v_add_u32 v14, 28, v14
    v_xor_b32 v15, v14, v13
    v_lshl_add_u32 v17, v15, 4, v12
    s_mul_i32 s70, s80, 10240
    s_add_u32 s70, s70, 73728
    v_add_u32 v18, s70, v2
    s_lshl_b32 s71, s81, 11
    v_add_u32 v28, s71, v18
    v_add_u32 v29, 2048, v28
    v_add_u32 v250, s66, v2
    v_add_u32 v251, 0x10000, v250
    v_mov_b32 v104, 0
    v_mov_b32 v105, 0
    s_waitcnt vmcnt(15)
    v_dot2c_f32_bf16 v104, s67, v88
    v_dot2c_f32_bf16 v105, v88, v88
    v_dot2c_f32_bf16 v104, s67, v89
    v_dot2c_f32_bf16 v105, v89, v89
    v_dot2c_f32_bf16 v104, s67, v90
    v_dot2c_f32_bf16 v105, v90, v90
    v_dot2c_f32_bf16 v104, s67, v91
    v_dot2c_f32_bf16 v105, v91, v91
    s_waitcnt vmcnt(14)
    v_dot2c_f32_bf16 v104, s67, v92
    v_dot2c_f32_bf16 v105, v92, v92
    v_dot2c_f32_bf16 v104, s67, v93
    v_dot2c_f32_bf16 v105, v93, v93
    v_dot2c_f32_bf16 v104, s67, v94
    v_dot2c_f32_bf16 v105, v94, v94
    v_dot2c_f32_bf16 v104, s67, v95
    v_dot2c_f32_bf16 v105, v95, v95
    s_nop 1
    v_add_f32_dpp v104, v104, v104 quad_perm:[1,0,3,2] row_mask:0xf bank_mask:0xf
    v_add_f32_dpp v105, v105, v105 quad_perm:[1,0,3,2] row_mask:0xf bank_mask:0xf
    s_nop 0
    v_add_f32_dpp v104, v104, v104 quad_perm:[2,3,0,1] row_mask:0xf bank_mask:0xf
    v_add_f32_dpp v105, v105, v105 quad_perm:[2,3,0,1] row_mask:0xf bank_mask:0xf
    s_nop 0
    v_add_f32_dpp v104, v104, v104 row_half_mirror row_mask:0xf bank_mask:0xf
    v_add_f32_dpp v105, v105, v105 row_half_mirror row_mask:0xf bank_mask:0xf
    s_nop 0
    v_add_f32_dpp v104, v104, v104 row_mirror row_mask:0xf bank_mask:0xf
    v_add_f32_dpp v105, v105, v105 row_mirror row_mask:0xf bank_mask:0xf
    v_mov_b32 v108, v104
    v_mov_b32 v109, v105
    s_nop 0
    v_permlane16_swap_b32 v104, v108
    v_permlane16_swap_b32 v105, v109
    v_add_f32 v104, v104, v108
    v_add_f32 v105, v105, v109
    v_mul_f32 v104, 0x3b124925, v104
    v_mul_f32 v105, 0x3b124925, v105
    v_fma_f32 v105, -v104, v104, v105
    v_max_f32 v105, 0, v105
    v_add_f32 v106, 0x3727c5ac, v105
    v_rsq_f32 v106, v106
    s_nop 0
    v_cvt_pk_bf16_f32 v106, v106, 0
    v_lshlrev_b32 v105, 16, v106
    v_mul_f32 v107, v104, v105
    v_mov_b32 v104, v106
    v_sub_f32 v106, 0, v107
    s_mov_b32 s70, 0x0fffffff
    s_mov_b32 s71, 0x0fffffff
    v_dot2_f32_bf16 v96, v88, v104, v106
    v_dot2_f32_bf16 v97, v88, v105, v106
    v_dot2_f32_bf16 v98, v89, v104, v106
    v_dot2_f32_bf16 v99, v89, v105, v106
    v_dot2_f32_bf16 v100, v90, v104, v106
    v_dot2_f32_bf16 v101, v90, v105, v106
    v_dot2_f32_bf16 v102, v91, v104, v106
    v_dot2_f32_bf16 v103, v91, v105, v106
    v_cvt_pk_bf16_f32 v88, v96, v97
    v_cvt_pk_bf16_f32 v89, v98, v99
    v_cvt_pk_bf16_f32 v90, v100, v101
    v_cvt_pk_bf16_f32 v91, v102, v103
    v_dot2_f32_bf16 v96, v92, v104, v106
    v_dot2_f32_bf16 v97, v92, v105, v106
    v_dot2_f32_bf16 v98, v93, v104, v106
    v_dot2_f32_bf16 v99, v93, v105, v106
    v_dot2_f32_bf16 v100, v94, v104, v106
    v_dot2_f32_bf16 v101, v94, v105, v106
    v_dot2_f32_bf16 v102, v95, v104, v106
    v_dot2_f32_bf16 v103, v95, v105, v106
    v_cvt_pk_bf16_f32 v92, v96, v97
    v_cvt_pk_bf16_f32 v93, v98, v99
    v_cvt_pk_bf16_f32 v94, v100, v101
    v_cvt_pk_bf16_f32 v95, v102, v103
    s_mov_b64 exec, s[70:71]
    ds_write_b128 v16, v[88:91]
    ds_write_b128 v17, v[92:95]
    s_mov_b64 exec, -1
    v_lshrrev_b32 v12, 3, v1
    s_lshl_b32 s70, s60, 4
    s_and_b32 s71, s60, 4
    s_lshl_b32 s71, s71, 2
    s_add_u32 s70, s70, s71
    v_add_u32 v12, s70, v12
    v_mul_u32_u24 v12, 896, v12
    v_lshrrev_b32 v13, 4, v1
    v_and_b32 v14, 7, v1
    v_xor_b32 v13, v13, v14
    v_lshl_add_u32 v6, v13, 4, v12
    v_xor_b32 v13, 4, v13
    v_lshl_add_u32 v7, v13, 4, v12
    v_add_u32 v7, 7168, v7
    v_mov_b32 v104, 0
    v_mov_b32 v105, 0
    s_waitcnt vmcnt(13)
    v_dot2c_f32_bf16 v104, s67, v32
    v_dot2c_f32_bf16 v105, v32, v32
    v_dot2c_f32_bf16 v104, s67, v33
    v_dot2c_f32_bf16 v105, v33, v33
    v_dot2c_f32_bf16 v104, s67, v34
    v_dot2c_f32_bf16 v105, v34, v34
    v_dot2c_f32_bf16 v104, s67, v35
    v_dot2c_f32_bf16 v105, v35, v35
    s_waitcnt vmcnt(12)
    v_dot2c_f32_bf16 v104, s67, v36
    v_dot2c_f32_bf16 v105, v36, v36
    v_dot2c_f32_bf16 v104, s67, v37
    v_dot2c_f32_bf16 v105, v37, v37
    v_dot2c_f32_bf16 v104, s67, v38
    v_dot2c_f32_bf16 v105, v38, v38
    v_dot2c_f32_bf16 v104, s67, v39
    v_dot2c_f32_bf16 v105, v39, v39
    s_waitcnt vmcnt(11)
    v_dot2c_f32_bf16 v104, s67, v40
    v_dot2c_f32_bf16 v105, v40, v40
    v_dot2c_f32_bf16 v104, s67, v41
    v_dot2c_f32_bf16 v105, v41, v41
    v_dot2c_f32_bf16 v104, s67, v42
    v_dot2c_f32_bf16 v105, v42, v42
    v_dot2c_f32_bf16 v104, s67, v43
    v_dot2c_f32_bf16 v105, v43, v43
    s_waitcnt vmcnt(10)
    v_dot2c_f32_bf16 v104, s67, v44
    v_dot2c_f32_bf16 v105, v44, v44
    v_dot2c_f32_bf16 v104, s67, v45
    v_dot2c_f32_bf16 v105, v45, v45
    v_dot2c_f32_bf16 v104, s67, v46
    v_dot2c_f32_bf16 v105, v46, v46
    v_dot2c_f32_bf16 v104, s67, v47
    v_dot2c_f32_bf16 v105, v47, v47
    s_waitcnt vmcnt(9)
    v_dot2c_f32_bf16 v104, s67, v48
    v_dot2c_f32_bf16 v105, v48, v48
    v_dot2c_f32_bf16 v104, s67, v49
    v_dot2c_f32_bf16 v105, v49, v49
    v_dot2c_f32_bf16 v104, s67, v50
    v_dot2c_f32_bf16 v105, v50, v50
    v_dot2c_f32_bf16 v104, s67, v51
    v_dot2c_f32_bf16 v105, v51, v51
    s_waitcnt vmcnt(8)
    v_dot2c_f32_bf16 v104, s67, v52
    v_dot2c_f32_bf16 v105, v52, v52
    v_dot2c_f32_bf16 v104, s67, v53
    v_dot2c_f32_bf16 v105, v53, v53
    v_dot2c_f32_bf16 v104, s67, v54
    v_dot2c_f32_bf16 v105, v54, v54
    v_dot2c_f32_bf16 v104, s67, v55
    v_dot2c_f32_bf16 v105, v55, v55
    s_waitcnt vmcnt(7)
    v_dot2c_f32_bf16 v104, s67, v56
    v_dot2c_f32_bf16 v105, v56, v56
    v_dot2c_f32_bf16 v104, s67, v57
    v_dot2c_f32_bf16 v105, v57, v57
    v_dot2c_f32_bf16 v104, s67, v58
    v_dot2c_f32_bf16 v105, v58, v58
    v_dot2c_f32_bf16 v104, s67, v59
    v_dot2c_f32_bf16 v105, v59, v59
    v_mov_b32 v112, 0
    v_mov_b32 v113, 0
    v_add_f32_dpp v104, v104, v104 quad_perm:[1,0,3,2] row_mask:0xf bank_mask:0xf
    s_waitcnt vmcnt(6)
    v_dot2c_f32_bf16 v112, s67, v60
    v_add_f32_dpp v105, v105, v105 quad_perm:[1,0,3,2] row_mask:0xf bank_mask:0xf
    v_dot2c_f32_bf16 v113, v60, v60
    v_dot2c_f32_bf16 v112, s67, v61
    v_add_f32_dpp v104, v104, v104 quad_perm:[2,3,0,1] row_mask:0xf bank_mask:0xf
    v_dot2c_f32_bf16 v113, v61, v61
    v_dot2c_f32_bf16 v112, s67, v62
    v_add_f32_dpp v105, v105, v105 quad_perm:[2,3,0,1] row_mask:0xf bank_mask:0xf
    v_dot2c_f32_bf16 v113, v62, v62
    v_dot2c_f32_bf16 v112, s67, v63
    v_add_f32_dpp v104, v104, v104 row_half_mirror row_mask:0xf bank_mask:0xf
    v_dot2c_f32_bf16 v113, v63, v63
    s_waitcnt vmcnt(5)
    v_add_f32_dpp v105, v105, v105 row_half_mirror row_mask:0xf bank_mask:0xf
    v_dot2c_f32_bf16 v112, s67, v64
    v_dot2c_f32_bf16 v113, v64, v64
    v_mul_f32 v104, 0x3b124925, v104
    v_dot2c_f32_bf16 v112, s67, v65
    v_dot2c_f32_bf16 v113, v65, v65
    v_mul_f32 v105, 0x3b124925, v105
    v_dot2c_f32_bf16 v112, s67, v66
    v_dot2c_f32_bf16 v113, v66, v66
    v_fma_f32 v105, -v104, v104, v105
    v_dot2c_f32_bf16 v112, s67, v67
    v_dot2c_f32_bf16 v113, v67, v67
    v_max_f32 v105, 0, v105
    s_waitcnt vmcnt(4)
    v_dot2c_f32_bf16 v112, s67, v68
    v_add_f32 v106, 0x3727c5ac, v105
    v_dot2c_f32_bf16 v113, v68, v68
    v_dot2c_f32_bf16 v112, s67, v69
    v_rsq_f32 v106, v106
    v_dot2c_f32_bf16 v113, v69, v69
    v_dot2c_f32_bf16 v112, s67, v70
    v_cvt_pk_bf16_f32 v106, v106, 0
    v_dot2c_f32_bf16 v113, v70, v70
    v_dot2c_f32_bf16 v112, s67, v71
    v_lshlrev_b32 v105, 16, v106
    v_dot2c_f32_bf16 v113, v71, v71
    s_waitcnt vmcnt(3)
    v_mul_f32 v107, v104, v105
    v_dot2c_f32_bf16 v112, s67, v72
    v_dot2c_f32_bf16 v113, v72, v72
    v_mov_b32 v104, v106
    v_dot2c_f32_bf16 v112, s67, v73
    v_dot2c_f32_bf16 v113, v73, v73
    v_sub_f32 v106, 0, v107
    v_dot2c_f32_bf16 v112, s67, v74
    v_dot2c_f32_bf16 v113, v74, v74
    v_dot2c_f32_bf16 v112, s67, v75
    v_dot2c_f32_bf16 v113, v75, v75
    s_waitcnt vmcnt(2)
    v_dot2c_f32_bf16 v112, s67, v76
    v_dot2c_f32_bf16 v113, v76, v76
    v_dot2c_f32_bf16 v112, s67, v77
    v_dot2c_f32_bf16 v113, v77, v77
    v_dot2c_f32_bf16 v112, s67, v78
    v_dot2c_f32_bf16 v113, v78, v78
    v_dot2c_f32_bf16 v112, s67, v79
    v_dot2c_f32_bf16 v113, v79, v79
    s_waitcnt vmcnt(1)
    v_dot2c_f32_bf16 v112, s67, v80
    v_dot2c_f32_bf16 v113, v80, v80
    v_dot2c_f32_bf16 v112, s67, v81
    v_dot2c_f32_bf16 v113, v81, v81
    v_dot2c_f32_bf16 v112, s67, v82
    v_dot2c_f32_bf16 v113, v82, v82
    v_dot2c_f32_bf16 v112, s67, v83
    v_dot2c_f32_bf16 v113, v83, v83
    s_waitcnt vmcnt(0)
    v_dot2c_f32_bf16 v112, s67, v84
    v_dot2c_f32_bf16 v113, v84, v84
    v_dot2c_f32_bf16 v112, s67, v85
    v_dot2c_f32_bf16 v113, v85, v85
    v_dot2c_f32_bf16 v112, s67, v86
    v_dot2c_f32_bf16 v113, v86, v86
    v_dot2c_f32_bf16 v112, s67, v87
    v_dot2c_f32_bf16 v113, v87, v87
    v_dot2_f32_bf16 v120, v32, v104, v106
    v_dot2_f32_bf16 v121, v32, v105, v106
    v_dot2_f32_bf16 v122, v33, v104, v106
    v_add_f32_dpp v112, v112, v112 quad_perm:[1,0,3,2] row_mask:0xf bank_mask:0xf
    v_dot2_f32_bf16 v123, v33, v105, v106
    v_dot2_f32_bf16 v124, v34, v104, v106
    v_dot2_f32_bf16 v125, v34, v105, v106
    v_add_f32_dpp v113, v113, v113 quad_perm:[1,0,3,2] row_mask:0xf bank_mask:0xf
    v_dot2_f32_bf16 v126, v35, v104, v106
    v_dot2_f32_bf16 v127, v35, v105, v106
    v_cvt_pk_bf16_f32 v32, v120, v121
    v_add_f32_dpp v112, v112, v112 quad_perm:[2,3,0,1] row_mask:0xf bank_mask:0xf
    v_cvt_pk_bf16_f32 v33, v122, v123
    v_cvt_pk_bf16_f32 v34, v124, v125
    v_cvt_pk_bf16_f32 v35, v126, v127
    v_add_f32_dpp v113, v113, v113 quad_perm:[2,3,0,1] row_mask:0xf bank_mask:0xf
    ds_write_b128 v6, v[32:35] offset:0
    v_dot2_f32_bf16 v96, v36, v104, v106
    v_dot2_f32_bf16 v97, v36, v105, v106
    v_add_f32_dpp v112, v112, v112 row_half_mirror row_mask:0xf bank_mask:0xf
    v_dot2_f32_bf16 v98, v37, v104, v106
    v_dot2_f32_bf16 v99, v37, v105, v106
    v_dot2_f32_bf16 v100, v38, v104, v106
    v_add_f32_dpp v113, v113, v113 row_half_mirror row_mask:0xf bank_mask:0xf
    v_dot2_f32_bf16 v101, v38, v105, v106
    v_dot2_f32_bf16 v102, v39, v104, v106
    v_dot2_f32_bf16 v103, v39, v105, v106
    v_mul_f32 v112, 0x3b124925, v112
    v_cvt_pk_bf16_f32 v36, v96, v97
    v_cvt_pk_bf16_f32 v37, v98, v99
    v_cvt_pk_bf16_f32 v38, v100, v101
    v_mul_f32 v113, 0x3b124925, v113
    v_cvt_pk_bf16_f32 v39, v102, v103
    ds_write_b128 v6, v[36:39] offset:128
    v_dot2_f32_bf16 v120, v40, v104, v106
    v_fma_f32 v113, -v112, v112, v113
    v_dot2_f32_bf16 v121, v40, v105, v106
    v_dot2_f32_bf16 v122, v41, v104, v106
    v_dot2_f32_bf16 v123, v41, v105, v106
    v_max_f32 v113, 0, v113
    v_dot2_f32_bf16 v124, v42, v104, v106
    v_dot2_f32_bf16 v125, v42, v105, v106
    v_dot2_f32_bf16 v126, v43, v104, v106
    v_add_f32 v114, 0x3727c5ac, v113
    v_dot2_f32_bf16 v127, v43, v105, v106
    v_cvt_pk_bf16_f32 v40, v120, v121
    v_cvt_pk_bf16_f32 v41, v122, v123
    v_rsq_f32 v114, v114
    v_cvt_pk_bf16_f32 v42, v124, v125
    v_cvt_pk_bf16_f32 v43, v126, v127
    ds_write_b128 v6, v[40:43] offset:256
    v_cvt_pk_bf16_f32 v114, v114, 0
    v_dot2_f32_bf16 v96, v44, v104, v106
    v_dot2_f32_bf16 v97, v44, v105, v106
    v_dot2_f32_bf16 v98, v45, v104, v106
    v_lshlrev_b32 v113, 16, v114
    v_dot2_f32_bf16 v99, v45, v105, v106
    v_dot2_f32_bf16 v100, v46, v104, v106
    v_dot2_f32_bf16 v101, v46, v105, v106
    v_mul_f32 v115, v112, v113
    v_dot2_f32_bf16 v102, v47, v104, v106
    v_dot2_f32_bf16 v103, v47, v105, v106
    v_cvt_pk_bf16_f32 v44, v96, v97
    v_mov_b32 v112, v114
    v_cvt_pk_bf16_f32 v45, v98, v99
    v_cvt_pk_bf16_f32 v46, v100, v101
    v_cvt_pk_bf16_f32 v47, v102, v103
    v_sub_f32 v114, 0, v115
    ds_write_b128 v6, v[44:47] offset:384
    v_dot2_f32_bf16 v120, v48, v104, v106
    v_dot2_f32_bf16 v121, v48, v105, v106
    v_dot2_f32_bf16 v122, v49, v104, v106
    v_dot2_f32_bf16 v123, v49, v105, v106
    v_dot2_f32_bf16 v124, v50, v104, v106
    v_dot2_f32_bf16 v125, v50, v105, v106
    v_dot2_f32_bf16 v126, v51, v104, v106
    v_dot2_f32_bf16 v127, v51, v105, v106
    v_cvt_pk_bf16_f32 v48, v120, v121
    v_cvt_pk_bf16_f32 v49, v122, v123
    v_cvt_pk_bf16_f32 v50, v124, v125
    v_cvt_pk_bf16_f32 v51, v126, v127
    ds_write_b128 v6, v[48:51] offset:512
    v_dot2_f32_bf16 v96, v52, v104, v106
    v_dot2_f32_bf16 v97, v52, v105, v106
    v_dot2_f32_bf16 v98, v53, v104, v106
    v_dot2_f32_bf16 v99, v53, v105, v106
    v_dot2_f32_bf16 v100, v54, v104, v106
    v_dot2_f32_bf16 v101, v54, v105, v106
    v_dot2_f32_bf16 v102, v55, v104, v106
    v_dot2_f32_bf16 v103, v55, v105, v106
    v_cvt_pk_bf16_f32 v52, v96, v97
    v_cvt_pk_bf16_f32 v53, v98, v99
    v_cvt_pk_bf16_f32 v54, v100, v101
    v_cvt_pk_bf16_f32 v55, v102, v103
    ds_write_b128 v6, v[52:55] offset:640
    v_dot2_f32_bf16 v120, v56, v104, v106
    v_dot2_f32_bf16 v121, v56, v105, v106
    v_dot2_f32_bf16 v122, v57, v104, v106
    v_dot2_f32_bf16 v123, v57, v105, v106
    v_dot2_f32_bf16 v124, v58, v104, v106
    v_dot2_f32_bf16 v125, v58, v105, v106
    v_dot2_f32_bf16 v126, v59, v104, v106
    v_dot2_f32_bf16 v127, v59, v105, v106
    v_cvt_pk_bf16_f32 v56, v120, v121
    v_cvt_pk_bf16_f32 v57, v122, v123
    v_cvt_pk_bf16_f32 v58, v124, v125
    v_cvt_pk_bf16_f32 v59, v126, v127
    ds_write_b128 v6, v[56:59] offset:768
    v_dot2_f32_bf16 v120, v60, v112, v114
    v_dot2_f32_bf16 v121, v60, v113, v114
    v_dot2_f32_bf16 v122, v61, v112, v114
    v_dot2_f32_bf16 v123, v61, v113, v114
    v_dot2_f32_bf16 v124, v62, v112, v114
    v_dot2_f32_bf16 v125, v62, v113, v114
    v_dot2_f32_bf16 v126, v63, v112, v114
    v_dot2_f32_bf16 v127, v63, v113, v114
    v_cvt_pk_bf16_f32 v60, v120, v121
    v_cvt_pk_bf16_f32 v61, v122, v123
    v_cvt_pk_bf16_f32 v62, v124, v125
    v_cvt_pk_bf16_f32 v63, v126, v127
    ds_write_b128 v7, v[60:63] offset:0
    v_dot2_f32_bf16 v96, v64, v112, v114
    v_dot2_f32_bf16 v97, v64, v113, v114
    v_dot2_f32_bf16 v98, v65, v112, v114
    v_dot2_f32_bf16 v99, v65, v113, v114
    v_dot2_f32_bf16 v100, v66, v112, v114
    v_dot2_f32_bf16 v101, v66, v113, v114
    v_dot2_f32_bf16 v102, v67, v112, v114
    v_dot2_f32_bf16 v103, v67, v113, v114
    v_cvt_pk_bf16_f32 v64, v96, v97
    v_cvt_pk_bf16_f32 v65, v98, v99
    v_cvt_pk_bf16_f32 v66, v100, v101
    v_cvt_pk_bf16_f32 v67, v102, v103
    ds_write_b128 v7, v[64:67] offset:128
    v_dot2_f32_bf16 v120, v68, v112, v114
    v_dot2_f32_bf16 v121, v68, v113, v114
    v_dot2_f32_bf16 v122, v69, v112, v114
    v_dot2_f32_bf16 v123, v69, v113, v114
    v_dot2_f32_bf16 v124, v70, v112, v114
    v_dot2_f32_bf16 v125, v70, v113, v114
    v_dot2_f32_bf16 v126, v71, v112, v114
    v_dot2_f32_bf16 v127, v71, v113, v114
    v_cvt_pk_bf16_f32 v68, v120, v121
    v_cvt_pk_bf16_f32 v69, v122, v123
    v_cvt_pk_bf16_f32 v70, v124, v125
    v_cvt_pk_bf16_f32 v71, v126, v127
    ds_write_b128 v7, v[68:71] offset:256
    v_dot2_f32_bf16 v96, v72, v112, v114
    v_dot2_f32_bf16 v97, v72, v113, v114
    v_dot2_f32_bf16 v98, v73, v112, v114
    v_dot2_f32_bf16 v99, v73, v113, v114
    v_dot2_f32_bf16 v100, v74, v112, v114
    v_dot2_f32_bf16 v101, v74, v113, v114
    v_dot2_f32_bf16 v102, v75, v112, v114
    v_dot2_f32_bf16 v103, v75, v113, v114
    v_cvt_pk_bf16_f32 v72, v96, v97
    v_cvt_pk_bf16_f32 v73, v98, v99
    v_cvt_pk_bf16_f32 v74, v100, v101
    v_cvt_pk_bf16_f32 v75, v102, v103
    ds_write_b128 v7, v[72:75] offset:384
    v_dot2_f32_bf16 v120, v76, v112, v114
    v_dot2_f32_bf16 v121, v76, v113, v114
    v_dot2_f32_bf16 v122, v77, v112, v114
    v_dot2_f32_bf16 v123, v77, v113, v114
    v_dot2_f32_bf16 v124, v78, v112, v114
    v_dot2_f32_bf16 v125, v78, v113, v114
    v_dot2_f32_bf16 v126, v79, v112, v114
    v_dot2_f32_bf16 v127, v79, v113, v114
    v_cvt_pk_bf16_f32 v76, v120, v121
    v_cvt_pk_bf16_f32 v77, v122, v123
    v_cvt_pk_bf16_f32 v78, v124, v125
    v_cvt_pk_bf16_f32 v79, v126, v127
    ds_write_b128 v7, v[76:79] offset:512
    v_dot2_f32_bf16 v96, v80, v112, v114
    v_dot2_f32_bf16 v97, v80, v113, v114
    v_dot2_f32_bf16 v98, v81, v112, v114
    v_dot2_f32_bf16 v99, v81, v113, v114
    v_dot2_f32_bf16 v100, v82, v112, v114
    v_dot2_f32_bf16 v101, v82, v113, v114
    v_dot2_f32_bf16 v102, v83, v112, v114
    v_dot2_f32_bf16 v103, v83, v113, v114
    v_cvt_pk_bf16_f32 v80, v96, v97
    v_cvt_pk_bf16_f32 v81, v98, v99
    v_cvt_pk_bf16_f32 v82, v100, v101
    v_cvt_pk_bf16_f32 v83, v102, v103
    ds_write_b128 v7, v[80:83] offset:640
    v_dot2_f32_bf16 v120, v84, v112, v114
    v_dot2_f32_bf16 v121, v84, v113, v114
    v_dot2_f32_bf16 v122, v85, v112, v114
    v_dot2_f32_bf16 v123, v85, v113, v114
    v_dot2_f32_bf16 v124, v86, v112, v114
    v_dot2_f32_bf16 v125, v86, v113, v114
    v_dot2_f32_bf16 v126, v87, v112, v114
    v_dot2_f32_bf16 v127, v87, v113, v114
    v_cvt_pk_bf16_f32 v84, v120, v121
    v_cvt_pk_bf16_f32 v85, v122, v123
    v_cvt_pk_bf16_f32 v86, v124, v125
    v_cvt_pk_bf16_f32 v87, v126, v127
    ds_write_b128 v7, v[84:87] offset:768
    s_add_u32 m0, s66, 131072
    s_add_u32 s74, s76, 896
    buffer_load_dwordx4 v4, s[32:35], s74 offen lds
    s_add_u32 m0, s66, 135168
    s_add_u32 s74, s76, 86912
    buffer_load_dwordx4 v4, s[32:35], s74 offen lds
    s_add_u32 m0, s66, 139264
    s_add_u32 s74, s76, 172928
    buffer_load_dwordx4 v4, s[32:35], s74 offen lds
    s_add_u32 m0, s66, 143360
    s_add_u32 s74, s76, 258944
    buffer_load_dwordx4 v4, s[32:35], s74 offen lds
    s_add_u32 m0, s66, 147456
    s_add_u32 s74, s76, 344960
    buffer_load_dwordx4 v4, s[32:35], s74 offen lds
    s_add_u32 m0, s66, 151552
    s_add_u32 s74, s76, 430976
    buffer_load_dwordx4 v4, s[32:35], s74 offen lds
    s_add_u32 m0, s66, 155648
    s_add_u32 s74, s76, 516992
    buffer_load_dwordx4 v4, s[32:35], s74 offen lds
    s_add_u32 m0, s66, 159744
    s_add_u32 s74, s76, 603008
    buffer_load_dwordx4 v4, s[32:35], s74 offen lds
    s_add_u32 s74, s76, 689024
    buffer_load_dwordx4 v[164:167], v4, s[32:35], s74 offen
    s_add_u32 s74, s76, 775040
    buffer_load_dwordx4 v[168:171], v4, s[32:35], s74 offen
    s_add_u32 s74, s76, 861056
    buffer_load_dwordx4 v[172:175], v4, s[32:35], s74 offen
    s_add_u32 s74, s76, 947072
    buffer_load_dwordx4 v[176:179], v4, s[32:35], s74 offen
    s_add_u32 s74, s76, 1033088
    buffer_load_dwordx4 v[180:183], v4, s[32:35], s74 offen
    s_add_u32 s74, s76, 1119104
    buffer_load_dwordx4 v[184:187], v4, s[32:35], s74 offen
    s_add_u32 s74, s76, 1792
    buffer_load_dwordx4 v[188:191], v4, s[32:35], s74 offen
    s_add_u32 s74, s76, 87808
    buffer_load_dwordx4 v[192:195], v4, s[32:35], s74 offen
    s_add_u32 s74, s76, 173824
    buffer_load_dwordx4 v[196:199], v4, s[32:35], s74 offen
    s_add_u32 s74, s76, 259840
    buffer_load_dwordx4 v[200:203], v4, s[32:35], s74 offen
    s_add_u32 s74, s76, 345856
    buffer_load_dwordx4 v[204:207], v4, s[32:35], s74 offen
    s_waitcnt vmcnt(15)
    s_waitcnt lgkmcnt(0)
    s_barrier
    s_bitcmp1_b32 s60, 0
    s_cbranch_scc1 L_Q1
L_Q0:
    ds_read_b128 v[32:35], v8 offset:0
    ds_read_b128 v[88:91], v8 offset:14336
    ds_read_b64_tr_b16 v[208:209], v26 offset:24576
    ds_read_b64_tr_b16 v[210:211], v26 offset:25088
    ds_read_b64_tr_b16 v[212:213], v27 offset:24576
    ds_read_b64_tr_b16 v[214:215], v27 offset:25088
    ds_read_b128 v[232:235], v10 offset:0
    ds_read_b128 v[36:39], v9 offset:0
    ds_read_b128 v[92:95], v9 offset:14336
    ds_read_b64_tr_b16 v[216:217], v26 offset:28672
    ds_read_b64_tr_b16 v[218:219], v26 offset:29184
    ds_read_b64_tr_b16 v[220:221], v27 offset:28672
    ds_read_b64_tr_b16 v[222:223], v27 offset:29184
    ds_read_b128 v[236:239], v11 offset:0
    s_waitcnt lgkmcnt(7)
    v_mfma_f32_16x16x32_bf16 v[144:147], v[208:211], v[32:35], 0
    v_mfma_f32_16x16x32_bf16 v[148:151], v[212:215], v[32:35], 0
    v_mfma_f32_16x16x32_bf16 v[152:155], v[208:211], v[88:91], 0
    v_mfma_f32_16x16x32_bf16 v[156:159], v[212:215], v[88:91], 0
    v_mfma_f32_16x16x32_bf16 v[160:163], v[208:211], v[232:235], 0
    ds_read_b64_tr_b16 v[224:225], v26 offset:32768
    ds_read_b64_tr_b16 v[226:227], v26 offset:33280
    ds_read_b64_tr_b16 v[228:229], v27 offset:32768
    ds_read_b64_tr_b16 v[230:231], v27 offset:33280
    ds_read_b128 v[240:243], v10 offset:128
    ds_read_b128 v[40:43], v8 offset:128
    ds_read_b128 v[96:99], v8 offset:14464
    ds_read_b128 v[44:47], v9 offset:128
    ds_read_b128 v[100:103], v9 offset:14464
    ds_read_b128 v[48:51], v8 offset:256
    ds_read_b128 v[104:107], v8 offset:14592
    ds_read_b128 v[52:55], v9 offset:256
    ds_read_b128 v[108:111], v9 offset:14592
    s_waitcnt lgkmcnt(13)
    v_mfma_f32_16x16x32_bf16 v[144:147], v[216:219], v[36:39], v[144:147]
    v_mfma_f32_16x16x32_bf16 v[148:151], v[220:223], v[36:39], v[148:151]
    v_mfma_f32_16x16x32_bf16 v[152:155], v[216:219], v[92:95], v[152:155]
    v_mfma_f32_16x16x32_bf16 v[156:159], v[220:223], v[92:95], v[156:159]
    v_mfma_f32_16x16x32_bf16 v[160:163], v[216:219], v[236:239], v[160:163]
    ds_read_b64_tr_b16 v[208:209], v26 offset:36864
    ds_read_b64_tr_b16 v[210:211], v26 offset:37376
    ds_read_b64_tr_b16 v[212:213], v27 offset:36864
    ds_read_b64_tr_b16 v[214:215], v27 offset:37376
    ds_read_b128 v[232:235], v11 offset:128
    ds_read_b128 v[56:59], v8 offset:384
    ds_read_b128 v[112:115], v8 offset:14720
    ds_read_b128 v[60:63], v9 offset:384
    ds_read_b128 v[116:119], v9 offset:14720
    ds_read_b128 v[64:67], v8 offset:512
    ds_read_b128 v[120:123], v8 offset:14848
    ds_read_b128 v[68:71], v9 offset:512
    ds_read_b128 v[124:127], v9 offset:14848
    s_getpc_b64 s[72:73]
L_pc1:
    s_sub_u32 s72, s72, L_pc1-recurrent_scan__sliding_local_dilated__mixer_channel_mlp__prompt_kernel
    s_subb_u32 s73, s73, 0
    s_lshl_b32 s70, s69, 11
    s_lshr_b32 s71, s66, 1
    s_add_u32 s70, s70, s71
    v_and_b32 v12, 3, v1
    v_lshlrev_b32 v12, 7, v12
    v_add_u32 v12, s70, v12
    s_mov_b32 s70, L_END-recurrent_scan__sliding_local_dilated__mixer_channel_mlp__prompt_kernel
    v_min_u32 v12, s70, v12
    s_mov_b64 exec, 15
    global_load_dword v254, v12, s[72:73]
    s_mov_b64 exec, -1
    s_cmp_eq_u32 s60, 0
    s_cselect_b64 s[72:73], s[12:13], s[72:73]
    s_cselect_b32 s70, 6272, s70
    s_cmp_eq_u32 s60, 1
    s_cselect_b64 s[72:73], s[8:9], s[72:73]
    s_cselect_b32 s70, 1568, s70
    s_cmp_eq_u32 s60, 2
    s_cselect_b64 s[72:73], s[16:17], s[72:73]
    s_cselect_b32 s70, 6272, s70
    s_cmp_eq_u32 s60, 3
    s_cselect_b64 s[72:73], s[10:11], s[72:73]
    s_cselect_b32 s70, 4704, s70
    s_sub_u32 s71, s70, 4
    s_mul_i32 s70, s70, s2
    v_min_u32 v12, s71, v255
    v_add_u32 v12, s70, v12
    global_load_dword v254, v12, s[72:73]
    s_waitcnt lgkmcnt(15)
    v_mfma_f32_16x16x32_bf16 v[144:147], v[224:227], v[40:43], v[144:147]
    v_mfma_f32_16x16x32_bf16 v[148:151], v[228:231], v[40:43], v[148:151]
    v_mfma_f32_16x16x32_bf16 v[152:155], v[224:227], v[96:99], v[152:155]
    v_mfma_f32_16x16x32_bf16 v[156:159], v[228:231], v[96:99], v[156:159]
    v_mfma_f32_16x16x32_bf16 v[160:163], v[224:227], v[240:243], v[160:163]
    ds_read_b128 v[72:75], v8 offset:640
    ds_read_b128 v[128:131], v8 offset:14976
    ds_read_b128 v[76:79], v9 offset:640
    ds_read_b128 v[132:135], v9 offset:14976
    ds_read_b128 v[80:83], v8 offset:768
    ds_read_b128 v[136:139], v8 offset:15104
    ds_read_b128 v[84:87], v9 offset:768
    ds_read_b128 v[140:143], v9 offset:15104
    s_waitcnt lgkmcnt(15)
    v_mfma_f32_16x16x32_bf16 v[144:147], v[208:211], v[44:47], v[144:147]
    v_mfma_f32_16x16x32_bf16 v[148:151], v[212:215], v[44:47], v[148:151]
    v_mfma_f32_16x16x32_bf16 v[152:155], v[208:211], v[100:103], v[152:155]
    v_mfma_f32_16x16x32_bf16 v[156:159], v[212:215], v[100:103], v[156:159]
    v_mfma_f32_16x16x32_bf16 v[160:163], v[208:211], v[232:235], v[160:163]
    s_waitcnt lgkmcnt(0)
    s_waitcnt vmcnt(13)
    s_barrier
    ds_read_b64_tr_b16 v[216:217], v26 offset:40960
    ds_read_b64_tr_b16 v[218:219], v26 offset:41472
    ds_read_b64_tr_b16 v[220:221], v27 offset:40960
    ds_read_b64_tr_b16 v[222:223], v27 offset:41472
    ds_read_b128 v[236:239], v10 offset:256
    ds_read_b64_tr_b16 v[224:225], v26 offset:45056
    ds_read_b64_tr_b16 v[226:227], v26 offset:45568
    ds_read_b64_tr_b16 v[228:229], v27 offset:45056
    ds_read_b64_tr_b16 v[230:231], v27 offset:45568
    ds_read_b128 v[240:243], v11 offset:256
    s_waitcnt lgkmcnt(5)
    v_mfma_f32_16x16x32_bf16 v[144:147], v[216:219], v[48:51], v[144:147]
    v_mfma_f32_16x16x32_bf16 v[148:151], v[220:223], v[48:51], v[148:151]
    v_mfma_f32_16x16x32_bf16 v[152:155], v[216:219], v[104:107], v[152:155]
    v_mfma_f32_16x16x32_bf16 v[156:159], v[220:223], v[104:107], v[156:159]
    v_mfma_f32_16x16x32_bf16 v[160:163], v[216:219], v[236:239], v[160:163]
    ds_read_b64_tr_b16 v[208:209], v26 offset:49152
    ds_read_b64_tr_b16 v[210:211], v26 offset:49664
    ds_read_b64_tr_b16 v[212:213], v27 offset:49152
    ds_read_b64_tr_b16 v[214:215], v27 offset:49664
    ds_read_b128 v[232:235], v10 offset:384
    s_waitcnt vmcnt(12)
    ds_write_b128 v251, v[164:167] offset:40960
    s_waitcnt vmcnt(11)
    ds_write_b128 v251, v[168:171] offset:45056
    s_waitcnt vmcnt(10)
    ds_write_b128 v251, v[172:175] offset:49152
    s_waitcnt vmcnt(9)
    ds_write_b128 v251, v[176:179] offset:53248
    s_waitcnt lgkmcnt(9)
    v_mfma_f32_16x16x32_bf16 v[144:147], v[224:227], v[52:55], v[144:147]
    v_mfma_f32_16x16x32_bf16 v[148:151], v[228:231], v[52:55], v[148:151]
    v_mfma_f32_16x16x32_bf16 v[152:155], v[224:227], v[108:111], v[152:155]
    v_mfma_f32_16x16x32_bf16 v[156:159], v[228:231], v[108:111], v[156:159]
    v_mfma_f32_16x16x32_bf16 v[160:163], v[224:227], v[240:243], v[160:163]
    ds_read_b64_tr_b16 v[216:217], v26 offset:53248
    ds_read_b64_tr_b16 v[218:219], v26 offset:53760
    ds_read_b64_tr_b16 v[220:221], v27 offset:53248
    ds_read_b64_tr_b16 v[222:223], v27 offset:53760
    ds_read_b128 v[236:239], v11 offset:384
    s_waitcnt vmcnt(8)
    ds_write_b128 v251, v[180:183] offset:57344
    s_waitcnt vmcnt(7)
    ds_write_b128 v251, v[184:187] offset:61440
    s_waitcnt lgkmcnt(11)
    v_mfma_f32_16x16x32_bf16 v[144:147], v[208:211], v[56:59], v[144:147]
    v_mfma_f32_16x16x32_bf16 v[148:151], v[212:215], v[56:59], v[148:151]
    v_mfma_f32_16x16x32_bf16 v[152:155], v[208:211], v[112:115], v[152:155]
    v_mfma_f32_16x16x32_bf16 v[156:159], v[212:215], v[112:115], v[156:159]
    v_mfma_f32_16x16x32_bf16 v[160:163], v[208:211], v[232:235], v[160:163]
    s_waitcnt lgkmcnt(0)
    s_barrier
    ds_read_b64_tr_b16 v[224:225], v26 offset:0
    ds_read_b64_tr_b16 v[226:227], v26 offset:512
    ds_read_b64_tr_b16 v[228:229], v27 offset:0
    ds_read_b64_tr_b16 v[230:231], v27 offset:512
    ds_read_b128 v[240:243], v10 offset:512
    s_waitcnt vmcnt(6)
    ds_write_b128 v250, v[188:191] offset:0
    v_mfma_f32_16x16x32_bf16 v[144:147], v[216:219], v[60:63], v[144:147]
    v_mfma_f32_16x16x32_bf16 v[148:151], v[220:223], v[60:63], v[148:151]
    v_mfma_f32_16x16x32_bf16 v[152:155], v[216:219], v[116:119], v[152:155]
    v_mfma_f32_16x16x32_bf16 v[156:159], v[220:223], v[116:119], v[156:159]
    v_mfma_f32_16x16x32_bf16 v[160:163], v[216:219], v[236:239], v[160:163]
    ds_read_b64_tr_b16 v[208:209], v26 offset:4096
    ds_read_b64_tr_b16 v[210:211], v26 offset:4608
    ds_read_b64_tr_b16 v[212:213], v27 offset:4096
    ds_read_b64_tr_b16 v[214:215], v27 offset:4608
    ds_read_b128 v[232:235], v11 offset:512
    s_waitcnt vmcnt(5)
    ds_write_b128 v250, v[192:195] offset:4096
    s_waitcnt lgkmcnt(7)
    v_mfma_f32_16x16x32_bf16 v[144:147], v[224:227], v[64:67], v[144:147]
    v_mfma_f32_16x16x32_bf16 v[148:151], v[228:231], v[64:67], v[148:151]
    v_mfma_f32_16x16x32_bf16 v[152:155], v[224:227], v[120:123], v[152:155]
    v_mfma_f32_16x16x32_bf16 v[156:159], v[228:231], v[120:123], v[156:159]
    v_mfma_f32_16x16x32_bf16 v[160:163], v[224:227], v[240:243], v[160:163]
    ds_read_b64_tr_b16 v[216:217], v26 offset:8192
    ds_read_b64_tr_b16 v[218:219], v26 offset:8704
    ds_read_b64_tr_b16 v[220:221], v27 offset:8192
    ds_read_b64_tr_b16 v[222:223], v27 offset:8704
    ds_read_b128 v[236:239], v10 offset:640
    s_waitcnt vmcnt(4)
    ds_write_b128 v250, v[196:199] offset:8192
    s_waitcnt lgkmcnt(7)
    v_mfma_f32_16x16x32_bf16 v[144:147], v[208:211], v[68:71], v[144:147]
    v_mfma_f32_16x16x32_bf16 v[148:151], v[212:215], v[68:71], v[148:151]
    v_mfma_f32_16x16x32_bf16 v[152:155], v[208:211], v[124:127], v[152:155]
    v_mfma_f32_16x16x32_bf16 v[156:159], v[212:215], v[124:127], v[156:159]
    v_mfma_f32_16x16x32_bf16 v[160:163], v[208:211], v[232:235], v[160:163]
    ds_read_b64_tr_b16 v[224:225], v26 offset:12288
    ds_read_b64_tr_b16 v[226:227], v26 offset:12800
    ds_read_b64_tr_b16 v[228:229], v27 offset:12288
    ds_read_b64_tr_b16 v[230:231], v27 offset:12800
    ds_read_b128 v[240:243], v11 offset:640
    s_waitcnt vmcnt(3)
    ds_write_b128 v250, v[200:203] offset:12288
    s_waitcnt lgkmcnt(7)
    v_mfma_f32_16x16x32_bf16 v[144:147], v[216:219], v[72:75], v[144:147]
    v_mfma_f32_16x16x32_bf16 v[148:151], v[220:223], v[72:75], v[148:151]
    v_mfma_f32_16x16x32_bf16 v[152:155], v[216:219], v[128:131], v[152:155]
    v_mfma_f32_16x16x32_bf16 v[156:159], v[220:223], v[128:131], v[156:159]
    v_mfma_f32_16x16x32_bf16 v[160:163], v[216:219], v[236:239], v[160:163]
    ds_read_b64_tr_b16 v[208:209], v26 offset:16384
    ds_read_b64_tr_b16 v[210:211], v26 offset:16896
    ds_read_b64_tr_b16 v[212:213], v27 offset:16384
    ds_read_b64_tr_b16 v[214:215], v27 offset:16896
    ds_read_b128 v[232:235], v10 offset:768
    s_waitcnt vmcnt(2)
    ds_write_b128 v250, v[204:207] offset:16384
    s_waitcnt lgkmcnt(7)
    v_mfma_f32_16x16x32_bf16 v[144:147], v[224:227], v[76:79], v[144:147]
    v_mfma_f32_16x16x32_bf16 v[148:151], v[228:231], v[76:79], v[148:151]
    v_mfma_f32_16x16x32_bf16 v[152:155], v[224:227], v[132:135], v[152:155]
    v_mfma_f32_16x16x32_bf16 v[156:159], v[228:231], v[132:135], v[156:159]
    v_mfma_f32_16x16x32_bf16 v[160:163], v[224:227], v[240:243], v[160:163]
    s_waitcnt lgkmcnt(0)
    s_barrier
    ds_read_b64_tr_b16 v[216:217], v26 offset:20480
    ds_read_b64_tr_b16 v[218:219], v26 offset:20992
    ds_read_b64_tr_b16 v[220:221], v27 offset:20480
    ds_read_b64_tr_b16 v[222:223], v27 offset:20992
    ds_read_b128 v[236:239], v11 offset:768
    s_add_u32 m0, s66, 131072
    s_add_u32 s74, s76, 0
    buffer_load_dwordx4 v4, s[32:35], s74 offen lds
    s_add_u32 m0, s66, 139264
    s_add_u32 s74, s76, 172032
    buffer_load_dwordx4 v4, s[32:35], s74 offen lds
    v_mfma_f32_16x16x32_bf16 v[144:147], v[208:211], v[80:83], v[144:147]
    v_mfma_f32_16x16x32_bf16 v[148:151], v[212:215], v[80:83], v[148:151]
    v_mfma_f32_16x16x32_bf16 v[152:155], v[208:211], v[136:139], v[152:155]
    v_mfma_f32_16x16x32_bf16 v[156:159], v[212:215], v[136:139], v[156:159]
    v_mfma_f32_16x16x32_bf16 v[160:163], v[208:211], v[232:235], v[160:163]
    ds_read_b64_tr_b16 v[224:225], v24 offset:0
    ds_read_b64_tr_b16 v[226:227], v24 offset:512
    ds_read_b64_tr_b16 v[228:229], v25 offset:0
    ds_read_b64_tr_b16 v[230:231], v25 offset:512
    s_add_u32 m0, s66, 147456
    s_add_u32 s74, s76, 344064
    buffer_load_dwordx4 v4, s[32:35], s74 offen lds
    v_and_b32 v12, 15, v1
    v_lshrrev_b32 v13, 4, v1
    v_lshlrev_b32 v13, 2, v13
    v_sub_u32 v12, v12, v13
    v_mov_b32 v14, 0xf149f2ca
    v_mov_b32 v15, 0
    s_or_b32 s82, s81, s61
    s_cmp_eq_u32 s82, 0
    s_cselect_b32 s78, 0xf149f2ca, 0
    s_waitcnt lgkmcnt(4)
    v_mfma_f32_16x16x32_bf16 v[144:147], v[216:219], v[84:87], v[144:147]
    v_mfma_f32_16x16x32_bf16 v[148:151], v[220:223], v[84:87], v[148:151]
    v_mfma_f32_16x16x32_bf16 v[152:155], v[216:219], v[140:143], v[152:155]
    v_mfma_f32_16x16x32_bf16 v[156:159], v[220:223], v[140:143], v[156:159]
    v_mfma_f32_16x16x32_bf16 v[160:163], v[216:219], v[236:239], v[160:163]
    ds_read_b64_tr_b16 v[208:209], v24 offset:4096
    ds_read_b64_tr_b16 v[210:211], v24 offset:4608
    ds_read_b64_tr_b16 v[212:213], v25 offset:4096
    ds_read_b64_tr_b16 v[214:215], v25 offset:4608
    s_add_u32 m0, s66, 155648
    s_add_u32 s74, s76, 516096
    buffer_load_dwordx4 v4, s[32:35], s74 offen lds
    v_subrev_u32 v13, 0, v12
    v_and_b32 v19, 0x80000001, v13
    v_cmp_eq_u32 vcc, 0, v19
    v_mov_b32 v20, 0x0000ffff
    s_nop 0
    v_cndmask_b32 v196, v14, v15, vcc
    v_cndmask_b32 v21, v15, v20, vcc
    v_cvt_pk_bf16_f32 v168, v144, v145
    v_cvt_pk_bf16_f32 v169, v146, v147
    v_cvt_pk_bf16_f32 v170, v148, v149
    v_cvt_pk_bf16_f32 v171, v150, v151
    v_cvt_pk_bf16_f32 v172, v152, v153
    v_cvt_pk_bf16_f32 v173, v154, v155
    v_cvt_pk_bf16_f32 v174, v156, v157
    v_cvt_pk_bf16_f32 v175, v158, v159
    ds_write_b128 v29, v[172:175]
    v_cvt_pk_bf16_f32 v248, v160, v161
    v_cvt_pk_bf16_f32 v249, v162, v163
    ds_write_b64 v18, v[248:249] offset:0
    s_waitcnt lgkmcnt(6)
    v_mfma_f32_16x16x32_bf16 v[144:147], v[32:35], v[224:227], 0
    v_mfma_f32_16x16x32_bf16 v[148:151], v[32:35], v[228:231], 0
    v_mfma_f32_16x16x32_bf16 v[152:155], v[88:91], v[224:227], 0
    v_mfma_f32_16x16x32_bf16 v[156:159], v[88:91], v[228:231], 0
    s_barrier
    ds_read_b64_tr_b16 v[216:217], v24 offset:8192
    ds_read_b64_tr_b16 v[218:219], v24 offset:8704
    ds_read_b64_tr_b16 v[220:221], v25 offset:8192
    ds_read_b64_tr_b16 v[222:223], v25 offset:8704
    s_add_u32 m0, s66, 106496
    s_add_u32 s74, s76, 688128
    buffer_load_dwordx4 v4, s[32:35], s74 offen lds
    v_cmp_eq_u32 vcc, 0x80000000, v19
    s_nop 1
    v_cndmask_b32 v200, v14, v15, vcc
    v_cndmask_b32 v252, v15, v20, vcc
    v_min_f32 v204, s78, v200
    s_waitcnt lgkmcnt(6)
    v_mfma_f32_16x16x32_bf16 v[144:147], v[36:39], v[208:211], v[144:147]
    v_mfma_f32_16x16x32_bf16 v[148:151], v[36:39], v[212:215], v[148:151]
    v_mfma_f32_16x16x32_bf16 v[152:155], v[92:95], v[208:211], v[152:155]
    v_mfma_f32_16x16x32_bf16 v[156:159], v[92:95], v[212:215], v[156:159]
    ds_read_b64_tr_b16 v[224:225], v24 offset:12288
    ds_read_b64_tr_b16 v[226:227], v24 offset:12800
    ds_read_b64_tr_b16 v[228:229], v25 offset:12288
    ds_read_b64_tr_b16 v[230:231], v25 offset:12800
    s_add_u32 m0, s66, 114688
    s_add_u32 s74, s76, 860160
    buffer_load_dwordx4 v4, s[32:35], s74 offen lds
    v_subrev_u32 v13, 1, v12
    v_and_b32 v19, 0x80000001, v13
    v_cmp_eq_u32 vcc, 0, v19
    v_mov_b32 v20, 0xffff0000
    s_nop 0
    v_cndmask_b32 v197, v14, v15, vcc
    v_cndmask_b32 v22, v15, v20, vcc
    s_waitcnt lgkmcnt(4)
    v_mfma_f32_16x16x32_bf16 v[144:147], v[40:43], v[216:219], v[144:147]
    v_mfma_f32_16x16x32_bf16 v[148:151], v[40:43], v[220:223], v[148:151]
    v_mfma_f32_16x16x32_bf16 v[152:155], v[96:99], v[216:219], v[152:155]
    v_mfma_f32_16x16x32_bf16 v[156:159], v[96:99], v[220:223], v[156:159]
    ds_read_b64_tr_b16 v[208:209], v24 offset:16384
    ds_read_b64_tr_b16 v[210:211], v24 offset:16896
    ds_read_b64_tr_b16 v[212:213], v25 offset:16384
    ds_read_b64_tr_b16 v[214:215], v25 offset:16896
    s_add_u32 m0, s66, 122880
    s_add_u32 s74, s76, 1032192
    buffer_load_dwordx4 v4, s[32:35], s74 offen lds
    v_cmp_eq_u32 vcc, 0x80000000, v19
    v_or_b32 v246, v21, v22
    s_waitcnt lgkmcnt(4)
    v_mfma_f32_16x16x32_bf16 v[144:147], v[44:47], v[224:227], v[144:147]
    v_mfma_f32_16x16x32_bf16 v[148:151], v[44:47], v[228:231], v[148:151]
    v_mfma_f32_16x16x32_bf16 v[152:155], v[100:103], v[224:227], v[152:155]
    v_mfma_f32_16x16x32_bf16 v[156:159], v[100:103], v[228:231], v[156:159]
    s_barrier
    ds_read_b64_tr_b16 v[216:217], v24 offset:20480
    ds_read_b64_tr_b16 v[218:219], v24 offset:20992
    ds_read_b64_tr_b16 v[220:221], v25 offset:20480
    ds_read_b64_tr_b16 v[222:223], v25 offset:20992
    v_cndmask_b32 v201, v14, v15, vcc
    v_cndmask_b32 v253, v15, v20, vcc
    v_or_b32 v244, v252, v253
    v_min_f32 v205, s78, v201
    s_waitcnt lgkmcnt(4)
    v_mfma_f32_16x16x32_bf16 v[144:147], v[48:51], v[208:211], v[144:147]
    v_mfma_f32_16x16x32_bf16 v[148:151], v[48:51], v[212:215], v[148:151]
    v_mfma_f32_16x16x32_bf16 v[152:155], v[104:107], v[208:211], v[152:155]
    v_mfma_f32_16x16x32_bf16 v[156:159], v[104:107], v[212:215], v[156:159]
    ds_read_b64_tr_b16 v[224:225], v24 offset:24576
    ds_read_b64_tr_b16 v[226:227], v24 offset:25088
    ds_read_b64_tr_b16 v[228:229], v25 offset:24576
    ds_read_b64_tr_b16 v[230:231], v25 offset:25088
    v_subrev_u32 v13, 2, v12
    v_and_b32 v19, 0x80000001, v13
    v_cmp_eq_u32 vcc, 0, v19
    v_mov_b32 v20, 0x0000ffff
    s_nop 0
    v_cndmask_b32 v198, v14, v15, vcc
    v_cndmask_b32 v21, v15, v20, vcc
    s_waitcnt lgkmcnt(4)
    v_mfma_f32_16x16x32_bf16 v[144:147], v[52:55], v[216:219], v[144:147]
    v_mfma_f32_16x16x32_bf16 v[148:151], v[52:55], v[220:223], v[148:151]
    v_mfma_f32_16x16x32_bf16 v[152:155], v[108:111], v[216:219], v[152:155]
    v_mfma_f32_16x16x32_bf16 v[156:159], v[108:111], v[220:223], v[156:159]
    ds_read_b64_tr_b16 v[208:209], v24 offset:28672
    ds_read_b64_tr_b16 v[210:211], v24 offset:29184
    ds_read_b64_tr_b16 v[212:213], v25 offset:28672
    ds_read_b64_tr_b16 v[214:215], v25 offset:29184
    v_mul_u32_u24 v251, 7, v255
    s_and_b32 s75, s64, 3
    s_lshl_b32 s75, s75, 3
    s_add_u32 s75, s75, s60
    s_lshl_b32 s74, s75, 5
    s_cmp_ge_u32 s75, 12
    s_cselect_b32 s73, 256, 0
    s_add_u32 s74, s74, s73
    s_cmp_ge_u32 s75, 22
    s_cselect_b32 s73, 256, 0
    s_add_u32 s74, s74, s73
    s_mul_i32 s74, s74, 896
    s_add_u32 s74, s74, s65
    s_mov_b64 exec, 0xffffffff
    buffer_load_dword v254, v251, s[44:47], s74 offen sc1
    s_mul_i32 s74, s75, 7168
    s_add_u32 s74, s74, s65
    s_mov_b64 exec, 0xff
    buffer_load_dword v254, v251, s[48:51], s74 offen sc1
    s_mov_b64 exec, -1
    v_cmp_eq_u32 vcc, 0x80000000, v19
    s_nop 1
    v_cndmask_b32 v202, v14, v15, vcc
    v_cndmask_b32 v252, v15, v20, vcc
    v_min_f32 v206, s78, v202
    s_waitcnt lgkmcnt(4)
    v_mfma_f32_16x16x32_bf16 v[144:147], v[56:59], v[224:227], v[144:147]
    v_mfma_f32_16x16x32_bf16 v[148:151], v[56:59], v[228:231], v[148:151]
    v_mfma_f32_16x16x32_bf16 v[152:155], v[112:115], v[224:227], v[152:155]
    v_mfma_f32_16x16x32_bf16 v[156:159], v[112:115], v[228:231], v[156:159]
    ds_read_b64_tr_b16 v[216:217], v24 offset:32768
    ds_read_b64_tr_b16 v[218:219], v24 offset:33280
    ds_read_b64_tr_b16 v[220:221], v25 offset:32768
    ds_read_b64_tr_b16 v[222:223], v25 offset:33280
    v_subrev_u32 v13, 3, v12
    v_and_b32 v19, 0x80000001, v13
    v_cmp_eq_u32 vcc, 0, v19
    v_mov_b32 v20, 0xffff0000
    s_nop 0
    v_cndmask_b32 v199, v14, v15, vcc
    v_cndmask_b32 v22, v15, v20, vcc
    s_waitcnt lgkmcnt(4)
    v_mfma_f32_16x16x32_bf16 v[144:147], v[60:63], v[208:211], v[144:147]
    v_mfma_f32_16x16x32_bf16 v[148:151], v[60:63], v[212:215], v[148:151]
    v_mfma_f32_16x16x32_bf16 v[152:155], v[116:119], v[208:211], v[152:155]
    v_mfma_f32_16x16x32_bf16 v[156:159], v[116:119], v[212:215], v[156:159]
    ds_read_b64_tr_b16 v[224:225], v24 offset:36864
    ds_read_b64_tr_b16 v[226:227], v24 offset:37376
    ds_read_b64_tr_b16 v[228:229], v25 offset:36864
    ds_read_b64_tr_b16 v[230:231], v25 offset:37376
    v_cmp_eq_u32 vcc, 0x80000000, v19
    v_or_b32 v247, v21, v22
    s_waitcnt lgkmcnt(4)
    v_mfma_f32_16x16x32_bf16 v[144:147], v[64:67], v[216:219], v[144:147]
    v_mfma_f32_16x16x32_bf16 v[148:151], v[64:67], v[220:223], v[148:151]
    v_mfma_f32_16x16x32_bf16 v[152:155], v[120:123], v[216:219], v[152:155]
    v_mfma_f32_16x16x32_bf16 v[156:159], v[120:123], v[220:223], v[156:159]
    ds_read_b64_tr_b16 v[208:209], v24 offset:40960
    ds_read_b64_tr_b16 v[210:211], v24 offset:41472
    ds_read_b64_tr_b16 v[212:213], v25 offset:40960
    ds_read_b64_tr_b16 v[214:215], v25 offset:41472
    v_cndmask_b32 v203, v14, v15, vcc
    v_cndmask_b32 v253, v15, v20, vcc
    v_or_b32 v245, v252, v253
    v_min_f32 v207, s78, v203
    s_waitcnt lgkmcnt(4)
    v_mfma_f32_16x16x32_bf16 v[144:147], v[68:71], v[224:227], v[144:147]
    v_mfma_f32_16x16x32_bf16 v[148:151], v[68:71], v[228:231], v[148:151]
    v_mfma_f32_16x16x32_bf16 v[152:155], v[124:127], v[224:227], v[152:155]
    v_mfma_f32_16x16x32_bf16 v[156:159], v[124:127], v[228:231], v[156:159]
    ds_read_b64_tr_b16 v[216:217], v24 offset:45056
    ds_read_b64_tr_b16 v[218:219], v24 offset:45568
    ds_read_b64_tr_b16 v[220:221], v25 offset:45056
    ds_read_b64_tr_b16 v[222:223], v25 offset:45568
    v_cmp_gt_u32 vcc, 48, v1
    v_mov_b32 v19, 0x3e8b97f6
    s_nop 0
    v_cndmask_b32 v20, v15, v19, vcc
    v_cndmask_b32 v21, 0, -1, vcc
    v_lshrrev_b32 v12, 4, v1
    v_and_b32 v13, 15, v1
    v_lshlrev_b32 v13, 4, v13
    v_lshl_add_u32 v22, v12, 9, v13
    s_waitcnt lgkmcnt(4)
    v_mfma_f32_16x16x32_bf16 v[144:147], v[72:75], v[208:211], v[144:147]
    v_mfma_f32_16x16x32_bf16 v[148:151], v[72:75], v[212:215], v[148:151]
    v_mfma_f32_16x16x32_bf16 v[152:155], v[128:131], v[208:211], v[152:155]
    v_mfma_f32_16x16x32_bf16 v[156:159], v[128:131], v[212:215], v[156:159]
    ds_read_b64_tr_b16 v[224:225], v24 offset:49152
    ds_read_b64_tr_b16 v[226:227], v24 offset:49664
    ds_read_b64_tr_b16 v[228:229], v25 offset:49152
    ds_read_b64_tr_b16 v[230:231], v25 offset:49664
    s_lshl_b32 s79, s61, 2
    s_add_u32 s79, s79, s81
    s_mul_i32 s79, s79, 145
    s_lshl_b32 s83, s62, 1
    s_add_u32 s82, s80, s83
    s_lshl_b32 s82, s82, 1
    s_add_u32 s79, s79, s82
    s_add_u32 s79, s79, 112
    s_lshl_b32 s79, s79, 10
    s_add_u32 s79, s79, 1048576
    s_waitcnt lgkmcnt(4)
    v_mfma_f32_16x16x32_bf16 v[144:147], v[76:79], v[216:219], v[144:147]
    v_mfma_f32_16x16x32_bf16 v[148:151], v[76:79], v[220:223], v[148:151]
    v_mfma_f32_16x16x32_bf16 v[152:155], v[132:135], v[216:219], v[152:155]
    v_mfma_f32_16x16x32_bf16 v[156:159], v[132:135], v[220:223], v[156:159]
    s_waitcnt vmcnt(5)
    s_barrier
    ds_read_b64_tr_b16 v[208:209], v24 offset:53248
    ds_read_b64_tr_b16 v[210:211], v24 offset:53760
    ds_read_b64_tr_b16 v[212:213], v25 offset:53248
    ds_read_b64_tr_b16 v[214:215], v25 offset:53760
    s_waitcnt lgkmcnt(4)
    v_mfma_f32_16x16x32_bf16 v[144:147], v[80:83], v[224:227], v[144:147]
    v_mfma_f32_16x16x32_bf16 v[148:151], v[80:83], v[228:231], v[148:151]
    v_mfma_f32_16x16x32_bf16 v[152:155], v[136:139], v[224:227], v[152:155]
    v_mfma_f32_16x16x32_bf16 v[156:159], v[136:139], v[228:231], v[156:159]
    ds_read_b64_tr_b16 v[216:217], v26 offset:24576
    ds_read_b64_tr_b16 v[218:219], v26 offset:25088
    ds_read_b64_tr_b16 v[220:221], v27 offset:24576
    ds_read_b64_tr_b16 v[222:223], v27 offset:25088
    s_waitcnt lgkmcnt(4)
    v_mfma_f32_16x16x32_bf16 v[144:147], v[84:87], v[208:211], v[144:147]
    v_mfma_f32_16x16x32_bf16 v[148:151], v[84:87], v[212:215], v[148:151]
    v_mfma_f32_16x16x32_bf16 v[152:155], v[140:143], v[208:211], v[152:155]
    v_mfma_f32_16x16x32_bf16 v[156:159], v[140:143], v[212:215], v[156:159]
    ds_read_b64_tr_b16 v[224:225], v26 offset:28672
    ds_read_b64_tr_b16 v[226:227], v26 offset:29184
    ds_read_b64_tr_b16 v[228:229], v27 offset:28672
    ds_read_b64_tr_b16 v[230:231], v27 offset:29184
    s_nop 0
    v_cvt_pk_bf16_f32 v178, v144, v145
    v_cvt_pk_bf16_f32 v179, v146, v147
    v_cvt_pk_bf16_f32 v184, v148, v149
    v_cvt_pk_bf16_f32 v185, v150, v151
    v_cvt_pk_bf16_f32 v180, v152, v153
    v_cvt_pk_bf16_f32 v181, v154, v155
    v_cvt_pk_bf16_f32 v186, v156, v157
    v_cvt_pk_bf16_f32 v187, v158, v159
    ds_write_b64 v29, v[180:181] offset:1024
    ds_write_b64 v29, v[186:187] offset:1032
    s_waitcnt lgkmcnt(6)
    v_mfma_f32_16x16x32_bf16 v[144:147], v[216:219], v[32:35], 0
    v_mfma_f32_16x16x32_bf16 v[148:151], v[220:223], v[32:35], 0
    v_mfma_f32_16x16x32_bf16 v[152:155], v[216:219], v[88:91], 0
    v_mfma_f32_16x16x32_bf16 v[156:159], v[220:223], v[88:91], 0
    ds_read_b64_tr_b16 v[208:209], v26 offset:32768
    ds_read_b64_tr_b16 v[210:211], v26 offset:33280
    ds_read_b64_tr_b16 v[212:213], v27 offset:32768
    ds_read_b64_tr_b16 v[214:215], v27 offset:33280
    s_cmp_lg_u32 s60, 0
    s_cbranch_scc1 L_ncQ0
    buffer_load_dword v30, v23, s[40:43], 0 offen offset:64 sc1
L_ncQ0:
    s_waitcnt lgkmcnt(6)
    v_mfma_f32_16x16x32_bf16 v[144:147], v[224:227], v[36:39], v[144:147]
    v_mfma_f32_16x16x32_bf16 v[148:151], v[228:231], v[36:39], v[148:151]
    v_mfma_f32_16x16x32_bf16 v[152:155], v[224:227], v[92:95], v[152:155]
    v_mfma_f32_16x16x32_bf16 v[156:159], v[228:231], v[92:95], v[156:159]
    s_waitcnt vmcnt(2)
    s_waitcnt lgkmcnt(4)
    s_barrier
    ds_read_b128 v[164:167], v28
    ds_read_b64 v[176:177], v28 offset:1024
    ds_read_b64 v[182:183], v28 offset:1032
    ds_read_b64_tr_b16 v[216:217], v26 offset:36864
    ds_read_b64_tr_b16 v[218:219], v26 offset:37376
    ds_read_b64_tr_b16 v[220:221], v27 offset:36864
    ds_read_b64_tr_b16 v[222:223], v27 offset:37376
    s_add_u32 m0, s66, 0
    s_add_u32 s74, s65, 344064
    buffer_load_dwordx4 v31, s[44:47], s74 offen lds
    s_add_u32 m0, s66, 8192
    s_add_u32 s74, s65, 401408
    buffer_load_dwordx4 v31, s[44:47], s74 offen lds
    s_waitcnt lgkmcnt(7)
    v_mfma_f32_16x16x32_bf16 v[144:147], v[208:211], v[40:43], v[144:147]
    v_mfma_f32_16x16x32_bf16 v[148:151], v[212:215], v[40:43], v[148:151]
    v_mfma_f32_16x16x32_bf16 v[152:155], v[208:211], v[96:99], v[152:155]
    v_mfma_f32_16x16x32_bf16 v[156:159], v[212:215], v[96:99], v[156:159]
    ds_read_b64_tr_b16 v[224:225], v26 offset:40960
    ds_read_b64_tr_b16 v[226:227], v26 offset:41472
    ds_read_b64_tr_b16 v[228:229], v27 offset:40960
    ds_read_b64_tr_b16 v[230:231], v27 offset:41472
    s_add_u32 m0, s66, 16384
    s_add_u32 s74, s65, 860160
    buffer_load_dwordx4 v31, s[44:47], s74 offen lds
    s_waitcnt lgkmcnt(4)
    v_mfma_f32_16x16x32_bf16 v[144:147], v[216:219], v[44:47], v[144:147]
    v_mfma_f32_16x16x32_bf16 v[148:151], v[220:223], v[44:47], v[148:151]
    v_mfma_f32_16x16x32_bf16 v[152:155], v[216:219], v[100:103], v[152:155]
    v_mfma_f32_16x16x32_bf16 v[156:159], v[220:223], v[100:103], v[156:159]
    ds_read_b64_tr_b16 v[208:209], v26 offset:45056
    ds_read_b64_tr_b16 v[210:211], v26 offset:45568
    ds_read_b64_tr_b16 v[212:213], v27 offset:45056
    ds_read_b64_tr_b16 v[214:215], v27 offset:45568
    s_add_u32 m0, s66, 24576
    s_add_u32 s74, s65, 917504
    buffer_load_dwordx4 v31, s[44:47], s74 offen lds
    s_waitcnt lgkmcnt(4)
    v_mfma_f32_16x16x32_bf16 v[144:147], v[224:227], v[48:51], v[144:147]
    v_mfma_f32_16x16x32_bf16 v[148:151], v[228:231], v[48:51], v[148:151]
    v_mfma_f32_16x16x32_bf16 v[152:155], v[224:227], v[104:107], v[152:155]
    v_mfma_f32_16x16x32_bf16 v[156:159], v[228:231], v[104:107], v[156:159]
    ds_read_b64_tr_b16 v[216:217], v26 offset:49152
    ds_read_b64_tr_b16 v[218:219], v26 offset:49664
    ds_read_b64_tr_b16 v[220:221], v27 offset:49152
    ds_read_b64_tr_b16 v[222:223], v27 offset:49664
    s_add_u32 m0, s66, 32768
    s_add_u32 s74, s65, 1376256
    buffer_load_dwordx4 v31, s[44:47], s74 offen lds
    s_waitcnt lgkmcnt(4)
    v_mfma_f32_16x16x32_bf16 v[144:147], v[208:211], v[52:55], v[144:147]
    v_mfma_f32_16x16x32_bf16 v[148:151], v[212:215], v[52:55], v[148:151]
    v_mfma_f32_16x16x32_bf16 v[152:155], v[208:211], v[108:111], v[152:155]
    v_mfma_f32_16x16x32_bf16 v[156:159], v[212:215], v[108:111], v[156:159]
    ds_read_b64_tr_b16 v[224:225], v26 offset:53248
    ds_read_b64_tr_b16 v[226:227], v26 offset:53760
    ds_read_b64_tr_b16 v[228:229], v27 offset:53248
    ds_read_b64_tr_b16 v[230:231], v27 offset:53760
    s_add_u32 m0, s66, 40960
    s_add_u32 s74, s65, 1433600
    buffer_load_dwordx4 v31, s[44:47], s74 offen lds
    s_add_u32 m0, s66, 49152
    s_add_u32 s74, s65, 200704
    buffer_load_dwordx4 v31, s[48:51], s74 offen lds
    s_waitcnt lgkmcnt(4)
    v_mfma_f32_16x16x32_bf16 v[144:147], v[216:219], v[56:59], v[144:147]
    v_mfma_f32_16x16x32_bf16 v[148:151], v[220:223], v[56:59], v[148:151]
    v_mfma_f32_16x16x32_bf16 v[152:155], v[216:219], v[112:115], v[152:155]
    v_mfma_f32_16x16x32_bf16 v[156:159], v[220:223], v[112:115], v[156:159]
    ds_read_b64_tr_b16 v[208:209], v26 offset:0
    ds_read_b64_tr_b16 v[210:211], v26 offset:512
    ds_read_b64_tr_b16 v[212:213], v27 offset:0
    ds_read_b64_tr_b16 v[214:215], v27 offset:512
    s_add_u32 m0, s66, 57344
    s_add_u32 s74, s65, 250880
    buffer_load_dwordx4 v31, s[48:51], s74 offen lds
    s_waitcnt lgkmcnt(4)
    v_mfma_f32_16x16x32_bf16 v[144:147], v[224:227], v[60:63], v[144:147]
    v_mfma_f32_16x16x32_bf16 v[148:151], v[228:231], v[60:63], v[148:151]
    v_mfma_f32_16x16x32_bf16 v[152:155], v[224:227], v[116:119], v[152:155]
    v_mfma_f32_16x16x32_bf16 v[156:159], v[228:231], v[116:119], v[156:159]
    ds_read_b64_tr_b16 v[216:217], v26 offset:4096
    ds_read_b64_tr_b16 v[218:219], v26 offset:4608
    ds_read_b64_tr_b16 v[220:221], v27 offset:4096
    ds_read_b64_tr_b16 v[222:223], v27 offset:4608
    s_add_u32 m0, s66, 65536
    s_add_u32 s74, s65, 458752
    buffer_load_dwordx4 v31, s[44:47], s74 offen lds
    s_waitcnt lgkmcnt(4)
    v_mfma_f32_16x16x32_bf16 v[144:147], v[208:211], v[64:67], v[144:147]
    v_mfma_f32_16x16x32_bf16 v[148:151], v[212:215], v[64:67], v[148:151]
    v_mfma_f32_16x16x32_bf16 v[152:155], v[208:211], v[120:123], v[152:155]
    v_mfma_f32_16x16x32_bf16 v[156:159], v[212:215], v[120:123], v[156:159]
    ds_read_b64_tr_b16 v[224:225], v26 offset:8192
    ds_read_b64_tr_b16 v[226:227], v26 offset:8704
    ds_read_b64_tr_b16 v[228:229], v27 offset:8192
    ds_read_b64_tr_b16 v[230:231], v27 offset:8704
    s_add_u32 m0, s66, 98304
    s_add_u32 s74, s65, 1490944
    buffer_load_dwordx4 v31, s[44:47], s74 offen lds
    s_waitcnt lgkmcnt(4)
    v_mfma_f32_16x16x32_bf16 v[144:147], v[216:219], v[68:71], v[144:147]
    v_mfma_f32_16x16x32_bf16 v[148:151], v[220:223], v[68:71], v[148:151]
    v_mfma_f32_16x16x32_bf16 v[152:155], v[216:219], v[124:127], v[152:155]
    v_mfma_f32_16x16x32_bf16 v[156:159], v[220:223], v[124:127], v[156:159]
    s_barrier
    ds_read_b64_tr_b16 v[208:209], v26 offset:12288
    ds_read_b64_tr_b16 v[210:211], v26 offset:12800
    ds_read_b64_tr_b16 v[212:213], v27 offset:12288
    ds_read_b64_tr_b16 v[214:215], v27 offset:12800
    s_add_u32 m0, s66, 73728
    s_add_u32 s74, s65, 516096
    buffer_load_dwordx4 v31, s[44:47], s74 offen lds
    s_add_u32 m0, s66, 81920
    s_add_u32 s74, s65, 974848
    buffer_load_dwordx4 v31, s[44:47], s74 offen lds
    s_waitcnt lgkmcnt(4)
    v_mfma_f32_16x16x32_bf16 v[144:147], v[224:227], v[72:75], v[144:147]
    v_mfma_f32_16x16x32_bf16 v[148:151], v[228:231], v[72:75], v[148:151]
    v_mfma_f32_16x16x32_bf16 v[152:155], v[224:227], v[128:131], v[152:155]
    v_mfma_f32_16x16x32_bf16 v[156:159], v[228:231], v[128:131], v[156:159]
    ds_read_b64_tr_b16 v[216:217], v26 offset:16384
    ds_read_b64_tr_b16 v[218:219], v26 offset:16896
    ds_read_b64_tr_b16 v[220:221], v27 offset:16384
    ds_read_b64_tr_b16 v[222:223], v27 offset:16896
    s_add_u32 m0, s66, 90112
    s_add_u32 s74, s65, 1032192
    buffer_load_dwordx4 v31, s[44:47], s74 offen lds
    s_waitcnt lgkmcnt(4)
    v_mfma_f32_16x16x32_bf16 v[144:147], v[208:211], v[76:79], v[144:147]
    v_mfma_f32_16x16x32_bf16 v[148:151], v[212:215], v[76:79], v[148:151]
    v_mfma_f32_16x16x32_bf16 v[152:155], v[208:211], v[132:135], v[152:155]
    v_mfma_f32_16x16x32_bf16 v[156:159], v[212:215], v[132:135], v[156:159]
    ds_read_b64_tr_b16 v[224:225], v26 offset:20480
    ds_read_b64_tr_b16 v[226:227], v26 offset:20992
    ds_read_b64_tr_b16 v[228:229], v27 offset:20480
    ds_read_b64_tr_b16 v[230:231], v27 offset:20992
    s_add_u32 m0, s66, 131072
    s_add_u32 s74, s65, 0
    buffer_load_dwordx4 v31, s[44:47], s74 offen lds
    s_add_u32 m0, s66, 139264
    s_add_u32 s74, s65, 573440
    buffer_load_dwordx4 v31, s[44:47], s74 offen lds
    s_waitcnt lgkmcnt(4)
    v_mfma_f32_16x16x32_bf16 v[144:147], v[216:219], v[80:83], v[144:147]
    v_mfma_f32_16x16x32_bf16 v[148:151], v[220:223], v[80:83], v[148:151]
    v_mfma_f32_16x16x32_bf16 v[152:155], v[216:219], v[136:139], v[152:155]
    v_mfma_f32_16x16x32_bf16 v[156:159], v[220:223], v[136:139], v[156:159]
    s_add_u32 m0, s66, 147456
    s_add_u32 s74, s65, 1089536
    buffer_load_dwordx4 v31, s[44:47], s74 offen lds
    s_waitcnt lgkmcnt(0)
    v_mfma_f32_16x16x32_bf16 v[144:147], v[224:227], v[84:87], v[144:147]
    v_mfma_f32_16x16x32_bf16 v[148:151], v[228:231], v[84:87], v[148:151]
    v_mfma_f32_16x16x32_bf16 v[152:155], v[224:227], v[140:143], v[152:155]
    v_mfma_f32_16x16x32_bf16 v[156:159], v[228:231], v[140:143], v[156:159]
    s_waitcnt vmcnt(8)
    s_cmp_lg_u32 s60, 0
    s_cbranch_scc1 L_cokQ0
    s_mov_b32 s71, 0
L_certQ0:
    v_cmp_eq_u32 vcc, 0, v30
    s_nop 1
    s_cbranch_vccz L_cokQ0
    s_add_u32 s71, s71, 1
    s_cmp_ge_u32 s71, 0x40000
    s_cbranch_scc1 L_cokQ0
    s_sleep 2
    buffer_load_dword v30, v23, s[40:43], 0 offen offset:64 sc1
    s_waitcnt vmcnt(0)
    s_branch L_certQ0
L_cokQ0:
    s_barrier
    s_add_u32 m0, s66, 155648
    s_add_u32 s74, s65, 0
    buffer_load_dwordx4 v31, s[48:51], s74 offen lds
    v_mul_f32 v144, v19, v144
    v_mul_f32 v145, v19, v145
    v_mul_f32 v146, v19, v146
    v_mul_f32 v147, v19, v147
    v_mul_f32 v148, v20, v148
    v_mul_f32 v149, v20, v149
    v_mul_f32 v150, v20, v150
    v_mul_f32 v151, v20, v151
    v_cvt_pk_bf16_f32 v188, v144, v145
    v_cvt_pk_bf16_f32 v189, v146, v147
    v_cvt_pk_bf16_f32 v190, v148, v149
    v_cvt_pk_bf16_f32 v191, v150, v151
    v_mul_f32 v152, v19, v152
    v_mul_f32 v153, v19, v153
    v_mul_f32 v154, v19, v154
    v_mul_f32 v155, v19, v155
    v_mul_f32 v156, v20, v156
    v_mul_f32 v157, v20, v157
    v_mul_f32 v158, v20, v158
    v_mul_f32 v159, v20, v159
    v_cvt_pk_bf16_f32 v192, v152, v153
    v_cvt_pk_bf16_f32 v193, v154, v155
    v_cvt_pk_bf16_f32 v194, v156, v157
    v_cvt_pk_bf16_f32 v195, v158, v159
    s_waitcnt lgkmcnt(0)
    v_mfma_f32_16x16x32_bf16 v[144:147], v[164:167], v[188:191], v[204:207]
    v_mfma_f32_16x16x32_bf16 v[148:151], v[168:171], v[188:191], v[196:199]
    v_mfma_f32_16x16x32_bf16 v[152:155], v[168:171], v[192:195], v[200:203]
    v_mfma_f32_16x16x32_bf16 v[156:159], v[172:175], v[192:195], v[196:199]
    s_nop 5
    v_max3_f32 v208, v144, v145, v148
    s_nop 0
    v_max3_f32 v212, v152, v153, v156
    v_max3_f32 v209, v146, v147, v150
    v_max3_f32 v213, v154, v155, v158
    v_max_f32 v208, v208, v149
    v_max_f32 v212, v212, v157
    v_max_f32 v209, v209, v151
    v_max_f32 v213, v213, v159
    v_max_f32 v210, v208, v209
    v_max_f32 v214, v212, v213
    v_mov_b32 v211, v210
    v_mov_b32 v215, v214
    s_nop 0
    v_permlane16_swap_b32 v210, v211
    v_permlane16_swap_b32 v214, v215
    v_max_f32 v210, v210, v211
    v_max_f32 v214, v214, v215
    v_mov_b32 v211, v210
    v_mov_b32 v215, v214
    s_nop 0
    v_permlane32_swap_b32 v210, v211
    v_permlane32_swap_b32 v214, v215
    v_max_f32 v210, v210, v211
    v_max_f32 v214, v214, v215
    v_sub_f32 v208, v208, v210
    v_sub_f32 v212, v212, v214
    v_sub_f32 v209, v209, v210
    v_sub_f32 v213, v213, v214
    v_exp_f32 v208, v208
    v_exp_f32 v212, v212
    v_exp_f32 v209, v209
    v_exp_f32 v213, v213
    v_add_f32 v210, v208, v209
    v_add_f32 v214, v212, v213
    v_mov_b32 v211, v210
    v_mov_b32 v215, v214
    s_nop 0
    v_permlane16_swap_b32 v210, v211
    v_permlane16_swap_b32 v214, v215
    v_add_f32 v210, v210, v211
    v_add_f32 v214, v214, v215
    v_mov_b32 v211, v210
    v_mov_b32 v215, v214
    s_nop 0
    v_permlane32_swap_b32 v210, v211
    v_permlane32_swap_b32 v214, v215
    v_add_f32 v210, v210, v211
    v_add_f32 v214, v214, v215
    v_rcp_f32 v210, v210
    v_rcp_f32 v214, v214
    v_mul_f32 v208, v208, v210
    v_mul_f32 v212, v212, v214
    v_mul_f32 v209, v209, v210
    v_mul_f32 v213, v213, v214
    v_cvt_pk_bf16_f32 v208, v208, v208
    v_cvt_pk_bf16_f32 v212, v212, v212
    v_cvt_pk_bf16_f32 v209, v209, v209
    v_cvt_pk_bf16_f32 v213, v213, v213
    v_and_b32 v216, v244, v208
    v_and_b32 v220, v244, v212
    v_and_b32 v217, v245, v209
    v_and_b32 v221, v245, v213
    v_and_b32 v218, v246, v208
    v_and_b32 v222, v246, v212
    v_and_b32 v219, v247, v209
    v_and_b32 v223, v247, v213
    s_nop 0
    v_mfma_f32_16x16x32_bf16 v[144:147], v[176:179], v[216:219], 0
    v_mfma_f32_16x16x32_bf16 v[148:151], v[182:185], v[216:219], 0
    v_mfma_f32_16x16x32_bf16 v[152:155], v[178:181], v[220:223], 0
    v_mfma_f32_16x16x32_bf16 v[156:159], v[184:187], v[220:223], 0
    s_nop 4
    v_cvt_pk_bf16_f32 v224, v144, v145
    v_cvt_pk_bf16_f32 v225, v146, v147
    v_cvt_pk_bf16_f32 v226, v148, v149
    v_cvt_pk_bf16_f32 v227, v150, v151
    v_and_b32 v226, v21, v226
    v_and_b32 v227, v21, v227
    buffer_store_dwordx4 v[224:227], v22, s[36:39], s79 offen offset:0 sc1
    v_cvt_pk_bf16_f32 v228, v152, v153
    v_cvt_pk_bf16_f32 v229, v154, v155
    v_cvt_pk_bf16_f32 v230, v156, v157
    v_cvt_pk_bf16_f32 v231, v158, v159
    v_and_b32 v230, v21, v230
    v_and_b32 v231, v21, v231
    buffer_store_dwordx4 v[228:231], v22, s[36:39], s79 offen offset:256 sc1
    s_lshl_b32 s72, s61, 12
    s_lshl_b32 s73, s63, 8
    s_add_u32 s72, s72, s73
    s_lshl_b32 s73, s62, 5
    s_add_u32 s72, s72, s73
    s_lshl_b32 s73, s60, 2
    s_add_u32 s72, s72, s73
    s_add_u32 s72, s72, 262144
    s_branch L_P2
L_Q1:
    ds_read_b128 v[32:35], v8 offset:0
    ds_read_b128 v[88:91], v8 offset:14336
    ds_read_b64_tr_b16 v[208:209], v26 offset:24576
    ds_read_b64_tr_b16 v[210:211], v26 offset:25088
    ds_read_b64_tr_b16 v[212:213], v27 offset:24576
    ds_read_b64_tr_b16 v[214:215], v27 offset:25088
    ds_read_b128 v[232:235], v10 offset:0
    ds_read_b128 v[36:39], v9 offset:0
    ds_read_b128 v[92:95], v9 offset:14336
    ds_read_b64_tr_b16 v[216:217], v26 offset:28672
    ds_read_b64_tr_b16 v[218:219], v26 offset:29184
    ds_read_b64_tr_b16 v[220:221], v27 offset:28672
    ds_read_b64_tr_b16 v[222:223], v27 offset:29184
    ds_read_b128 v[236:239], v11 offset:0
    s_waitcnt lgkmcnt(7)
    v_mfma_f32_16x16x32_bf16 v[144:147], v[208:211], v[32:35], 0
    v_mfma_f32_16x16x32_bf16 v[148:151], v[212:215], v[32:35], 0
    v_mfma_f32_16x16x32_bf16 v[152:155], v[208:211], v[88:91], 0
    v_mfma_f32_16x16x32_bf16 v[156:159], v[212:215], v[88:91], 0
    v_mfma_f32_16x16x32_bf16 v[160:163], v[212:215], v[232:235], 0
    ds_read_b64_tr_b16 v[224:225], v26 offset:32768
    ds_read_b64_tr_b16 v[226:227], v26 offset:33280
    ds_read_b64_tr_b16 v[228:229], v27 offset:32768
    ds_read_b64_tr_b16 v[230:231], v27 offset:33280
    ds_read_b128 v[240:243], v10 offset:128
    ds_read_b128 v[40:43], v8 offset:128
    ds_read_b128 v[96:99], v8 offset:14464
    ds_read_b128 v[44:47], v9 offset:128
    ds_read_b128 v[100:103], v9 offset:14464
    ds_read_b128 v[48:51], v8 offset:256
    ds_read_b128 v[104:107], v8 offset:14592
    ds_read_b128 v[52:55], v9 offset:256
    ds_read_b128 v[108:111], v9 offset:14592
    s_waitcnt lgkmcnt(13)
    v_mfma_f32_16x16x32_bf16 v[144:147], v[216:219], v[36:39], v[144:147]
    v_mfma_f32_16x16x32_bf16 v[148:151], v[220:223], v[36:39], v[148:151]
    v_mfma_f32_16x16x32_bf16 v[152:155], v[216:219], v[92:95], v[152:155]
    v_mfma_f32_16x16x32_bf16 v[156:159], v[220:223], v[92:95], v[156:159]
    v_mfma_f32_16x16x32_bf16 v[160:163], v[220:223], v[236:239], v[160:163]
    ds_read_b64_tr_b16 v[208:209], v26 offset:36864
    ds_read_b64_tr_b16 v[210:211], v26 offset:37376
    ds_read_b64_tr_b16 v[212:213], v27 offset:36864
    ds_read_b64_tr_b16 v[214:215], v27 offset:37376
    ds_read_b128 v[232:235], v11 offset:128
    ds_read_b128 v[56:59], v8 offset:384
    ds_read_b128 v[112:115], v8 offset:14720
    ds_read_b128 v[60:63], v9 offset:384
    ds_read_b128 v[116:119], v9 offset:14720
    ds_read_b128 v[64:67], v8 offset:512
    ds_read_b128 v[120:123], v8 offset:14848
    ds_read_b128 v[68:71], v9 offset:512
    ds_read_b128 v[124:127], v9 offset:14848
    s_getpc_b64 s[72:73]
L_pc2:
    s_sub_u32 s72, s72, L_pc2-recurrent_scan__sliding_local_dilated__mixer_channel_mlp__prompt_kernel
    s_subb_u32 s73, s73, 0
    s_lshl_b32 s70, s69, 11
    s_lshr_b32 s71, s66, 1
    s_add_u32 s70, s70, s71
    v_and_b32 v12, 3, v1
    v_lshlrev_b32 v12, 7, v12
    v_add_u32 v12, s70, v12
    s_mov_b32 s70, L_END-recurrent_scan__sliding_local_dilated__mixer_channel_mlp__prompt_kernel
    v_min_u32 v12, s70, v12
    s_mov_b64 exec, 15
    global_load_dword v254, v12, s[72:73]
    s_mov_b64 exec, -1
    s_cmp_eq_u32 s60, 0
    s_cselect_b64 s[72:73], s[12:13], s[72:73]
    s_cselect_b32 s70, 6272, s70
    s_cmp_eq_u32 s60, 1
    s_cselect_b64 s[72:73], s[8:9], s[72:73]
    s_cselect_b32 s70, 1568, s70
    s_cmp_eq_u32 s60, 2
    s_cselect_b64 s[72:73], s[16:17], s[72:73]
    s_cselect_b32 s70, 6272, s70
    s_cmp_eq_u32 s60, 3
    s_cselect_b64 s[72:73], s[10:11], s[72:73]
    s_cselect_b32 s70, 4704, s70
    s_sub_u32 s71, s70, 4
    s_mul_i32 s70, s70, s2
    v_min_u32 v12, s71, v255
    v_add_u32 v12, s70, v12
    global_load_dword v254, v12, s[72:73]
    s_waitcnt lgkmcnt(15)
    v_mfma_f32_16x16x32_bf16 v[144:147], v[224:227], v[40:43], v[144:147]
    v_mfma_f32_16x16x32_bf16 v[148:151], v[228:231], v[40:43], v[148:151]
    v_mfma_f32_16x16x32_bf16 v[152:155], v[224:227], v[96:99], v[152:155]
    v_mfma_f32_16x16x32_bf16 v[156:159], v[228:231], v[96:99], v[156:159]
    v_mfma_f32_16x16x32_bf16 v[160:163], v[228:231], v[240:243], v[160:163]
    ds_read_b128 v[72:75], v8 offset:640
    ds_read_b128 v[128:131], v8 offset:14976
    ds_read_b128 v[76:79], v9 offset:640
    ds_read_b128 v[132:135], v9 offset:14976
    ds_read_b128 v[80:83], v8 offset:768
    ds_read_b128 v[136:139], v8 offset:15104
    ds_read_b128 v[84:87], v9 offset:768
    ds_read_b128 v[140:143], v9 offset:15104
    s_waitcnt lgkmcnt(15)
    v_mfma_f32_16x16x32_bf16 v[144:147], v[208:211], v[44:47], v[144:147]
    v_mfma_f32_16x16x32_bf16 v[148:151], v[212:215], v[44:47], v[148:151]
    v_mfma_f32_16x16x32_bf16 v[152:155], v[208:211], v[100:103], v[152:155]
    v_mfma_f32_16x16x32_bf16 v[156:159], v[212:215], v[100:103], v[156:159]
    v_mfma_f32_16x16x32_bf16 v[160:163], v[212:215], v[232:235], v[160:163]
    s_waitcnt lgkmcnt(0)
    s_waitcnt vmcnt(13)
    s_barrier
    ds_read_b64_tr_b16 v[216:217], v26 offset:40960
    ds_read_b64_tr_b16 v[218:219], v26 offset:41472
    ds_read_b64_tr_b16 v[220:221], v27 offset:40960
    ds_read_b64_tr_b16 v[222:223], v27 offset:41472
    ds_read_b128 v[236:239], v10 offset:256
    ds_read_b64_tr_b16 v[224:225], v26 offset:45056
    ds_read_b64_tr_b16 v[226:227], v26 offset:45568
    ds_read_b64_tr_b16 v[228:229], v27 offset:45056
    ds_read_b64_tr_b16 v[230:231], v27 offset:45568
    ds_read_b128 v[240:243], v11 offset:256
    s_waitcnt lgkmcnt(5)
    v_mfma_f32_16x16x32_bf16 v[144:147], v[216:219], v[48:51], v[144:147]
    v_mfma_f32_16x16x32_bf16 v[148:151], v[220:223], v[48:51], v[148:151]
    v_mfma_f32_16x16x32_bf16 v[152:155], v[216:219], v[104:107], v[152:155]
    v_mfma_f32_16x16x32_bf16 v[156:159], v[220:223], v[104:107], v[156:159]
    v_mfma_f32_16x16x32_bf16 v[160:163], v[220:223], v[236:239], v[160:163]
    ds_read_b64_tr_b16 v[208:209], v26 offset:49152
    ds_read_b64_tr_b16 v[210:211], v26 offset:49664
    ds_read_b64_tr_b16 v[212:213], v27 offset:49152
    ds_read_b64_tr_b16 v[214:215], v27 offset:49664
    ds_read_b128 v[232:235], v10 offset:384
    s_waitcnt vmcnt(12)
    ds_write_b128 v251, v[164:167] offset:40960
    s_waitcnt vmcnt(11)
    ds_write_b128 v251, v[168:171] offset:45056
    s_waitcnt vmcnt(10)
    ds_write_b128 v251, v[172:175] offset:49152
    s_waitcnt vmcnt(9)
    ds_write_b128 v251, v[176:179] offset:53248
    s_waitcnt lgkmcnt(9)
    v_mfma_f32_16x16x32_bf16 v[144:147], v[224:227], v[52:55], v[144:147]
    v_mfma_f32_16x16x32_bf16 v[148:151], v[228:231], v[52:55], v[148:151]
    v_mfma_f32_16x16x32_bf16 v[152:155], v[224:227], v[108:111], v[152:155]
    v_mfma_f32_16x16x32_bf16 v[156:159], v[228:231], v[108:111], v[156:159]
    v_mfma_f32_16x16x32_bf16 v[160:163], v[228:231], v[240:243], v[160:163]
    ds_read_b64_tr_b16 v[216:217], v26 offset:53248
    ds_read_b64_tr_b16 v[218:219], v26 offset:53760
    ds_read_b64_tr_b16 v[220:221], v27 offset:53248
    ds_read_b64_tr_b16 v[222:223], v27 offset:53760
    ds_read_b128 v[236:239], v11 offset:384
    s_waitcnt vmcnt(8)
    ds_write_b128 v251, v[180:183] offset:57344
    s_waitcnt vmcnt(7)
    ds_write_b128 v251, v[184:187] offset:61440
    s_waitcnt lgkmcnt(11)
    v_mfma_f32_16x16x32_bf16 v[144:147], v[208:211], v[56:59], v[144:147]
    v_mfma_f32_16x16x32_bf16 v[148:151], v[212:215], v[56:59], v[148:151]
    v_mfma_f32_16x16x32_bf16 v[152:155], v[208:211], v[112:115], v[152:155]
    v_mfma_f32_16x16x32_bf16 v[156:159], v[212:215], v[112:115], v[156:159]
    v_mfma_f32_16x16x32_bf16 v[160:163], v[212:215], v[232:235], v[160:163]
    s_waitcnt lgkmcnt(0)
    s_barrier
    ds_read_b64_tr_b16 v[224:225], v26 offset:0
    ds_read_b64_tr_b16 v[226:227], v26 offset:512
    ds_read_b64_tr_b16 v[228:229], v27 offset:0
    ds_read_b64_tr_b16 v[230:231], v27 offset:512
    ds_read_b128 v[240:243], v10 offset:512
    s_waitcnt vmcnt(6)
    ds_write_b128 v250, v[188:191] offset:0
    v_mfma_f32_16x16x32_bf16 v[144:147], v[216:219], v[60:63], v[144:147]
    v_mfma_f32_16x16x32_bf16 v[148:151], v[220:223], v[60:63], v[148:151]
    v_mfma_f32_16x16x32_bf16 v[152:155], v[216:219], v[116:119], v[152:155]
    v_mfma_f32_16x16x32_bf16 v[156:159], v[220:223], v[116:119], v[156:159]
    v_mfma_f32_16x16x32_bf16 v[160:163], v[220:223], v[236:239], v[160:163]
    ds_read_b64_tr_b16 v[208:209], v26 offset:4096
    ds_read_b64_tr_b16 v[210:211], v26 offset:4608
    ds_read_b64_tr_b16 v[212:213], v27 offset:4096
    ds_read_b64_tr_b16 v[214:215], v27 offset:4608
    ds_read_b128 v[232:235], v11 offset:512
    s_waitcnt vmcnt(5)
    ds_write_b128 v250, v[192:195] offset:4096
    s_waitcnt lgkmcnt(7)
    v_mfma_f32_16x16x32_bf16 v[144:147], v[224:227], v[64:67], v[144:147]
    v_mfma_f32_16x16x32_bf16 v[148:151], v[228:231], v[64:67], v[148:151]
    v_mfma_f32_16x16x32_bf16 v[152:155], v[224:227], v[120:123], v[152:155]
    v_mfma_f32_16x16x32_bf16 v[156:159], v[228:231], v[120:123], v[156:159]
    v_mfma_f32_16x16x32_bf16 v[160:163], v[228:231], v[240:243], v[160:163]
    ds_read_b64_tr_b16 v[216:217], v26 offset:8192
    ds_read_b64_tr_b16 v[218:219], v26 offset:8704
    ds_read_b64_tr_b16 v[220:221], v27 offset:8192
    ds_read_b64_tr_b16 v[222:223], v27 offset:8704
    ds_read_b128 v[236:239], v10 offset:640
    s_waitcnt vmcnt(4)
    ds_write_b128 v250, v[196:199] offset:8192
    s_waitcnt lgkmcnt(7)
    v_mfma_f32_16x16x32_bf16 v[144:147], v[208:211], v[68:71], v[144:147]
    v_mfma_f32_16x16x32_bf16 v[148:151], v[212:215], v[68:71], v[148:151]
    v_mfma_f32_16x16x32_bf16 v[152:155], v[208:211], v[124:127], v[152:155]
    v_mfma_f32_16x16x32_bf16 v[156:159], v[212:215], v[124:127], v[156:159]
    v_mfma_f32_16x16x32_bf16 v[160:163], v[212:215], v[232:235], v[160:163]
    ds_read_b64_tr_b16 v[224:225], v26 offset:12288
    ds_read_b64_tr_b16 v[226:227], v26 offset:12800
    ds_read_b64_tr_b16 v[228:229], v27 offset:12288
    ds_read_b64_tr_b16 v[230:231], v27 offset:12800
    ds_read_b128 v[240:243], v11 offset:640
    s_waitcnt vmcnt(3)
    ds_write_b128 v250, v[200:203] offset:12288
    s_waitcnt lgkmcnt(7)
    v_mfma_f32_16x16x32_bf16 v[144:147], v[216:219], v[72:75], v[144:147]
    v_mfma_f32_16x16x32_bf16 v[148:151], v[220:223], v[72:75], v[148:151]
    v_mfma_f32_16x16x32_bf16 v[152:155], v[216:219], v[128:131], v[152:155]
    v_mfma_f32_16x16x32_bf16 v[156:159], v[220:223], v[128:131], v[156:159]
    v_mfma_f32_16x16x32_bf16 v[160:163], v[220:223], v[236:239], v[160:163]
    ds_read_b64_tr_b16 v[208:209], v26 offset:16384
    ds_read_b64_tr_b16 v[210:211], v26 offset:16896
    ds_read_b64_tr_b16 v[212:213], v27 offset:16384
    ds_read_b64_tr_b16 v[214:215], v27 offset:16896
    ds_read_b128 v[232:235], v10 offset:768
    s_waitcnt vmcnt(2)
    ds_write_b128 v250, v[204:207] offset:16384
    s_waitcnt lgkmcnt(7)
    v_mfma_f32_16x16x32_bf16 v[144:147], v[224:227], v[76:79], v[144:147]
    v_mfma_f32_16x16x32_bf16 v[148:151], v[228:231], v[76:79], v[148:151]
    v_mfma_f32_16x16x32_bf16 v[152:155], v[224:227], v[132:135], v[152:155]
    v_mfma_f32_16x16x32_bf16 v[156:159], v[228:231], v[132:135], v[156:159]
    v_mfma_f32_16x16x32_bf16 v[160:163], v[228:231], v[240:243], v[160:163]
    s_waitcnt lgkmcnt(0)
    s_barrier
    ds_read_b64_tr_b16 v[216:217], v26 offset:20480
    ds_read_b64_tr_b16 v[218:219], v26 offset:20992
    ds_read_b64_tr_b16 v[220:221], v27 offset:20480
    ds_read_b64_tr_b16 v[222:223], v27 offset:20992
    ds_read_b128 v[236:239], v11 offset:768
    s_add_u32 m0, s66, 131072
    s_add_u32 s74, s76, 0
    buffer_load_dwordx4 v4, s[32:35], s74 offen lds
    s_add_u32 m0, s66, 139264
    s_add_u32 s74, s76, 172032
    buffer_load_dwordx4 v4, s[32:35], s74 offen lds
    v_mfma_f32_16x16x32_bf16 v[144:147], v[208:211], v[80:83], v[144:147]
    v_mfma_f32_16x16x32_bf16 v[148:151], v[212:215], v[80:83], v[148:151]
    v_mfma_f32_16x16x32_bf16 v[152:155], v[208:211], v[136:139], v[152:155]
    v_mfma_f32_16x16x32_bf16 v[156:159], v[212:215], v[136:139], v[156:159]
    v_mfma_f32_16x16x32_bf16 v[160:163], v[212:215], v[232:235], v[160:163]
    ds_read_b64_tr_b16 v[224:225], v24 offset:0
    ds_read_b64_tr_b16 v[226:227], v24 offset:512
    ds_read_b64_tr_b16 v[228:229], v25 offset:0
    ds_read_b64_tr_b16 v[230:231], v25 offset:512
    s_add_u32 m0, s66, 147456
    s_add_u32 s74, s76, 344064
    buffer_load_dwordx4 v4, s[32:35], s74 offen lds
    v_and_b32 v12, 15, v1
    v_lshrrev_b32 v13, 4, v1
    v_lshlrev_b32 v13, 2, v13
    v_sub_u32 v12, v12, v13
    v_mov_b32 v14, 0xf149f2ca
    v_mov_b32 v15, 0
    s_or_b32 s82, s81, s61
    s_cmp_eq_u32 s82, 0
    s_cselect_b32 s78, 0xf149f2ca, 0
    s_waitcnt lgkmcnt(4)
    v_mfma_f32_16x16x32_bf16 v[144:147], v[216:219], v[84:87], v[144:147]
    v_mfma_f32_16x16x32_bf16 v[148:151], v[220:223], v[84:87], v[148:151]
    v_mfma_f32_16x16x32_bf16 v[152:155], v[216:219], v[140:143], v[152:155]
    v_mfma_f32_16x16x32_bf16 v[156:159], v[220:223], v[140:143], v[156:159]
    v_mfma_f32_16x16x32_bf16 v[160:163], v[220:223], v[236:239], v[160:163]
    ds_read_b64_tr_b16 v[208:209], v24 offset:4096
    ds_read_b64_tr_b16 v[210:211], v24 offset:4608
    ds_read_b64_tr_b16 v[212:213], v25 offset:4096
    ds_read_b64_tr_b16 v[214:215], v25 offset:4608
    s_add_u32 m0, s66, 155648
    s_add_u32 s74, s76, 516096
    buffer_load_dwordx4 v4, s[32:35], s74 offen lds
    v_subrev_u32 v13, 0, v12
    v_and_b32 v19, 0x80000001, v13
    v_cmp_eq_u32 vcc, 0, v19
    v_mov_b32 v20, 0x0000ffff
    s_nop 0
    v_cndmask_b32 v196, v14, v15, vcc
    v_cndmask_b32 v21, v15, v20, vcc
    v_cvt_pk_bf16_f32 v168, v144, v145
    v_cvt_pk_bf16_f32 v169, v146, v147
    v_cvt_pk_bf16_f32 v170, v148, v149
    v_cvt_pk_bf16_f32 v171, v150, v151
    v_cvt_pk_bf16_f32 v172, v152, v153
    v_cvt_pk_bf16_f32 v173, v154, v155
    v_cvt_pk_bf16_f32 v174, v156, v157
    v_cvt_pk_bf16_f32 v175, v158, v159
    ds_write_b128 v29, v[172:175]
    v_cvt_pk_bf16_f32 v248, v160, v161
    v_cvt_pk_bf16_f32 v249, v162, v163
    ds_write_b64 v18, v[248:249] offset:8
    s_waitcnt lgkmcnt(6)
    v_mfma_f32_16x16x32_bf16 v[144:147], v[32:35], v[224:227], 0
    v_mfma_f32_16x16x32_bf16 v[148:151], v[32:35], v[228:231], 0
    v_mfma_f32_16x16x32_bf16 v[152:155], v[88:91], v[224:227], 0
    v_mfma_f32_16x16x32_bf16 v[156:159], v[88:91], v[228:231], 0
    s_barrier
    ds_read_b64_tr_b16 v[216:217], v24 offset:8192
    ds_read_b64_tr_b16 v[218:219], v24 offset:8704
    ds_read_b64_tr_b16 v[220:221], v25 offset:8192
    ds_read_b64_tr_b16 v[222:223], v25 offset:8704
    s_add_u32 m0, s66, 106496
    s_add_u32 s74, s76, 688128
    buffer_load_dwordx4 v4, s[32:35], s74 offen lds
    v_cmp_eq_u32 vcc, 0x80000000, v19
    s_nop 1
    v_cndmask_b32 v200, v14, v15, vcc
    v_cndmask_b32 v252, v15, v20, vcc
    v_min_f32 v204, s78, v200
    s_waitcnt lgkmcnt(6)
    v_mfma_f32_16x16x32_bf16 v[144:147], v[36:39], v[208:211], v[144:147]
    v_mfma_f32_16x16x32_bf16 v[148:151], v[36:39], v[212:215], v[148:151]
    v_mfma_f32_16x16x32_bf16 v[152:155], v[92:95], v[208:211], v[152:155]
    v_mfma_f32_16x16x32_bf16 v[156:159], v[92:95], v[212:215], v[156:159]
    ds_read_b64_tr_b16 v[224:225], v24 offset:12288
    ds_read_b64_tr_b16 v[226:227], v24 offset:12800
    ds_read_b64_tr_b16 v[228:229], v25 offset:12288
    ds_read_b64_tr_b16 v[230:231], v25 offset:12800
    s_add_u32 m0, s66, 114688
    s_add_u32 s74, s76, 860160
    buffer_load_dwordx4 v4, s[32:35], s74 offen lds
    v_subrev_u32 v13, 1, v12
    v_and_b32 v19, 0x80000001, v13
    v_cmp_eq_u32 vcc, 0, v19
    v_mov_b32 v20, 0xffff0000
    s_nop 0
    v_cndmask_b32 v197, v14, v15, vcc
    v_cndmask_b32 v22, v15, v20, vcc
    s_waitcnt lgkmcnt(4)
    v_mfma_f32_16x16x32_bf16 v[144:147], v[40:43], v[216:219], v[144:147]
    v_mfma_f32_16x16x32_bf16 v[148:151], v[40:43], v[220:223], v[148:151]
    v_mfma_f32_16x16x32_bf16 v[152:155], v[96:99], v[216:219], v[152:155]
    v_mfma_f32_16x16x32_bf16 v[156:159], v[96:99], v[220:223], v[156:159]
    ds_read_b64_tr_b16 v[208:209], v24 offset:16384
    ds_read_b64_tr_b16 v[210:211], v24 offset:16896
    ds_read_b64_tr_b16 v[212:213], v25 offset:16384
    ds_read_b64_tr_b16 v[214:215], v25 offset:16896
    s_add_u32 m0, s66, 122880
    s_add_u32 s74, s76, 1032192
    buffer_load_dwordx4 v4, s[32:35], s74 offen lds
    v_cmp_eq_u32 vcc, 0x80000000, v19
    v_or_b32 v246, v21, v22
    s_waitcnt lgkmcnt(4)
    v_mfma_f32_16x16x32_bf16 v[144:147], v[44:47], v[224:227], v[144:147]
    v_mfma_f32_16x16x32_bf16 v[148:151], v[44:47], v[228:231], v[148:151]
    v_mfma_f32_16x16x32_bf16 v[152:155], v[100:103], v[224:227], v[152:155]
    v_mfma_f32_16x16x32_bf16 v[156:159], v[100:103], v[228:231], v[156:159]
    s_barrier
    ds_read_b64_tr_b16 v[216:217], v24 offset:20480
    ds_read_b64_tr_b16 v[218:219], v24 offset:20992
    ds_read_b64_tr_b16 v[220:221], v25 offset:20480
    ds_read_b64_tr_b16 v[222:223], v25 offset:20992
    v_cndmask_b32 v201, v14, v15, vcc
    v_cndmask_b32 v253, v15, v20, vcc
    v_or_b32 v244, v252, v253
    v_min_f32 v205, s78, v201
    s_waitcnt lgkmcnt(4)
    v_mfma_f32_16x16x32_bf16 v[144:147], v[48:51], v[208:211], v[144:147]
    v_mfma_f32_16x16x32_bf16 v[148:151], v[48:51], v[212:215], v[148:151]
    v_mfma_f32_16x16x32_bf16 v[152:155], v[104:107], v[208:211], v[152:155]
    v_mfma_f32_16x16x32_bf16 v[156:159], v[104:107], v[212:215], v[156:159]
    ds_read_b64_tr_b16 v[224:225], v24 offset:24576
    ds_read_b64_tr_b16 v[226:227], v24 offset:25088
    ds_read_b64_tr_b16 v[228:229], v25 offset:24576
    ds_read_b64_tr_b16 v[230:231], v25 offset:25088
    v_subrev_u32 v13, 2, v12
    v_and_b32 v19, 0x80000001, v13
    v_cmp_eq_u32 vcc, 0, v19
    v_mov_b32 v20, 0x0000ffff
    s_nop 0
    v_cndmask_b32 v198, v14, v15, vcc
    v_cndmask_b32 v21, v15, v20, vcc
    s_waitcnt lgkmcnt(4)
    v_mfma_f32_16x16x32_bf16 v[144:147], v[52:55], v[216:219], v[144:147]
    v_mfma_f32_16x16x32_bf16 v[148:151], v[52:55], v[220:223], v[148:151]
    v_mfma_f32_16x16x32_bf16 v[152:155], v[108:111], v[216:219], v[152:155]
    v_mfma_f32_16x16x32_bf16 v[156:159], v[108:111], v[220:223], v[156:159]
    ds_read_b64_tr_b16 v[208:209], v24 offset:28672
    ds_read_b64_tr_b16 v[210:211], v24 offset:29184
    ds_read_b64_tr_b16 v[212:213], v25 offset:28672
    ds_read_b64_tr_b16 v[214:215], v25 offset:29184
    v_mul_u32_u24 v251, 7, v255
    s_and_b32 s75, s64, 3
    s_lshl_b32 s75, s75, 3
    s_add_u32 s75, s75, s60
    s_lshl_b32 s74, s75, 5
    s_cmp_ge_u32 s75, 12
    s_cselect_b32 s73, 256, 0
    s_add_u32 s74, s74, s73
    s_cmp_ge_u32 s75, 22
    s_cselect_b32 s73, 256, 0
    s_add_u32 s74, s74, s73
    s_mul_i32 s74, s74, 896
    s_add_u32 s74, s74, s65
    s_mov_b64 exec, 0xffffffff
    buffer_load_dword v254, v251, s[44:47], s74 offen sc1
    s_mul_i32 s74, s75, 7168
    s_add_u32 s74, s74, s65
    s_mov_b64 exec, 0xff
    buffer_load_dword v254, v251, s[48:51], s74 offen sc1
    s_mov_b64 exec, -1
    v_cmp_eq_u32 vcc, 0x80000000, v19
    s_nop 1
    v_cndmask_b32 v202, v14, v15, vcc
    v_cndmask_b32 v252, v15, v20, vcc
    v_min_f32 v206, s78, v202
    s_waitcnt lgkmcnt(4)
    v_mfma_f32_16x16x32_bf16 v[144:147], v[56:59], v[224:227], v[144:147]
    v_mfma_f32_16x16x32_bf16 v[148:151], v[56:59], v[228:231], v[148:151]
    v_mfma_f32_16x16x32_bf16 v[152:155], v[112:115], v[224:227], v[152:155]
    v_mfma_f32_16x16x32_bf16 v[156:159], v[112:115], v[228:231], v[156:159]
    ds_read_b64_tr_b16 v[216:217], v24 offset:32768
    ds_read_b64_tr_b16 v[218:219], v24 offset:33280
    ds_read_b64_tr_b16 v[220:221], v25 offset:32768
    ds_read_b64_tr_b16 v[222:223], v25 offset:33280
    v_subrev_u32 v13, 3, v12
    v_and_b32 v19, 0x80000001, v13
    v_cmp_eq_u32 vcc, 0, v19
    v_mov_b32 v20, 0xffff0000
    s_nop 0
    v_cndmask_b32 v199, v14, v15, vcc
    v_cndmask_b32 v22, v15, v20, vcc
    s_waitcnt lgkmcnt(4)
    v_mfma_f32_16x16x32_bf16 v[144:147], v[60:63], v[208:211], v[144:147]
    v_mfma_f32_16x16x32_bf16 v[148:151], v[60:63], v[212:215], v[148:151]
    v_mfma_f32_16x16x32_bf16 v[152:155], v[116:119], v[208:211], v[152:155]
    v_mfma_f32_16x16x32_bf16 v[156:159], v[116:119], v[212:215], v[156:159]
    ds_read_b64_tr_b16 v[224:225], v24 offset:36864
    ds_read_b64_tr_b16 v[226:227], v24 offset:37376
    ds_read_b64_tr_b16 v[228:229], v25 offset:36864
    ds_read_b64_tr_b16 v[230:231], v25 offset:37376
    v_cmp_eq_u32 vcc, 0x80000000, v19
    v_or_b32 v247, v21, v22
    s_waitcnt lgkmcnt(4)
    v_mfma_f32_16x16x32_bf16 v[144:147], v[64:67], v[216:219], v[144:147]
    v_mfma_f32_16x16x32_bf16 v[148:151], v[64:67], v[220:223], v[148:151]
    v_mfma_f32_16x16x32_bf16 v[152:155], v[120:123], v[216:219], v[152:155]
    v_mfma_f32_16x16x32_bf16 v[156:159], v[120:123], v[220:223], v[156:159]
    ds_read_b64_tr_b16 v[208:209], v24 offset:40960
    ds_read_b64_tr_b16 v[210:211], v24 offset:41472
    ds_read_b64_tr_b16 v[212:213], v25 offset:40960
    ds_read_b64_tr_b16 v[214:215], v25 offset:41472
    v_cndmask_b32 v203, v14, v15, vcc
    v_cndmask_b32 v253, v15, v20, vcc
    v_or_b32 v245, v252, v253
    v_min_f32 v207, s78, v203
    s_waitcnt lgkmcnt(4)
    v_mfma_f32_16x16x32_bf16 v[144:147], v[68:71], v[224:227], v[144:147]
    v_mfma_f32_16x16x32_bf16 v[148:151], v[68:71], v[228:231], v[148:151]
    v_mfma_f32_16x16x32_bf16 v[152:155], v[124:127], v[224:227], v[152:155]
    v_mfma_f32_16x16x32_bf16 v[156:159], v[124:127], v[228:231], v[156:159]
    ds_read_b64_tr_b16 v[216:217], v24 offset:45056
    ds_read_b64_tr_b16 v[218:219], v24 offset:45568
    ds_read_b64_tr_b16 v[220:221], v25 offset:45056
    ds_read_b64_tr_b16 v[222:223], v25 offset:45568
    v_cmp_gt_u32 vcc, 48, v1
    v_mov_b32 v19, 0x3e8b97f6
    s_nop 0
    v_cndmask_b32 v20, v15, v19, vcc
    v_cndmask_b32 v21, 0, -1, vcc
    v_lshrrev_b32 v12, 4, v1
    v_and_b32 v13, 15, v1
    v_lshlrev_b32 v13, 4, v13
    v_lshl_add_u32 v22, v12, 9, v13
    s_waitcnt lgkmcnt(4)
    v_mfma_f32_16x16x32_bf16 v[144:147], v[72:75], v[208:211], v[144:147]
    v_mfma_f32_16x16x32_bf16 v[148:151], v[72:75], v[212:215], v[148:151]
    v_mfma_f32_16x16x32_bf16 v[152:155], v[128:131], v[208:211], v[152:155]
    v_mfma_f32_16x16x32_bf16 v[156:159], v[128:131], v[212:215], v[156:159]
    ds_read_b64_tr_b16 v[224:225], v24 offset:49152
    ds_read_b64_tr_b16 v[226:227], v24 offset:49664
    ds_read_b64_tr_b16 v[228:229], v25 offset:49152
    ds_read_b64_tr_b16 v[230:231], v25 offset:49664
    s_lshl_b32 s79, s61, 2
    s_add_u32 s79, s79, s81
    s_mul_i32 s79, s79, 145
    s_lshl_b32 s83, s62, 1
    s_add_u32 s82, s80, s83
    s_lshl_b32 s82, s82, 1
    s_add_u32 s79, s79, s82
    s_add_u32 s79, s79, 112
    s_lshl_b32 s79, s79, 10
    s_add_u32 s79, s79, 1048576
    s_waitcnt lgkmcnt(4)
    v_mfma_f32_16x16x32_bf16 v[144:147], v[76:79], v[216:219], v[144:147]
    v_mfma_f32_16x16x32_bf16 v[148:151], v[76:79], v[220:223], v[148:151]
    v_mfma_f32_16x16x32_bf16 v[152:155], v[132:135], v[216:219], v[152:155]
    v_mfma_f32_16x16x32_bf16 v[156:159], v[132:135], v[220:223], v[156:159]
    s_waitcnt vmcnt(5)
    s_barrier
    ds_read_b64_tr_b16 v[208:209], v24 offset:53248
    ds_read_b64_tr_b16 v[210:211], v24 offset:53760
    ds_read_b64_tr_b16 v[212:213], v25 offset:53248
    ds_read_b64_tr_b16 v[214:215], v25 offset:53760
    s_waitcnt lgkmcnt(4)
    v_mfma_f32_16x16x32_bf16 v[144:147], v[80:83], v[224:227], v[144:147]
    v_mfma_f32_16x16x32_bf16 v[148:151], v[80:83], v[228:231], v[148:151]
    v_mfma_f32_16x16x32_bf16 v[152:155], v[136:139], v[224:227], v[152:155]
    v_mfma_f32_16x16x32_bf16 v[156:159], v[136:139], v[228:231], v[156:159]
    ds_read_b64_tr_b16 v[216:217], v26 offset:24576
    ds_read_b64_tr_b16 v[218:219], v26 offset:25088
    ds_read_b64_tr_b16 v[220:221], v27 offset:24576
    ds_read_b64_tr_b16 v[222:223], v27 offset:25088
    s_waitcnt lgkmcnt(4)
    v_mfma_f32_16x16x32_bf16 v[144:147], v[84:87], v[208:211], v[144:147]
    v_mfma_f32_16x16x32_bf16 v[148:151], v[84:87], v[212:215], v[148:151]
    v_mfma_f32_16x16x32_bf16 v[152:155], v[140:143], v[208:211], v[152:155]
    v_mfma_f32_16x16x32_bf16 v[156:159], v[140:143], v[212:215], v[156:159]
    ds_read_b64_tr_b16 v[224:225], v26 offset:28672
    ds_read_b64_tr_b16 v[226:227], v26 offset:29184
    ds_read_b64_tr_b16 v[228:229], v27 offset:28672
    ds_read_b64_tr_b16 v[230:231], v27 offset:29184
    s_nop 0
    v_cvt_pk_bf16_f32 v178, v144, v145
    v_cvt_pk_bf16_f32 v179, v146, v147
    v_cvt_pk_bf16_f32 v184, v148, v149
    v_cvt_pk_bf16_f32 v185, v150, v151
    v_cvt_pk_bf16_f32 v180, v152, v153
    v_cvt_pk_bf16_f32 v181, v154, v155
    v_cvt_pk_bf16_f32 v186, v156, v157
    v_cvt_pk_bf16_f32 v187, v158, v159
    ds_write_b64 v29, v[180:181] offset:1024
    ds_write_b64 v29, v[186:187] offset:1032
    s_waitcnt lgkmcnt(6)
    v_mfma_f32_16x16x32_bf16 v[144:147], v[216:219], v[32:35], 0
    v_mfma_f32_16x16x32_bf16 v[148:151], v[220:223], v[32:35], 0
    v_mfma_f32_16x16x32_bf16 v[152:155], v[216:219], v[88:91], 0
    v_mfma_f32_16x16x32_bf16 v[156:159], v[220:223], v[88:91], 0
    ds_read_b64_tr_b16 v[208:209], v26 offset:32768
    ds_read_b64_tr_b16 v[210:211], v26 offset:33280
    ds_read_b64_tr_b16 v[212:213], v27 offset:32768
    ds_read_b64_tr_b16 v[214:215], v27 offset:33280
    s_waitcnt lgkmcnt(6)
    v_mfma_f32_16x16x32_bf16 v[144:147], v[224:227], v[36:39], v[144:147]
    v_mfma_f32_16x16x32_bf16 v[148:151], v[228:231], v[36:39], v[148:151]
    v_mfma_f32_16x16x32_bf16 v[152:155], v[224:227], v[92:95], v[152:155]
    v_mfma_f32_16x16x32_bf16 v[156:159], v[228:231], v[92:95], v[156:159]
    s_waitcnt vmcnt(2)
    s_waitcnt lgkmcnt(4)
    s_barrier
    ds_read_b128 v[164:167], v28
    ds_read_b64 v[176:177], v28 offset:1024
    ds_read_b64 v[182:183], v28 offset:1032
    ds_read_b64_tr_b16 v[216:217], v26 offset:36864
    ds_read_b64_tr_b16 v[218:219], v26 offset:37376
    ds_read_b64_tr_b16 v[220:221], v27 offset:36864
    ds_read_b64_tr_b16 v[222:223], v27 offset:37376
    s_add_u32 m0, s66, 0
    s_add_u32 s74, s65, 344064
    buffer_load_dwordx4 v31, s[44:47], s74 offen lds
    s_add_u32 m0, s66, 8192
    s_add_u32 s74, s65, 401408
    buffer_load_dwordx4 v31, s[44:47], s74 offen lds
    s_waitcnt lgkmcnt(7)
    v_mfma_f32_16x16x32_bf16 v[144:147], v[208:211], v[40:43], v[144:147]
    v_mfma_f32_16x16x32_bf16 v[148:151], v[212:215], v[40:43], v[148:151]
    v_mfma_f32_16x16x32_bf16 v[152:155], v[208:211], v[96:99], v[152:155]
    v_mfma_f32_16x16x32_bf16 v[156:159], v[212:215], v[96:99], v[156:159]
    ds_read_b64_tr_b16 v[224:225], v26 offset:40960
    ds_read_b64_tr_b16 v[226:227], v26 offset:41472
    ds_read_b64_tr_b16 v[228:229], v27 offset:40960
    ds_read_b64_tr_b16 v[230:231], v27 offset:41472
    s_add_u32 m0, s66, 16384
    s_add_u32 s74, s65, 860160
    buffer_load_dwordx4 v31, s[44:47], s74 offen lds
    s_waitcnt lgkmcnt(4)
    v_mfma_f32_16x16x32_bf16 v[144:147], v[216:219], v[44:47], v[144:147]
    v_mfma_f32_16x16x32_bf16 v[148:151], v[220:223], v[44:47], v[148:151]
    v_mfma_f32_16x16x32_bf16 v[152:155], v[216:219], v[100:103], v[152:155]
    v_mfma_f32_16x16x32_bf16 v[156:159], v[220:223], v[100:103], v[156:159]
    ds_read_b64_tr_b16 v[208:209], v26 offset:45056
    ds_read_b64_tr_b16 v[210:211], v26 offset:45568
    ds_read_b64_tr_b16 v[212:213], v27 offset:45056
    ds_read_b64_tr_b16 v[214:215], v27 offset:45568
    s_add_u32 m0, s66, 24576
    s_add_u32 s74, s65, 917504
    buffer_load_dwordx4 v31, s[44:47], s74 offen lds
    s_waitcnt lgkmcnt(4)
    v_mfma_f32_16x16x32_bf16 v[144:147], v[224:227], v[48:51], v[144:147]
    v_mfma_f32_16x16x32_bf16 v[148:151], v[228:231], v[48:51], v[148:151]
    v_mfma_f32_16x16x32_bf16 v[152:155], v[224:227], v[104:107], v[152:155]
    v_mfma_f32_16x16x32_bf16 v[156:159], v[228:231], v[104:107], v[156:159]
    ds_read_b64_tr_b16 v[216:217], v26 offset:49152
    ds_read_b64_tr_b16 v[218:219], v26 offset:49664
    ds_read_b64_tr_b16 v[220:221], v27 offset:49152
    ds_read_b64_tr_b16 v[222:223], v27 offset:49664
    s_add_u32 m0, s66, 32768
    s_add_u32 s74, s65, 1376256
    buffer_load_dwordx4 v31, s[44:47], s74 offen lds
    s_waitcnt lgkmcnt(4)
    v_mfma_f32_16x16x32_bf16 v[144:147], v[208:211], v[52:55], v[144:147]
    v_mfma_f32_16x16x32_bf16 v[148:151], v[212:215], v[52:55], v[148:151]
    v_mfma_f32_16x16x32_bf16 v[152:155], v[208:211], v[108:111], v[152:155]
    v_mfma_f32_16x16x32_bf16 v[156:159], v[212:215], v[108:111], v[156:159]
    ds_read_b64_tr_b16 v[224:225], v26 offset:53248
    ds_read_b64_tr_b16 v[226:227], v26 offset:53760
    ds_read_b64_tr_b16 v[228:229], v27 offset:53248
    ds_read_b64_tr_b16 v[230:231], v27 offset:53760
    s_add_u32 m0, s66, 40960
    s_add_u32 s74, s65, 1433600
    buffer_load_dwordx4 v31, s[44:47], s74 offen lds
    s_add_u32 m0, s66, 49152
    s_add_u32 s74, s65, 200704
    buffer_load_dwordx4 v31, s[48:51], s74 offen lds
    s_waitcnt lgkmcnt(4)
    v_mfma_f32_16x16x32_bf16 v[144:147], v[216:219], v[56:59], v[144:147]
    v_mfma_f32_16x16x32_bf16 v[148:151], v[220:223], v[56:59], v[148:151]
    v_mfma_f32_16x16x32_bf16 v[152:155], v[216:219], v[112:115], v[152:155]
    v_mfma_f32_16x16x32_bf16 v[156:159], v[220:223], v[112:115], v[156:159]
    ds_read_b64_tr_b16 v[208:209], v26 offset:0
    ds_read_b64_tr_b16 v[210:211], v26 offset:512
    ds_read_b64_tr_b16 v[212:213], v27 offset:0
    ds_read_b64_tr_b16 v[214:215], v27 offset:512
    s_add_u32 m0, s66, 57344
    s_add_u32 s74, s65, 250880
    buffer_load_dwordx4 v31, s[48:51], s74 offen lds
    s_waitcnt lgkmcnt(4)
    v_mfma_f32_16x16x32_bf16 v[144:147], v[224:227], v[60:63], v[144:147]
    v_mfma_f32_16x16x32_bf16 v[148:151], v[228:231], v[60:63], v[148:151]
    v_mfma_f32_16x16x32_bf16 v[152:155], v[224:227], v[116:119], v[152:155]
    v_mfma_f32_16x16x32_bf16 v[156:159], v[228:231], v[116:119], v[156:159]
    ds_read_b64_tr_b16 v[216:217], v26 offset:4096
    ds_read_b64_tr_b16 v[218:219], v26 offset:4608
    ds_read_b64_tr_b16 v[220:221], v27 offset:4096
    ds_read_b64_tr_b16 v[222:223], v27 offset:4608
    s_add_u32 m0, s66, 65536
    s_add_u32 s74, s65, 458752
    buffer_load_dwordx4 v31, s[44:47], s74 offen lds
    s_waitcnt lgkmcnt(4)
    v_mfma_f32_16x16x32_bf16 v[144:147], v[208:211], v[64:67], v[144:147]
    v_mfma_f32_16x16x32_bf16 v[148:151], v[212:215], v[64:67], v[148:151]
    v_mfma_f32_16x16x32_bf16 v[152:155], v[208:211], v[120:123], v[152:155]
    v_mfma_f32_16x16x32_bf16 v[156:159], v[212:215], v[120:123], v[156:159]
    ds_read_b64_tr_b16 v[224:225], v26 offset:8192
    ds_read_b64_tr_b16 v[226:227], v26 offset:8704
    ds_read_b64_tr_b16 v[228:229], v27 offset:8192
    ds_read_b64_tr_b16 v[230:231], v27 offset:8704
    s_add_u32 m0, s66, 98304
    s_add_u32 s74, s65, 1490944
    buffer_load_dwordx4 v31, s[44:47], s74 offen lds
    s_waitcnt lgkmcnt(4)
    v_mfma_f32_16x16x32_bf16 v[144:147], v[216:219], v[68:71], v[144:147]
    v_mfma_f32_16x16x32_bf16 v[148:151], v[220:223], v[68:71], v[148:151]
    v_mfma_f32_16x16x32_bf16 v[152:155], v[216:219], v[124:127], v[152:155]
    v_mfma_f32_16x16x32_bf16 v[156:159], v[220:223], v[124:127], v[156:159]
    s_barrier
    ds_read_b64_tr_b16 v[208:209], v26 offset:12288
    ds_read_b64_tr_b16 v[210:211], v26 offset:12800
    ds_read_b64_tr_b16 v[212:213], v27 offset:12288
    ds_read_b64_tr_b16 v[214:215], v27 offset:12800
    s_add_u32 m0, s66, 73728
    s_add_u32 s74, s65, 516096
    buffer_load_dwordx4 v31, s[44:47], s74 offen lds
    s_add_u32 m0, s66, 81920
    s_add_u32 s74, s65, 974848
    buffer_load_dwordx4 v31, s[44:47], s74 offen lds
    s_waitcnt lgkmcnt(4)
    v_mfma_f32_16x16x32_bf16 v[144:147], v[224:227], v[72:75], v[144:147]
    v_mfma_f32_16x16x32_bf16 v[148:151], v[228:231], v[72:75], v[148:151]
    v_mfma_f32_16x16x32_bf16 v[152:155], v[224:227], v[128:131], v[152:155]
    v_mfma_f32_16x16x32_bf16 v[156:159], v[228:231], v[128:131], v[156:159]
    ds_read_b64_tr_b16 v[216:217], v26 offset:16384
    ds_read_b64_tr_b16 v[218:219], v26 offset:16896
    ds_read_b64_tr_b16 v[220:221], v27 offset:16384
    ds_read_b64_tr_b16 v[222:223], v27 offset:16896
    s_add_u32 m0, s66, 90112
    s_add_u32 s74, s65, 1032192
    buffer_load_dwordx4 v31, s[44:47], s74 offen lds
    s_waitcnt lgkmcnt(4)
    v_mfma_f32_16x16x32_bf16 v[144:147], v[208:211], v[76:79], v[144:147]
    v_mfma_f32_16x16x32_bf16 v[148:151], v[212:215], v[76:79], v[148:151]
    v_mfma_f32_16x16x32_bf16 v[152:155], v[208:211], v[132:135], v[152:155]
    v_mfma_f32_16x16x32_bf16 v[156:159], v[212:215], v[132:135], v[156:159]
    ds_read_b64_tr_b16 v[224:225], v26 offset:20480
    ds_read_b64_tr_b16 v[226:227], v26 offset:20992
    ds_read_b64_tr_b16 v[228:229], v27 offset:20480
    ds_read_b64_tr_b16 v[230:231], v27 offset:20992
    s_add_u32 m0, s66, 131072
    s_add_u32 s74, s65, 0
    buffer_load_dwordx4 v31, s[44:47], s74 offen lds
    s_add_u32 m0, s66, 139264
    s_add_u32 s74, s65, 573440
    buffer_load_dwordx4 v31, s[44:47], s74 offen lds
    s_waitcnt lgkmcnt(4)
    v_mfma_f32_16x16x32_bf16 v[144:147], v[216:219], v[80:83], v[144:147]
    v_mfma_f32_16x16x32_bf16 v[148:151], v[220:223], v[80:83], v[148:151]
    v_mfma_f32_16x16x32_bf16 v[152:155], v[216:219], v[136:139], v[152:155]
    v_mfma_f32_16x16x32_bf16 v[156:159], v[220:223], v[136:139], v[156:159]
    s_add_u32 m0, s66, 147456
    s_add_u32 s74, s65, 1089536
    buffer_load_dwordx4 v31, s[44:47], s74 offen lds
    s_waitcnt lgkmcnt(0)
    v_mfma_f32_16x16x32_bf16 v[144:147], v[224:227], v[84:87], v[144:147]
    v_mfma_f32_16x16x32_bf16 v[148:151], v[228:231], v[84:87], v[148:151]
    v_mfma_f32_16x16x32_bf16 v[152:155], v[224:227], v[140:143], v[152:155]
    v_mfma_f32_16x16x32_bf16 v[156:159], v[228:231], v[140:143], v[156:159]
    s_waitcnt vmcnt(8)
    s_barrier
    s_add_u32 m0, s66, 155648
    s_add_u32 s74, s65, 0
    buffer_load_dwordx4 v31, s[48:51], s74 offen lds
    v_mul_f32 v144, v19, v144
    v_mul_f32 v145, v19, v145
    v_mul_f32 v146, v19, v146
    v_mul_f32 v147, v19, v147
    v_mul_f32 v148, v20, v148
    v_mul_f32 v149, v20, v149
    v_mul_f32 v150, v20, v150
    v_mul_f32 v151, v20, v151
    v_cvt_pk_bf16_f32 v188, v144, v145
    v_cvt_pk_bf16_f32 v189, v146, v147
    v_cvt_pk_bf16_f32 v190, v148, v149
    v_cvt_pk_bf16_f32 v191, v150, v151
    v_mul_f32 v152, v19, v152
    v_mul_f32 v153, v19, v153
    v_mul_f32 v154, v19, v154
    v_mul_f32 v155, v19, v155
    v_mul_f32 v156, v20, v156
    v_mul_f32 v157, v20, v157
    v_mul_f32 v158, v20, v158
    v_mul_f32 v159, v20, v159
    v_cvt_pk_bf16_f32 v192, v152, v153
    v_cvt_pk_bf16_f32 v193, v154, v155
    v_cvt_pk_bf16_f32 v194, v156, v157
    v_cvt_pk_bf16_f32 v195, v158, v159
    s_waitcnt lgkmcnt(0)
    v_mfma_f32_16x16x32_bf16 v[144:147], v[164:167], v[188:191], v[204:207]
    v_mfma_f32_16x16x32_bf16 v[148:151], v[168:171], v[188:191], v[196:199]
    v_mfma_f32_16x16x32_bf16 v[152:155], v[168:171], v[192:195], v[200:203]
    v_mfma_f32_16x16x32_bf16 v[156:159], v[172:175], v[192:195], v[196:199]
    s_nop 5
    v_max3_f32 v208, v144, v145, v148
    s_nop 0
    v_max3_f32 v212, v152, v153, v156
    v_max3_f32 v209, v146, v147, v150
    v_max3_f32 v213, v154, v155, v158
    v_max_f32 v208, v208, v149
    v_max_f32 v212, v212, v157
    v_max_f32 v209, v209, v151
    v_max_f32 v213, v213, v159
    v_max_f32 v210, v208, v209
    v_max_f32 v214, v212, v213
    v_mov_b32 v211, v210
    v_mov_b32 v215, v214
    s_nop 0
    v_permlane16_swap_b32 v210, v211
    v_permlane16_swap_b32 v214, v215
    v_max_f32 v210, v210, v211
    v_max_f32 v214, v214, v215
    v_mov_b32 v211, v210
    v_mov_b32 v215, v214
    s_nop 0
    v_permlane32_swap_b32 v210, v211
    v_permlane32_swap_b32 v214, v215
    v_max_f32 v210, v210, v211
    v_max_f32 v214, v214, v215
    v_sub_f32 v208, v208, v210
    v_sub_f32 v212, v212, v214
    v_sub_f32 v209, v209, v210
    v_sub_f32 v213, v213, v214
    v_exp_f32 v208, v208
    v_exp_f32 v212, v212
    v_exp_f32 v209, v209
    v_exp_f32 v213, v213
    v_add_f32 v210, v208, v209
    v_add_f32 v214, v212, v213
    v_mov_b32 v211, v210
    v_mov_b32 v215, v214
    s_nop 0
    v_permlane16_swap_b32 v210, v211
    v_permlane16_swap_b32 v214, v215
    v_add_f32 v210, v210, v211
    v_add_f32 v214, v214, v215
    v_mov_b32 v211, v210
    v_mov_b32 v215, v214
    s_nop 0
    v_permlane32_swap_b32 v210, v211
    v_permlane32_swap_b32 v214, v215
    v_add_f32 v210, v210, v211
    v_add_f32 v214, v214, v215
    v_rcp_f32 v210, v210
    v_rcp_f32 v214, v214
    v_mul_f32 v208, v208, v210
    v_mul_f32 v212, v212, v214
    v_mul_f32 v209, v209, v210
    v_mul_f32 v213, v213, v214
    v_cvt_pk_bf16_f32 v208, v208, v208
    v_cvt_pk_bf16_f32 v212, v212, v212
    v_cvt_pk_bf16_f32 v209, v209, v209
    v_cvt_pk_bf16_f32 v213, v213, v213
    v_and_b32 v216, v244, v208
    v_and_b32 v220, v244, v212
    v_and_b32 v217, v245, v209
    v_and_b32 v221, v245, v213
    v_and_b32 v218, v246, v208
    v_and_b32 v222, v246, v212
    v_and_b32 v219, v247, v209
    v_and_b32 v223, v247, v213
    s_nop 0
    v_mfma_f32_16x16x32_bf16 v[144:147], v[176:179], v[216:219], 0
    v_mfma_f32_16x16x32_bf16 v[148:151], v[182:185], v[216:219], 0
    v_mfma_f32_16x16x32_bf16 v[152:155], v[178:181], v[220:223], 0
    v_mfma_f32_16x16x32_bf16 v[156:159], v[184:187], v[220:223], 0
    s_nop 4
    v_cvt_pk_bf16_f32 v224, v144, v145
    v_cvt_pk_bf16_f32 v225, v146, v147
    v_cvt_pk_bf16_f32 v226, v148, v149
    v_cvt_pk_bf16_f32 v227, v150, v151
    v_and_b32 v226, v21, v226
    v_and_b32 v227, v21, v227
    buffer_store_dwordx4 v[224:227], v22, s[36:39], s79 offen offset:0 sc1
    v_cvt_pk_bf16_f32 v228, v152, v153
    v_cvt_pk_bf16_f32 v229, v154, v155
    v_cvt_pk_bf16_f32 v230, v156, v157
    v_cvt_pk_bf16_f32 v231, v158, v159
    v_and_b32 v230, v21, v230
    v_and_b32 v231, v21, v231
    buffer_store_dwordx4 v[228:231], v22, s[36:39], s79 offen offset:256 sc1
    s_lshl_b32 s72, s61, 12
    s_lshl_b32 s73, s63, 8
    s_add_u32 s72, s72, s73
    s_lshl_b32 s73, s62, 5
    s_add_u32 s72, s72, s73
    s_lshl_b32 s73, s60, 2
    s_add_u32 s72, s72, s73
    s_add_u32 s72, s72, 262144
    s_branch L_P2
L_QB:
    s_mov_b32 s32, s6
    s_mov_b32 s33, s7
    s_mov_b32 s34, 1204224
    s_mov_b32 s35, 0x20000
    v_bfe_u32 v12, v0, 3, 5
    v_mul_u32_u24 v4, 2688, v12
    v_lshrrev_b32 v13, 2, v1
    v_and_b32 v13, 4, v13
    s_and_b32 s70, s60, 1
    s_lshl_b32 s70, s70, 1
    v_or_b32 v13, s70, v13
    v_and_b32 v12, 7, v1
    v_xor_b32 v12, v12, v13
    v_lshl_add_u32 v4, v12, 4, v4
    s_mul_i32 s76, s62, 112
    s_mov_b32 s36, s24
    s_mov_b32 s37, s25
    s_mov_b32 s38, 268435456
    s_mov_b32 s39, 0x20000
    s_mov_b32 s40, s22
    s_mov_b32 s41, s23
    s_mov_b32 s42, 256
    s_mov_b32 s43, 0x20000
    s_mov_b32 s44, s16
    s_mov_b32 s45, s17
    s_mov_b32 s46, 1605632
    s_mov_b32 s47, 0x20000
    s_mov_b32 s48, s8
    s_mov_b32 s49, s9
    s_mov_b32 s50, 401408
    s_mov_b32 s51, 0x20000
    s_mov_b32 s52, s20
    s_mov_b32 s53, s21
    s_mov_b32 s54, 1835008
    s_mov_b32 s55, 0x20000
    s_mov_b64 s[58:59], s[18:19]
    s_lshr_b32 s70, s64, 1
    s_sub_u32 s70, s70, s61
    v_and_b32 v23, 1, v1
    v_mul_lo_u32 v23, v23, s70
    v_add_u32 v23, s61, v23
    v_lshlrev_b32 v23, 2, v23
    v_lshlrev_b32 v255, 7, v1
    v_bfe_u32 v12, v0, 3, 5
    v_mul_u32_u24 v31, 896, v12
    v_lshrrev_b32 v13, 2, v1
    v_and_b32 v13, 4, v13
    v_and_b32 v12, 7, v1
    v_xor_b32 v12, v12, v13
    v_lshl_add_u32 v31, v12, 4, v31
    s_and_b32 s81, s60, 1
    s_add_u32 s81, s81, 2
    s_bfe_u32 s80, s60, 0x10001
    s_lshl_b32 s70, s81, 5
    s_add_u32 s70, s70, 16
    s_mul_i32 s70, s70, 896
    v_and_b32 v12, 15, v1
    v_mul_u32_u24 v13, 896, v12
    v_bfe_u32 v12, v1, 1, 3
    v_lshrrev_b32 v14, 4, v1
    v_xor_b32 v12, v12, v14
    v_lshl_add_u32 v10, v12, 4, v13
    v_xor_b32 v12, 4, v12
    v_lshl_add_u32 v11, v12, 4, v13
    v_add_u32 v8, s70, v10
    v_add_u32 v9, s70, v11
    v_add_u32 v10, 57344, v10
    v_add_u32 v11, 57344, v11
    s_mul_i32 s70, s80, 56
    v_lshrrev_b32 v12, 4, v1
    v_bfe_u32 v13, v1, 2, 2
    v_lshl_add_u32 v14, v12, 3, v13
    v_lshlrev_b32 v14, 7, v14
    v_lshrrev_b32 v13, 1, v13
    v_lshlrev_b32 v13, 6, v13
    v_and_b32 v12, 1, v12
    v_lshl_or_b32 v13, v12, 5, v13
    v_and_b32 v12, 3, v1
    v_lshlrev_b32 v12, 3, v12
    v_add_u32 v12, s70, v12
    v_xor_b32 v15, v12, v13
    v_add_u32 v24, v14, v15
    v_add_u32 v12, 32, v12
    v_xor_b32 v15, v12, v13
    v_add_u32 v25, v14, v15
    v_add_u32 v26, 106496, v24
    v_add_u32 v27, 106496, v25
    v_lshrrev_b32 v12, 5, v1
    s_lshl_b32 s70, s60, 1
    v_add_u32 v12, s70, v12
    v_bfe_u32 v13, v12, 1, 3
    v_mul_u32_u24 v12, 896, v12
    v_add_u32 v12, 57344, v12
    v_and_b32 v14, 31, v1
    v_xor_b32 v15, v14, v13
    v_lshl_add_u32 v16, v15, 4, v12
    v_add_u32 v14, 28, v14
    v_xor_b32 v15, v14, v13
    v_lshl_add_u32 v17, v15, 4, v12
    s_mul_i32 s70, s80, 10240
    s_add_u32 s70, s70, 73728
    v_add_u32 v18, s70, v2
    s_lshl_b32 s71, s81, 11
    v_add_u32 v28, s71, v18
    v_add_u32 v29, 2048, v28
    v_mov_b32 v104, 0
    v_mov_b32 v105, 0
    s_waitcnt vmcnt(15)
    v_dot2c_f32_bf16 v104, s67, v88
    v_dot2c_f32_bf16 v105, v88, v88
    v_dot2c_f32_bf16 v104, s67, v89
    v_dot2c_f32_bf16 v105, v89, v89
    v_dot2c_f32_bf16 v104, s67, v90
    v_dot2c_f32_bf16 v105, v90, v90
    v_dot2c_f32_bf16 v104, s67, v91
    v_dot2c_f32_bf16 v105, v91, v91
    s_waitcnt vmcnt(14)
    v_dot2c_f32_bf16 v104, s67, v92
    v_dot2c_f32_bf16 v105, v92, v92
    v_dot2c_f32_bf16 v104, s67, v93
    v_dot2c_f32_bf16 v105, v93, v93
    v_dot2c_f32_bf16 v104, s67, v94
    v_dot2c_f32_bf16 v105, v94, v94
    v_dot2c_f32_bf16 v104, s67, v95
    v_dot2c_f32_bf16 v105, v95, v95
    s_nop 1
    v_add_f32_dpp v104, v104, v104 quad_perm:[1,0,3,2] row_mask:0xf bank_mask:0xf
    v_add_f32_dpp v105, v105, v105 quad_perm:[1,0,3,2] row_mask:0xf bank_mask:0xf
    s_nop 0
    v_add_f32_dpp v104, v104, v104 quad_perm:[2,3,0,1] row_mask:0xf bank_mask:0xf
    v_add_f32_dpp v105, v105, v105 quad_perm:[2,3,0,1] row_mask:0xf bank_mask:0xf
    s_nop 0
    v_add_f32_dpp v104, v104, v104 row_half_mirror row_mask:0xf bank_mask:0xf
    v_add_f32_dpp v105, v105, v105 row_half_mirror row_mask:0xf bank_mask:0xf
    s_nop 0
    v_add_f32_dpp v104, v104, v104 row_mirror row_mask:0xf bank_mask:0xf
    v_add_f32_dpp v105, v105, v105 row_mirror row_mask:0xf bank_mask:0xf
    v_mov_b32 v108, v104
    v_mov_b32 v109, v105
    s_nop 0
    v_permlane16_swap_b32 v104, v108
    v_permlane16_swap_b32 v105, v109
    v_add_f32 v104, v104, v108
    v_add_f32 v105, v105, v109
    v_mul_f32 v104, 0x3b124925, v104
    v_mul_f32 v105, 0x3b124925, v105
    v_fma_f32 v105, -v104, v104, v105
    v_max_f32 v105, 0, v105
    v_add_f32 v106, 0x3727c5ac, v105
    v_rsq_f32 v106, v106
    s_nop 0
    v_cvt_pk_bf16_f32 v106, v106, 0
    v_lshlrev_b32 v105, 16, v106
    v_mul_f32 v107, v104, v105
    v_mov_b32 v104, v106
    v_sub_f32 v106, 0, v107
    s_mov_b32 s70, 0x0fffffff
    s_mov_b32 s71, 0x0fffffff
    v_dot2_f32_bf16 v96, v88, v104, v106
    v_dot2_f32_bf16 v97, v88, v105, v106
    v_dot2_f32_bf16 v98, v89, v104, v106
    v_dot2_f32_bf16 v99, v89, v105, v106
    v_dot2_f32_bf16 v100, v90, v104, v106
    v_dot2_f32_bf16 v101, v90, v105, v106
    v_dot2_f32_bf16 v102, v91, v104, v106
    v_dot2_f32_bf16 v103, v91, v105, v106
    v_cvt_pk_bf16_f32 v88, v96, v97
    v_cvt_pk_bf16_f32 v89, v98, v99
    v_cvt_pk_bf16_f32 v90, v100, v101
    v_cvt_pk_bf16_f32 v91, v102, v103
    v_dot2_f32_bf16 v96, v92, v104, v106
    v_dot2_f32_bf16 v97, v92, v105, v106
    v_dot2_f32_bf16 v98, v93, v104, v106
    v_dot2_f32_bf16 v99, v93, v105, v106
    v_dot2_f32_bf16 v100, v94, v104, v106
    v_dot2_f32_bf16 v101, v94, v105, v106
    v_dot2_f32_bf16 v102, v95, v104, v106
    v_dot2_f32_bf16 v103, v95, v105, v106
    v_cvt_pk_bf16_f32 v92, v96, v97
    v_cvt_pk_bf16_f32 v93, v98, v99
    v_cvt_pk_bf16_f32 v94, v100, v101
    v_cvt_pk_bf16_f32 v95, v102, v103
    s_mov_b64 exec, s[70:71]
    ds_write_b128 v16, v[88:91]
    ds_write_b128 v17, v[92:95]
    s_mov_b64 exec, -1
    v_lshrrev_b32 v12, 3, v1
    s_lshl_b32 s70, s60, 4
    s_and_b32 s71, s60, 4
    s_lshl_b32 s71, s71, 2
    s_add_u32 s70, s70, s71
    v_add_u32 v12, s70, v12
    v_mul_u32_u24 v12, 896, v12
    v_lshrrev_b32 v13, 4, v1
    v_and_b32 v14, 7, v1
    v_xor_b32 v13, v13, v14
    v_lshl_add_u32 v6, v13, 4, v12
    v_xor_b32 v13, 4, v13
    v_lshl_add_u32 v7, v13, 4, v12
    v_add_u32 v7, 7168, v7
    v_mov_b32 v104, 0
    v_mov_b32 v105, 0
    s_waitcnt vmcnt(13)
    v_dot2c_f32_bf16 v104, s67, v32
    v_dot2c_f32_bf16 v105, v32, v32
    v_dot2c_f32_bf16 v104, s67, v33
    v_dot2c_f32_bf16 v105, v33, v33
    v_dot2c_f32_bf16 v104, s67, v34
    v_dot2c_f32_bf16 v105, v34, v34
    v_dot2c_f32_bf16 v104, s67, v35
    v_dot2c_f32_bf16 v105, v35, v35
    s_waitcnt vmcnt(12)
    v_dot2c_f32_bf16 v104, s67, v36
    v_dot2c_f32_bf16 v105, v36, v36
    v_dot2c_f32_bf16 v104, s67, v37
    v_dot2c_f32_bf16 v105, v37, v37
    v_dot2c_f32_bf16 v104, s67, v38
    v_dot2c_f32_bf16 v105, v38, v38
    v_dot2c_f32_bf16 v104, s67, v39
    v_dot2c_f32_bf16 v105, v39, v39
    s_waitcnt vmcnt(11)
    v_dot2c_f32_bf16 v104, s67, v40
    v_dot2c_f32_bf16 v105, v40, v40
    v_dot2c_f32_bf16 v104, s67, v41
    v_dot2c_f32_bf16 v105, v41, v41
    v_dot2c_f32_bf16 v104, s67, v42
    v_dot2c_f32_bf16 v105, v42, v42
    v_dot2c_f32_bf16 v104, s67, v43
    v_dot2c_f32_bf16 v105, v43, v43
    s_waitcnt vmcnt(10)
    v_dot2c_f32_bf16 v104, s67, v44
    v_dot2c_f32_bf16 v105, v44, v44
    v_dot2c_f32_bf16 v104, s67, v45
    v_dot2c_f32_bf16 v105, v45, v45
    v_dot2c_f32_bf16 v104, s67, v46
    v_dot2c_f32_bf16 v105, v46, v46
    v_dot2c_f32_bf16 v104, s67, v47
    v_dot2c_f32_bf16 v105, v47, v47
    s_waitcnt vmcnt(9)
    v_dot2c_f32_bf16 v104, s67, v48
    v_dot2c_f32_bf16 v105, v48, v48
    v_dot2c_f32_bf16 v104, s67, v49
    v_dot2c_f32_bf16 v105, v49, v49
    v_dot2c_f32_bf16 v104, s67, v50
    v_dot2c_f32_bf16 v105, v50, v50
    v_dot2c_f32_bf16 v104, s67, v51
    v_dot2c_f32_bf16 v105, v51, v51
    s_waitcnt vmcnt(8)
    v_dot2c_f32_bf16 v104, s67, v52
    v_dot2c_f32_bf16 v105, v52, v52
    v_dot2c_f32_bf16 v104, s67, v53
    v_dot2c_f32_bf16 v105, v53, v53
    v_dot2c_f32_bf16 v104, s67, v54
    v_dot2c_f32_bf16 v105, v54, v54
    v_dot2c_f32_bf16 v104, s67, v55
    v_dot2c_f32_bf16 v105, v55, v55
    s_waitcnt vmcnt(7)
    v_dot2c_f32_bf16 v104, s67, v56
    v_dot2c_f32_bf16 v105, v56, v56
    v_dot2c_f32_bf16 v104, s67, v57
    v_dot2c_f32_bf16 v105, v57, v57
    v_dot2c_f32_bf16 v104, s67, v58
    v_dot2c_f32_bf16 v105, v58, v58
    v_dot2c_f32_bf16 v104, s67, v59
    v_dot2c_f32_bf16 v105, v59, v59
    v_mov_b32 v112, 0
    v_mov_b32 v113, 0
    v_add_f32_dpp v104, v104, v104 quad_perm:[1,0,3,2] row_mask:0xf bank_mask:0xf
    s_waitcnt vmcnt(6)
    v_dot2c_f32_bf16 v112, s67, v60
    v_add_f32_dpp v105, v105, v105 quad_perm:[1,0,3,2] row_mask:0xf bank_mask:0xf
    v_dot2c_f32_bf16 v113, v60, v60
    v_dot2c_f32_bf16 v112, s67, v61
    v_add_f32_dpp v104, v104, v104 quad_perm:[2,3,0,1] row_mask:0xf bank_mask:0xf
    v_dot2c_f32_bf16 v113, v61, v61
    v_dot2c_f32_bf16 v112, s67, v62
    v_add_f32_dpp v105, v105, v105 quad_perm:[2,3,0,1] row_mask:0xf bank_mask:0xf
    v_dot2c_f32_bf16 v113, v62, v62
    v_dot2c_f32_bf16 v112, s67, v63
    v_add_f32_dpp v104, v104, v104 row_half_mirror row_mask:0xf bank_mask:0xf
    v_dot2c_f32_bf16 v113, v63, v63
    s_waitcnt vmcnt(5)
    v_add_f32_dpp v105, v105, v105 row_half_mirror row_mask:0xf bank_mask:0xf
    v_dot2c_f32_bf16 v112, s67, v64
    v_dot2c_f32_bf16 v113, v64, v64
    v_mul_f32 v104, 0x3b124925, v104
    v_dot2c_f32_bf16 v112, s67, v65
    v_dot2c_f32_bf16 v113, v65, v65
    v_mul_f32 v105, 0x3b124925, v105
    v_dot2c_f32_bf16 v112, s67, v66
    v_dot2c_f32_bf16 v113, v66, v66
    v_fma_f32 v105, -v104, v104, v105
    v_dot2c_f32_bf16 v112, s67, v67
    v_dot2c_f32_bf16 v113, v67, v67
    v_max_f32 v105, 0, v105
    s_waitcnt vmcnt(4)
    v_dot2c_f32_bf16 v112, s67, v68
    v_add_f32 v106, 0x3727c5ac, v105
    v_dot2c_f32_bf16 v113, v68, v68
    v_dot2c_f32_bf16 v112, s67, v69
    v_rsq_f32 v106, v106
    v_dot2c_f32_bf16 v113, v69, v69
    v_dot2c_f32_bf16 v112, s67, v70
    v_cvt_pk_bf16_f32 v106, v106, 0
    v_dot2c_f32_bf16 v113, v70, v70
    v_dot2c_f32_bf16 v112, s67, v71
    v_lshlrev_b32 v105, 16, v106
    v_dot2c_f32_bf16 v113, v71, v71
    s_waitcnt vmcnt(3)
    v_mul_f32 v107, v104, v105
    v_dot2c_f32_bf16 v112, s67, v72
    v_dot2c_f32_bf16 v113, v72, v72
    v_mov_b32 v104, v106
    v_dot2c_f32_bf16 v112, s67, v73
    v_dot2c_f32_bf16 v113, v73, v73
    v_sub_f32 v106, 0, v107
    v_dot2c_f32_bf16 v112, s67, v74
    v_dot2c_f32_bf16 v113, v74, v74
    v_dot2c_f32_bf16 v112, s67, v75
    v_dot2c_f32_bf16 v113, v75, v75
    s_waitcnt vmcnt(2)
    v_dot2c_f32_bf16 v112, s67, v76
    v_dot2c_f32_bf16 v113, v76, v76
    v_dot2c_f32_bf16 v112, s67, v77
    v_dot2c_f32_bf16 v113, v77, v77
    v_dot2c_f32_bf16 v112, s67, v78
    v_dot2c_f32_bf16 v113, v78, v78
    v_dot2c_f32_bf16 v112, s67, v79
    v_dot2c_f32_bf16 v113, v79, v79
    s_waitcnt vmcnt(1)
    v_dot2c_f32_bf16 v112, s67, v80
    v_dot2c_f32_bf16 v113, v80, v80
    v_dot2c_f32_bf16 v112, s67, v81
    v_dot2c_f32_bf16 v113, v81, v81
    v_dot2c_f32_bf16 v112, s67, v82
    v_dot2c_f32_bf16 v113, v82, v82
    v_dot2c_f32_bf16 v112, s67, v83
    v_dot2c_f32_bf16 v113, v83, v83
    s_waitcnt vmcnt(0)
    v_dot2c_f32_bf16 v112, s67, v84
    v_dot2c_f32_bf16 v113, v84, v84
    v_dot2c_f32_bf16 v112, s67, v85
    v_dot2c_f32_bf16 v113, v85, v85
    v_dot2c_f32_bf16 v112, s67, v86
    v_dot2c_f32_bf16 v113, v86, v86
    v_dot2c_f32_bf16 v112, s67, v87
    v_dot2c_f32_bf16 v113, v87, v87
    v_dot2_f32_bf16 v120, v32, v104, v106
    v_dot2_f32_bf16 v121, v32, v105, v106
    v_dot2_f32_bf16 v122, v33, v104, v106
    v_add_f32_dpp v112, v112, v112 quad_perm:[1,0,3,2] row_mask:0xf bank_mask:0xf
    v_dot2_f32_bf16 v123, v33, v105, v106
    v_dot2_f32_bf16 v124, v34, v104, v106
    v_dot2_f32_bf16 v125, v34, v105, v106
    v_add_f32_dpp v113, v113, v113 quad_perm:[1,0,3,2] row_mask:0xf bank_mask:0xf
    v_dot2_f32_bf16 v126, v35, v104, v106
    v_dot2_f32_bf16 v127, v35, v105, v106
    v_cvt_pk_bf16_f32 v32, v120, v121
    v_add_f32_dpp v112, v112, v112 quad_perm:[2,3,0,1] row_mask:0xf bank_mask:0xf
    v_cvt_pk_bf16_f32 v33, v122, v123
    v_cvt_pk_bf16_f32 v34, v124, v125
    v_cvt_pk_bf16_f32 v35, v126, v127
    v_add_f32_dpp v113, v113, v113 quad_perm:[2,3,0,1] row_mask:0xf bank_mask:0xf
    ds_write_b128 v6, v[32:35] offset:0
    v_dot2_f32_bf16 v96, v36, v104, v106
    v_dot2_f32_bf16 v97, v36, v105, v106
    v_add_f32_dpp v112, v112, v112 row_half_mirror row_mask:0xf bank_mask:0xf
    v_dot2_f32_bf16 v98, v37, v104, v106
    v_dot2_f32_bf16 v99, v37, v105, v106
    v_dot2_f32_bf16 v100, v38, v104, v106
    v_add_f32_dpp v113, v113, v113 row_half_mirror row_mask:0xf bank_mask:0xf
    v_dot2_f32_bf16 v101, v38, v105, v106
    v_dot2_f32_bf16 v102, v39, v104, v106
    v_dot2_f32_bf16 v103, v39, v105, v106
    v_mul_f32 v112, 0x3b124925, v112
    v_cvt_pk_bf16_f32 v36, v96, v97
    v_cvt_pk_bf16_f32 v37, v98, v99
    v_cvt_pk_bf16_f32 v38, v100, v101
    v_mul_f32 v113, 0x3b124925, v113
    v_cvt_pk_bf16_f32 v39, v102, v103
    ds_write_b128 v6, v[36:39] offset:128
    v_dot2_f32_bf16 v120, v40, v104, v106
    v_fma_f32 v113, -v112, v112, v113
    v_dot2_f32_bf16 v121, v40, v105, v106
    v_dot2_f32_bf16 v122, v41, v104, v106
    v_dot2_f32_bf16 v123, v41, v105, v106
    v_max_f32 v113, 0, v113
    v_dot2_f32_bf16 v124, v42, v104, v106
    v_dot2_f32_bf16 v125, v42, v105, v106
    v_dot2_f32_bf16 v126, v43, v104, v106
    v_add_f32 v114, 0x3727c5ac, v113
    v_dot2_f32_bf16 v127, v43, v105, v106
    v_cvt_pk_bf16_f32 v40, v120, v121
    v_cvt_pk_bf16_f32 v41, v122, v123
    v_rsq_f32 v114, v114
    v_cvt_pk_bf16_f32 v42, v124, v125
    v_cvt_pk_bf16_f32 v43, v126, v127
    ds_write_b128 v6, v[40:43] offset:256
    v_cvt_pk_bf16_f32 v114, v114, 0
    v_dot2_f32_bf16 v96, v44, v104, v106
    v_dot2_f32_bf16 v97, v44, v105, v106
    v_dot2_f32_bf16 v98, v45, v104, v106
    v_lshlrev_b32 v113, 16, v114
    v_dot2_f32_bf16 v99, v45, v105, v106
    v_dot2_f32_bf16 v100, v46, v104, v106
    v_dot2_f32_bf16 v101, v46, v105, v106
    v_mul_f32 v115, v112, v113
    v_dot2_f32_bf16 v102, v47, v104, v106
    v_dot2_f32_bf16 v103, v47, v105, v106
    v_cvt_pk_bf16_f32 v44, v96, v97
    v_mov_b32 v112, v114
    v_cvt_pk_bf16_f32 v45, v98, v99
    v_cvt_pk_bf16_f32 v46, v100, v101
    v_cvt_pk_bf16_f32 v47, v102, v103
    v_sub_f32 v114, 0, v115
    ds_write_b128 v6, v[44:47] offset:384
    v_dot2_f32_bf16 v120, v48, v104, v106
    v_dot2_f32_bf16 v121, v48, v105, v106
    v_dot2_f32_bf16 v122, v49, v104, v106
    v_dot2_f32_bf16 v123, v49, v105, v106
    v_dot2_f32_bf16 v124, v50, v104, v106
    v_dot2_f32_bf16 v125, v50, v105, v106
    v_dot2_f32_bf16 v126, v51, v104, v106
    v_dot2_f32_bf16 v127, v51, v105, v106
    v_cvt_pk_bf16_f32 v48, v120, v121
    v_cvt_pk_bf16_f32 v49, v122, v123
    v_cvt_pk_bf16_f32 v50, v124, v125
    v_cvt_pk_bf16_f32 v51, v126, v127
    ds_write_b128 v6, v[48:51] offset:512
    v_dot2_f32_bf16 v96, v52, v104, v106
    v_dot2_f32_bf16 v97, v52, v105, v106
    v_dot2_f32_bf16 v98, v53, v104, v106
    v_dot2_f32_bf16 v99, v53, v105, v106
    v_dot2_f32_bf16 v100, v54, v104, v106
    v_dot2_f32_bf16 v101, v54, v105, v106
    v_dot2_f32_bf16 v102, v55, v104, v106
    v_dot2_f32_bf16 v103, v55, v105, v106
    v_cvt_pk_bf16_f32 v52, v96, v97
    v_cvt_pk_bf16_f32 v53, v98, v99
    v_cvt_pk_bf16_f32 v54, v100, v101
    v_cvt_pk_bf16_f32 v55, v102, v103
    ds_write_b128 v6, v[52:55] offset:640
    v_dot2_f32_bf16 v120, v56, v104, v106
    v_dot2_f32_bf16 v121, v56, v105, v106
    v_dot2_f32_bf16 v122, v57, v104, v106
    v_dot2_f32_bf16 v123, v57, v105, v106
    v_dot2_f32_bf16 v124, v58, v104, v106
    v_dot2_f32_bf16 v125, v58, v105, v106
    v_dot2_f32_bf16 v126, v59, v104, v106
    v_dot2_f32_bf16 v127, v59, v105, v106
    v_cvt_pk_bf16_f32 v56, v120, v121
    v_cvt_pk_bf16_f32 v57, v122, v123
    v_cvt_pk_bf16_f32 v58, v124, v125
    v_cvt_pk_bf16_f32 v59, v126, v127
    ds_write_b128 v6, v[56:59] offset:768
    v_dot2_f32_bf16 v120, v60, v112, v114
    v_dot2_f32_bf16 v121, v60, v113, v114
    v_dot2_f32_bf16 v122, v61, v112, v114
    v_dot2_f32_bf16 v123, v61, v113, v114
    v_dot2_f32_bf16 v124, v62, v112, v114
    v_dot2_f32_bf16 v125, v62, v113, v114
    v_dot2_f32_bf16 v126, v63, v112, v114
    v_dot2_f32_bf16 v127, v63, v113, v114
    v_cvt_pk_bf16_f32 v60, v120, v121
    v_cvt_pk_bf16_f32 v61, v122, v123
    v_cvt_pk_bf16_f32 v62, v124, v125
    v_cvt_pk_bf16_f32 v63, v126, v127
    ds_write_b128 v7, v[60:63] offset:0
    v_dot2_f32_bf16 v96, v64, v112, v114
    v_dot2_f32_bf16 v97, v64, v113, v114
    v_dot2_f32_bf16 v98, v65, v112, v114
    v_dot2_f32_bf16 v99, v65, v113, v114
    v_dot2_f32_bf16 v100, v66, v112, v114
    v_dot2_f32_bf16 v101, v66, v113, v114
    v_dot2_f32_bf16 v102, v67, v112, v114
    v_dot2_f32_bf16 v103, v67, v113, v114
    v_cvt_pk_bf16_f32 v64, v96, v97
    v_cvt_pk_bf16_f32 v65, v98, v99
    v_cvt_pk_bf16_f32 v66, v100, v101
    v_cvt_pk_bf16_f32 v67, v102, v103
    ds_write_b128 v7, v[64:67] offset:128
    v_dot2_f32_bf16 v120, v68, v112, v114
    v_dot2_f32_bf16 v121, v68, v113, v114
    v_dot2_f32_bf16 v122, v69, v112, v114
    v_dot2_f32_bf16 v123, v69, v113, v114
    v_dot2_f32_bf16 v124, v70, v112, v114
    v_dot2_f32_bf16 v125, v70, v113, v114
    v_dot2_f32_bf16 v126, v71, v112, v114
    v_dot2_f32_bf16 v127, v71, v113, v114
    v_cvt_pk_bf16_f32 v68, v120, v121
    v_cvt_pk_bf16_f32 v69, v122, v123
    v_cvt_pk_bf16_f32 v70, v124, v125
    v_cvt_pk_bf16_f32 v71, v126, v127
    ds_write_b128 v7, v[68:71] offset:256
    v_dot2_f32_bf16 v96, v72, v112, v114
    v_dot2_f32_bf16 v97, v72, v113, v114
    v_dot2_f32_bf16 v98, v73, v112, v114
    v_dot2_f32_bf16 v99, v73, v113, v114
    v_dot2_f32_bf16 v100, v74, v112, v114
    v_dot2_f32_bf16 v101, v74, v113, v114
    v_dot2_f32_bf16 v102, v75, v112, v114
    v_dot2_f32_bf16 v103, v75, v113, v114
    v_cvt_pk_bf16_f32 v72, v96, v97
    v_cvt_pk_bf16_f32 v73, v98, v99
    v_cvt_pk_bf16_f32 v74, v100, v101
    v_cvt_pk_bf16_f32 v75, v102, v103
    ds_write_b128 v7, v[72:75] offset:384
    v_dot2_f32_bf16 v120, v76, v112, v114
    v_dot2_f32_bf16 v121, v76, v113, v114
    v_dot2_f32_bf16 v122, v77, v112, v114
    v_dot2_f32_bf16 v123, v77, v113, v114
    v_dot2_f32_bf16 v124, v78, v112, v114
    v_dot2_f32_bf16 v125, v78, v113, v114
    v_dot2_f32_bf16 v126, v79, v112, v114
    v_dot2_f32_bf16 v127, v79, v113, v114
    v_cvt_pk_bf16_f32 v76, v120, v121
    v_cvt_pk_bf16_f32 v77, v122, v123
    v_cvt_pk_bf16_f32 v78, v124, v125
    v_cvt_pk_bf16_f32 v79, v126, v127
    ds_write_b128 v7, v[76:79] offset:512
    v_dot2_f32_bf16 v96, v80, v112, v114
    v_dot2_f32_bf16 v97, v80, v113, v114
    v_dot2_f32_bf16 v98, v81, v112, v114
    v_dot2_f32_bf16 v99, v81, v113, v114
    v_dot2_f32_bf16 v100, v82, v112, v114
    v_dot2_f32_bf16 v101, v82, v113, v114
    v_dot2_f32_bf16 v102, v83, v112, v114
    v_dot2_f32_bf16 v103, v83, v113, v114
    v_cvt_pk_bf16_f32 v80, v96, v97
    v_cvt_pk_bf16_f32 v81, v98, v99
    v_cvt_pk_bf16_f32 v82, v100, v101
    v_cvt_pk_bf16_f32 v83, v102, v103
    ds_write_b128 v7, v[80:83] offset:640
    v_dot2_f32_bf16 v120, v84, v112, v114
    v_dot2_f32_bf16 v121, v84, v113, v114
    v_dot2_f32_bf16 v122, v85, v112, v114
    v_dot2_f32_bf16 v123, v85, v113, v114
    v_dot2_f32_bf16 v124, v86, v112, v114
    v_dot2_f32_bf16 v125, v86, v113, v114
    v_dot2_f32_bf16 v126, v87, v112, v114
    v_dot2_f32_bf16 v127, v87, v113, v114
    v_cvt_pk_bf16_f32 v84, v120, v121
    v_cvt_pk_bf16_f32 v85, v122, v123
    v_cvt_pk_bf16_f32 v86, v124, v125
    v_cvt_pk_bf16_f32 v87, v126, v127
    ds_write_b128 v7, v[84:87] offset:768
    s_waitcnt lgkmcnt(0)
    s_barrier
    s_bitcmp1_b32 s60, 0
    s_cbranch_scc1 L_Q3
L_Q2:
    ds_read_b128 v[32:35], v8 offset:0
    ds_read_b128 v[88:91], v8 offset:14336
    ds_read_b64_tr_b16 v[208:209], v26 offset:24576
    ds_read_b64_tr_b16 v[210:211], v26 offset:25088
    ds_read_b64_tr_b16 v[212:213], v27 offset:24576
    ds_read_b64_tr_b16 v[214:215], v27 offset:25088
    ds_read_b128 v[36:39], v9 offset:0
    ds_read_b128 v[92:95], v9 offset:14336
    ds_read_b64_tr_b16 v[216:217], v26 offset:28672
    ds_read_b64_tr_b16 v[218:219], v26 offset:29184
    ds_read_b64_tr_b16 v[220:221], v27 offset:28672
    ds_read_b64_tr_b16 v[222:223], v27 offset:29184
    s_waitcnt lgkmcnt(6)
    v_mfma_f32_16x16x32_bf16 v[144:147], v[208:211], v[32:35], 0
    v_mfma_f32_16x16x32_bf16 v[148:151], v[212:215], v[32:35], 0
    v_mfma_f32_16x16x32_bf16 v[152:155], v[208:211], v[88:91], 0
    v_mfma_f32_16x16x32_bf16 v[156:159], v[212:215], v[88:91], 0
    ds_read_b64_tr_b16 v[224:225], v26 offset:32768
    ds_read_b64_tr_b16 v[226:227], v26 offset:33280
    ds_read_b64_tr_b16 v[228:229], v27 offset:32768
    ds_read_b64_tr_b16 v[230:231], v27 offset:33280
    ds_read_b128 v[40:43], v8 offset:128
    ds_read_b128 v[96:99], v8 offset:14464
    ds_read_b128 v[44:47], v9 offset:128
    ds_read_b128 v[100:103], v9 offset:14464
    ds_read_b128 v[48:51], v8 offset:256
    ds_read_b128 v[104:107], v8 offset:14592
    ds_read_b128 v[52:55], v9 offset:256
    ds_read_b128 v[108:111], v9 offset:14592
    s_waitcnt lgkmcnt(12)
    v_mfma_f32_16x16x32_bf16 v[144:147], v[216:219], v[36:39], v[144:147]
    v_mfma_f32_16x16x32_bf16 v[148:151], v[220:223], v[36:39], v[148:151]
    v_mfma_f32_16x16x32_bf16 v[152:155], v[216:219], v[92:95], v[152:155]
    v_mfma_f32_16x16x32_bf16 v[156:159], v[220:223], v[92:95], v[156:159]
    ds_read_b64_tr_b16 v[208:209], v26 offset:36864
    ds_read_b64_tr_b16 v[210:211], v26 offset:37376
    ds_read_b64_tr_b16 v[212:213], v27 offset:36864
    ds_read_b64_tr_b16 v[214:215], v27 offset:37376
    ds_read_b128 v[56:59], v8 offset:384
    ds_read_b128 v[112:115], v8 offset:14720
    ds_read_b128 v[60:63], v9 offset:384
    ds_read_b128 v[116:119], v9 offset:14720
    ds_read_b128 v[64:67], v8 offset:512
    ds_read_b128 v[120:123], v8 offset:14848
    ds_read_b128 v[68:71], v9 offset:512
    ds_read_b128 v[124:127], v9 offset:14848
    s_waitcnt lgkmcnt(15)
    v_mfma_f32_16x16x32_bf16 v[144:147], v[224:227], v[40:43], v[144:147]
    v_mfma_f32_16x16x32_bf16 v[148:151], v[228:231], v[40:43], v[148:151]
    v_mfma_f32_16x16x32_bf16 v[152:155], v[224:227], v[96:99], v[152:155]
    v_mfma_f32_16x16x32_bf16 v[156:159], v[228:231], v[96:99], v[156:159]
    ds_read_b128 v[72:75], v8 offset:640
    ds_read_b128 v[128:131], v8 offset:14976
    ds_read_b128 v[76:79], v9 offset:640
    ds_read_b128 v[132:135], v9 offset:14976
    ds_read_b128 v[80:83], v8 offset:768
    ds_read_b128 v[136:139], v8 offset:15104
    ds_read_b128 v[84:87], v9 offset:768
    ds_read_b128 v[140:143], v9 offset:15104
    s_waitcnt lgkmcnt(15)
    v_mfma_f32_16x16x32_bf16 v[144:147], v[208:211], v[44:47], v[144:147]
    v_mfma_f32_16x16x32_bf16 v[148:151], v[212:215], v[44:47], v[148:151]
    v_mfma_f32_16x16x32_bf16 v[152:155], v[208:211], v[100:103], v[152:155]
    v_mfma_f32_16x16x32_bf16 v[156:159], v[212:215], v[100:103], v[156:159]
    s_waitcnt lgkmcnt(0)
    s_barrier
    ds_read_b64_tr_b16 v[216:217], v26 offset:40960
    ds_read_b64_tr_b16 v[218:219], v26 offset:41472
    ds_read_b64_tr_b16 v[220:221], v27 offset:40960
    ds_read_b64_tr_b16 v[222:223], v27 offset:41472
    ds_read_b64_tr_b16 v[224:225], v26 offset:45056
    ds_read_b64_tr_b16 v[226:227], v26 offset:45568
    ds_read_b64_tr_b16 v[228:229], v27 offset:45056
    ds_read_b64_tr_b16 v[230:231], v27 offset:45568
    s_waitcnt lgkmcnt(4)
    v_mfma_f32_16x16x32_bf16 v[144:147], v[216:219], v[48:51], v[144:147]
    v_mfma_f32_16x16x32_bf16 v[148:151], v[220:223], v[48:51], v[148:151]
    v_mfma_f32_16x16x32_bf16 v[152:155], v[216:219], v[104:107], v[152:155]
    v_mfma_f32_16x16x32_bf16 v[156:159], v[220:223], v[104:107], v[156:159]
    ds_read_b64_tr_b16 v[208:209], v26 offset:49152
    ds_read_b64_tr_b16 v[210:211], v26 offset:49664
    ds_read_b64_tr_b16 v[212:213], v27 offset:49152
    ds_read_b64_tr_b16 v[214:215], v27 offset:49664
    s_add_u32 m0, s66, 20480
    s_add_u32 s74, s76, 431872
    buffer_load_dwordx4 v4, s[32:35], s74 offen lds
    s_add_u32 m0, s66, 24576
    s_add_u32 s74, s76, 517888
    buffer_load_dwordx4 v4, s[32:35], s74 offen lds
    s_waitcnt lgkmcnt(4)
    v_mfma_f32_16x16x32_bf16 v[144:147], v[224:227], v[52:55], v[144:147]
    v_mfma_f32_16x16x32_bf16 v[148:151], v[228:231], v[52:55], v[148:151]
    v_mfma_f32_16x16x32_bf16 v[152:155], v[224:227], v[108:111], v[152:155]
    v_mfma_f32_16x16x32_bf16 v[156:159], v[228:231], v[108:111], v[156:159]
    ds_read_b64_tr_b16 v[216:217], v26 offset:53248
    ds_read_b64_tr_b16 v[218:219], v26 offset:53760
    ds_read_b64_tr_b16 v[220:221], v27 offset:53248
    ds_read_b64_tr_b16 v[222:223], v27 offset:53760
    s_add_u32 m0, s66, 28672
    s_add_u32 s74, s76, 603904
    buffer_load_dwordx4 v4, s[32:35], s74 offen lds
    s_add_u32 m0, s66, 32768
    s_add_u32 s74, s76, 689920
    buffer_load_dwordx4 v4, s[32:35], s74 offen lds
    s_waitcnt lgkmcnt(4)
    v_mfma_f32_16x16x32_bf16 v[144:147], v[208:211], v[56:59], v[144:147]
    v_mfma_f32_16x16x32_bf16 v[148:151], v[212:215], v[56:59], v[148:151]
    v_mfma_f32_16x16x32_bf16 v[152:155], v[208:211], v[112:115], v[152:155]
    v_mfma_f32_16x16x32_bf16 v[156:159], v[212:215], v[112:115], v[156:159]
    s_barrier
    ds_read_b64_tr_b16 v[224:225], v26 offset:0
    ds_read_b64_tr_b16 v[226:227], v26 offset:512
    ds_read_b64_tr_b16 v[228:229], v27 offset:0
    ds_read_b64_tr_b16 v[230:231], v27 offset:512
    s_add_u32 m0, s66, 36864
    s_add_u32 s74, s76, 775936
    buffer_load_dwordx4 v4, s[32:35], s74 offen lds
    s_add_u32 m0, s66, 40960
    s_add_u32 s74, s76, 861952
    buffer_load_dwordx4 v4, s[32:35], s74 offen lds
    s_waitcnt lgkmcnt(4)
    v_mfma_f32_16x16x32_bf16 v[144:147], v[216:219], v[60:63], v[144:147]
    v_mfma_f32_16x16x32_bf16 v[148:151], v[220:223], v[60:63], v[148:151]
    v_mfma_f32_16x16x32_bf16 v[152:155], v[216:219], v[116:119], v[152:155]
    v_mfma_f32_16x16x32_bf16 v[156:159], v[220:223], v[116:119], v[156:159]
    ds_read_b64_tr_b16 v[208:209], v26 offset:4096
    ds_read_b64_tr_b16 v[210:211], v26 offset:4608
    ds_read_b64_tr_b16 v[212:213], v27 offset:4096
    ds_read_b64_tr_b16 v[214:215], v27 offset:4608
    s_add_u32 m0, s66, 45056
    s_add_u32 s74, s76, 947968
    buffer_load_dwordx4 v4, s[32:35], s74 offen lds
    s_add_u32 m0, s66, 49152
    s_add_u32 s74, s76, 1033984
    buffer_load_dwordx4 v4, s[32:35], s74 offen lds
    s_waitcnt lgkmcnt(4)
    v_mfma_f32_16x16x32_bf16 v[144:147], v[224:227], v[64:67], v[144:147]
    v_mfma_f32_16x16x32_bf16 v[148:151], v[228:231], v[64:67], v[148:151]
    v_mfma_f32_16x16x32_bf16 v[152:155], v[224:227], v[120:123], v[152:155]
    v_mfma_f32_16x16x32_bf16 v[156:159], v[228:231], v[120:123], v[156:159]
    ds_read_b64_tr_b16 v[216:217], v26 offset:8192
    ds_read_b64_tr_b16 v[218:219], v26 offset:8704
    ds_read_b64_tr_b16 v[220:221], v27 offset:8192
    ds_read_b64_tr_b16 v[222:223], v27 offset:8704
    s_add_u32 m0, s66, 53248
    s_add_u32 s74, s76, 1120000
    buffer_load_dwordx4 v4, s[32:35], s74 offen lds
    s_waitcnt lgkmcnt(4)
    v_mfma_f32_16x16x32_bf16 v[144:147], v[208:211], v[68:71], v[144:147]
    v_mfma_f32_16x16x32_bf16 v[148:151], v[212:215], v[68:71], v[148:151]
    v_mfma_f32_16x16x32_bf16 v[152:155], v[208:211], v[124:127], v[152:155]
    v_mfma_f32_16x16x32_bf16 v[156:159], v[212:215], v[124:127], v[156:159]
    ds_read_b64_tr_b16 v[224:225], v26 offset:12288
    ds_read_b64_tr_b16 v[226:227], v26 offset:12800
    ds_read_b64_tr_b16 v[228:229], v27 offset:12288
    ds_read_b64_tr_b16 v[230:231], v27 offset:12800
    s_waitcnt lgkmcnt(4)
    v_mfma_f32_16x16x32_bf16 v[144:147], v[216:219], v[72:75], v[144:147]
    v_mfma_f32_16x16x32_bf16 v[148:151], v[220:223], v[72:75], v[148:151]
    v_mfma_f32_16x16x32_bf16 v[152:155], v[216:219], v[128:131], v[152:155]
    v_mfma_f32_16x16x32_bf16 v[156:159], v[220:223], v[128:131], v[156:159]
    ds_read_b64_tr_b16 v[208:209], v26 offset:16384
    ds_read_b64_tr_b16 v[210:211], v26 offset:16896
    ds_read_b64_tr_b16 v[212:213], v27 offset:16384
    ds_read_b64_tr_b16 v[214:215], v27 offset:16896
    s_waitcnt lgkmcnt(4)
    v_mfma_f32_16x16x32_bf16 v[144:147], v[224:227], v[76:79], v[144:147]
    v_mfma_f32_16x16x32_bf16 v[148:151], v[228:231], v[76:79], v[148:151]
    v_mfma_f32_16x16x32_bf16 v[152:155], v[224:227], v[132:135], v[152:155]
    v_mfma_f32_16x16x32_bf16 v[156:159], v[228:231], v[132:135], v[156:159]
    s_waitcnt vmcnt(8)
    s_barrier
    ds_read_b64_tr_b16 v[216:217], v26 offset:20480
    ds_read_b64_tr_b16 v[218:219], v26 offset:20992
    ds_read_b64_tr_b16 v[220:221], v27 offset:20480
    ds_read_b64_tr_b16 v[222:223], v27 offset:20992
    s_add_u32 m0, s66, 135168
    s_add_u32 s74, s76, 86016
    buffer_load_dwordx4 v4, s[32:35], s74 offen lds
    s_add_u32 m0, s66, 143360
    s_add_u32 s74, s76, 258048
    buffer_load_dwordx4 v4, s[32:35], s74 offen lds
    s_waitcnt lgkmcnt(4)
    v_mfma_f32_16x16x32_bf16 v[144:147], v[208:211], v[80:83], v[144:147]
    v_mfma_f32_16x16x32_bf16 v[148:151], v[212:215], v[80:83], v[148:151]
    v_mfma_f32_16x16x32_bf16 v[152:155], v[208:211], v[136:139], v[152:155]
    v_mfma_f32_16x16x32_bf16 v[156:159], v[212:215], v[136:139], v[156:159]
    ds_read_b64_tr_b16 v[224:225], v24 offset:0
    ds_read_b64_tr_b16 v[226:227], v24 offset:512
    ds_read_b64_tr_b16 v[228:229], v25 offset:0
    ds_read_b64_tr_b16 v[230:231], v25 offset:512
    ds_read_b128 v[240:243], v10 offset:0
    s_add_u32 m0, s66, 151552
    s_add_u32 s74, s76, 430080
    buffer_load_dwordx4 v4, s[32:35], s74 offen lds
    v_and_b32 v12, 15, v1
    v_lshrrev_b32 v13, 4, v1
    v_lshlrev_b32 v13, 2, v13
    v_sub_u32 v12, v12, v13
    v_mov_b32 v14, 0xf149f2ca
    v_mov_b32 v15, 0
    s_or_b32 s82, s81, s61
    s_cmp_eq_u32 s82, 0
    s_cselect_b32 s78, 0xf149f2ca, 0
    s_waitcnt lgkmcnt(5)
    v_mfma_f32_16x16x32_bf16 v[144:147], v[216:219], v[84:87], v[144:147]
    v_mfma_f32_16x16x32_bf16 v[148:151], v[220:223], v[84:87], v[148:151]
    v_mfma_f32_16x16x32_bf16 v[152:155], v[216:219], v[140:143], v[152:155]
    v_mfma_f32_16x16x32_bf16 v[156:159], v[220:223], v[140:143], v[156:159]
    ds_read_b64_tr_b16 v[208:209], v24 offset:4096
    ds_read_b64_tr_b16 v[210:211], v24 offset:4608
    ds_read_b64_tr_b16 v[212:213], v25 offset:4096
    ds_read_b64_tr_b16 v[214:215], v25 offset:4608
    ds_read_b128 v[232:235], v11 offset:0
    s_add_u32 m0, s66, 159744
    s_add_u32 s74, s76, 602112
    buffer_load_dwordx4 v4, s[32:35], s74 offen lds
    v_subrev_u32 v13, 0, v12
    v_and_b32 v19, 0x80000001, v13
    v_cmp_eq_u32 vcc, 0, v19
    v_mov_b32 v20, 0x0000ffff
    s_nop 0
    v_cndmask_b32 v196, v14, v15, vcc
    v_cndmask_b32 v21, v15, v20, vcc
    v_cvt_pk_bf16_f32 v168, v144, v145
    v_cvt_pk_bf16_f32 v169, v146, v147
    v_cvt_pk_bf16_f32 v170, v148, v149
    v_cvt_pk_bf16_f32 v171, v150, v151
    v_cvt_pk_bf16_f32 v172, v152, v153
    v_cvt_pk_bf16_f32 v173, v154, v155
    v_cvt_pk_bf16_f32 v174, v156, v157
    v_cvt_pk_bf16_f32 v175, v158, v159
    ds_write_b128 v29, v[172:175]
    s_waitcnt lgkmcnt(6)
    v_mfma_f32_16x16x32_bf16 v[144:147], v[32:35], v[224:227], 0
    v_mfma_f32_16x16x32_bf16 v[148:151], v[32:35], v[228:231], 0
    v_mfma_f32_16x16x32_bf16 v[152:155], v[88:91], v[224:227], 0
    v_mfma_f32_16x16x32_bf16 v[156:159], v[88:91], v[228:231], 0
    v_mfma_f32_16x16x32_bf16 v[160:163], v[240:243], v[224:227], 0
    s_barrier
    ds_read_b64_tr_b16 v[216:217], v24 offset:8192
    ds_read_b64_tr_b16 v[218:219], v24 offset:8704
    ds_read_b64_tr_b16 v[220:221], v25 offset:8192
    ds_read_b64_tr_b16 v[222:223], v25 offset:8704
    ds_read_b128 v[236:239], v10 offset:128
    s_add_u32 m0, s66, 110592
    s_add_u32 s74, s76, 774144
    buffer_load_dwordx4 v4, s[32:35], s74 offen lds
    v_cmp_eq_u32 vcc, 0x80000000, v19
    s_nop 1
    v_cndmask_b32 v200, v14, v15, vcc
    v_cndmask_b32 v252, v15, v20, vcc
    v_min_f32 v204, s78, v200
    s_waitcnt lgkmcnt(6)
    v_mfma_f32_16x16x32_bf16 v[144:147], v[36:39], v[208:211], v[144:147]
    v_mfma_f32_16x16x32_bf16 v[148:151], v[36:39], v[212:215], v[148:151]
    v_mfma_f32_16x16x32_bf16 v[152:155], v[92:95], v[208:211], v[152:155]
    v_mfma_f32_16x16x32_bf16 v[156:159], v[92:95], v[212:215], v[156:159]
    v_mfma_f32_16x16x32_bf16 v[160:163], v[232:235], v[208:211], v[160:163]
    ds_read_b64_tr_b16 v[224:225], v24 offset:12288
    ds_read_b64_tr_b16 v[226:227], v24 offset:12800
    ds_read_b64_tr_b16 v[228:229], v25 offset:12288
    ds_read_b64_tr_b16 v[230:231], v25 offset:12800
    ds_read_b128 v[240:243], v11 offset:128
    s_add_u32 m0, s66, 118784
    s_add_u32 s74, s76, 946176
    buffer_load_dwordx4 v4, s[32:35], s74 offen lds
    v_subrev_u32 v13, 1, v12
    v_and_b32 v19, 0x80000001, v13
    v_cmp_eq_u32 vcc, 0, v19
    v_mov_b32 v20, 0xffff0000
    s_nop 0
    v_cndmask_b32 v197, v14, v15, vcc
    v_cndmask_b32 v22, v15, v20, vcc
    s_waitcnt lgkmcnt(5)
    v_mfma_f32_16x16x32_bf16 v[144:147], v[40:43], v[216:219], v[144:147]
    v_mfma_f32_16x16x32_bf16 v[148:151], v[40:43], v[220:223], v[148:151]
    v_mfma_f32_16x16x32_bf16 v[152:155], v[96:99], v[216:219], v[152:155]
    v_mfma_f32_16x16x32_bf16 v[156:159], v[96:99], v[220:223], v[156:159]
    v_mfma_f32_16x16x32_bf16 v[160:163], v[236:239], v[216:219], v[160:163]
    ds_read_b64_tr_b16 v[208:209], v24 offset:16384
    ds_read_b64_tr_b16 v[210:211], v24 offset:16896
    ds_read_b64_tr_b16 v[212:213], v25 offset:16384
    ds_read_b64_tr_b16 v[214:215], v25 offset:16896
    ds_read_b128 v[232:235], v10 offset:256
    s_add_u32 m0, s66, 126976
    s_add_u32 s74, s76, 1118208
    buffer_load_dwordx4 v4, s[32:35], s74 offen lds
    v_cmp_eq_u32 vcc, 0x80000000, v19
    v_or_b32 v246, v21, v22
    s_waitcnt lgkmcnt(5)
    v_mfma_f32_16x16x32_bf16 v[144:147], v[44:47], v[224:227], v[144:147]
    v_mfma_f32_16x16x32_bf16 v[148:151], v[44:47], v[228:231], v[148:151]
    v_mfma_f32_16x16x32_bf16 v[152:155], v[100:103], v[224:227], v[152:155]
    v_mfma_f32_16x16x32_bf16 v[156:159], v[100:103], v[228:231], v[156:159]
    v_mfma_f32_16x16x32_bf16 v[160:163], v[240:243], v[224:227], v[160:163]
    s_waitcnt vmcnt(7)
    s_barrier
    ds_read_b64_tr_b16 v[216:217], v24 offset:20480
    ds_read_b64_tr_b16 v[218:219], v24 offset:20992
    ds_read_b64_tr_b16 v[220:221], v25 offset:20480
    ds_read_b64_tr_b16 v[222:223], v25 offset:20992
    ds_read_b128 v[236:239], v11 offset:256
    v_cndmask_b32 v201, v14, v15, vcc
    v_cndmask_b32 v253, v15, v20, vcc
    v_or_b32 v244, v252, v253
    v_min_f32 v205, s78, v201
    s_waitcnt lgkmcnt(5)
    v_mfma_f32_16x16x32_bf16 v[144:147], v[48:51], v[208:211], v[144:147]
    v_mfma_f32_16x16x32_bf16 v[148:151], v[48:51], v[212:215], v[148:151]
    v_mfma_f32_16x16x32_bf16 v[152:155], v[104:107], v[208:211], v[152:155]
    v_mfma_f32_16x16x32_bf16 v[156:159], v[104:107], v[212:215], v[156:159]
    v_mfma_f32_16x16x32_bf16 v[160:163], v[232:235], v[208:211], v[160:163]
    ds_read_b64_tr_b16 v[224:225], v24 offset:24576
    ds_read_b64_tr_b16 v[226:227], v24 offset:25088
    ds_read_b64_tr_b16 v[228:229], v25 offset:24576
    ds_read_b64_tr_b16 v[230:231], v25 offset:25088
    ds_read_b128 v[240:243], v10 offset:384
    v_subrev_u32 v13, 2, v12
    v_and_b32 v19, 0x80000001, v13
    v_cmp_eq_u32 vcc, 0, v19
    v_mov_b32 v20, 0x0000ffff
    s_nop 0
    v_cndmask_b32 v198, v14, v15, vcc
    v_cndmask_b32 v21, v15, v20, vcc
    s_waitcnt lgkmcnt(5)
    v_mfma_f32_16x16x32_bf16 v[144:147], v[52:55], v[216:219], v[144:147]
    v_mfma_f32_16x16x32_bf16 v[148:151], v[52:55], v[220:223], v[148:151]
    v_mfma_f32_16x16x32_bf16 v[152:155], v[108:111], v[216:219], v[152:155]
    v_mfma_f32_16x16x32_bf16 v[156:159], v[108:111], v[220:223], v[156:159]
    v_mfma_f32_16x16x32_bf16 v[160:163], v[236:239], v[216:219], v[160:163]
    ds_read_b64_tr_b16 v[208:209], v24 offset:28672
    ds_read_b64_tr_b16 v[210:211], v24 offset:29184
    ds_read_b64_tr_b16 v[212:213], v25 offset:28672
    ds_read_b64_tr_b16 v[214:215], v25 offset:29184
    ds_read_b128 v[232:235], v11 offset:384
    v_mul_u32_u24 v251, 7, v255
    s_and_b32 s75, s64, 3
    s_lshl_b32 s75, s75, 3
    s_add_u32 s75, s75, s60
    s_lshl_b32 s74, s75, 5
    s_cmp_ge_u32 s75, 12
    s_cselect_b32 s73, 256, 0
    s_add_u32 s74, s74, s73
    s_cmp_ge_u32 s75, 22
    s_cselect_b32 s73, 256, 0
    s_add_u32 s74, s74, s73
    s_mul_i32 s74, s74, 896
    s_add_u32 s74, s74, s65
    s_mov_b64 exec, 0xffffffff
    buffer_load_dword v254, v251, s[44:47], s74 offen sc1
    s_mul_i32 s74, s75, 7168
    s_add_u32 s74, s74, s65
    s_mov_b64 exec, 0xff
    buffer_load_dword v254, v251, s[48:51], s74 offen sc1
    s_mov_b64 exec, -1
    v_cmp_eq_u32 vcc, 0x80000000, v19
    s_nop 1
    v_cndmask_b32 v202, v14, v15, vcc
    v_cndmask_b32 v252, v15, v20, vcc
    v_min_f32 v206, s78, v202
    s_waitcnt lgkmcnt(5)
    v_mfma_f32_16x16x32_bf16 v[144:147], v[56:59], v[224:227], v[144:147]
    v_mfma_f32_16x16x32_bf16 v[148:151], v[56:59], v[228:231], v[148:151]
    v_mfma_f32_16x16x32_bf16 v[152:155], v[112:115], v[224:227], v[152:155]
    v_mfma_f32_16x16x32_bf16 v[156:159], v[112:115], v[228:231], v[156:159]
    v_mfma_f32_16x16x32_bf16 v[160:163], v[240:243], v[224:227], v[160:163]
    ds_read_b64_tr_b16 v[216:217], v24 offset:32768
    ds_read_b64_tr_b16 v[218:219], v24 offset:33280
    ds_read_b64_tr_b16 v[220:221], v25 offset:32768
    ds_read_b64_tr_b16 v[222:223], v25 offset:33280
    ds_read_b128 v[236:239], v10 offset:512
    v_subrev_u32 v13, 3, v12
    v_and_b32 v19, 0x80000001, v13
    v_cmp_eq_u32 vcc, 0, v19
    v_mov_b32 v20, 0xffff0000
    s_nop 0
    v_cndmask_b32 v199, v14, v15, vcc
    v_cndmask_b32 v22, v15, v20, vcc
    s_waitcnt lgkmcnt(5)
    v_mfma_f32_16x16x32_bf16 v[144:147], v[60:63], v[208:211], v[144:147]
    v_mfma_f32_16x16x32_bf16 v[148:151], v[60:63], v[212:215], v[148:151]
    v_mfma_f32_16x16x32_bf16 v[152:155], v[116:119], v[208:211], v[152:155]
    v_mfma_f32_16x16x32_bf16 v[156:159], v[116:119], v[212:215], v[156:159]
    v_mfma_f32_16x16x32_bf16 v[160:163], v[232:235], v[208:211], v[160:163]
    ds_read_b64_tr_b16 v[224:225], v24 offset:36864
    ds_read_b64_tr_b16 v[226:227], v24 offset:37376
    ds_read_b64_tr_b16 v[228:229], v25 offset:36864
    ds_read_b64_tr_b16 v[230:231], v25 offset:37376
    ds_read_b128 v[240:243], v11 offset:512
    v_cmp_eq_u32 vcc, 0x80000000, v19
    v_or_b32 v247, v21, v22
    s_waitcnt lgkmcnt(5)
    v_mfma_f32_16x16x32_bf16 v[144:147], v[64:67], v[216:219], v[144:147]
    v_mfma_f32_16x16x32_bf16 v[148:151], v[64:67], v[220:223], v[148:151]
    v_mfma_f32_16x16x32_bf16 v[152:155], v[120:123], v[216:219], v[152:155]
    v_mfma_f32_16x16x32_bf16 v[156:159], v[120:123], v[220:223], v[156:159]
    v_mfma_f32_16x16x32_bf16 v[160:163], v[236:239], v[216:219], v[160:163]
    ds_read_b64_tr_b16 v[208:209], v24 offset:40960
    ds_read_b64_tr_b16 v[210:211], v24 offset:41472
    ds_read_b64_tr_b16 v[212:213], v25 offset:40960
    ds_read_b64_tr_b16 v[214:215], v25 offset:41472
    ds_read_b128 v[232:235], v10 offset:640
    v_cndmask_b32 v203, v14, v15, vcc
    v_cndmask_b32 v253, v15, v20, vcc
    v_or_b32 v245, v252, v253
    v_min_f32 v207, s78, v203
    s_waitcnt lgkmcnt(5)
    v_mfma_f32_16x16x32_bf16 v[144:147], v[68:71], v[224:227], v[144:147]
    v_mfma_f32_16x16x32_bf16 v[148:151], v[68:71], v[228:231], v[148:151]
    v_mfma_f32_16x16x32_bf16 v[152:155], v[124:127], v[224:227], v[152:155]
    v_mfma_f32_16x16x32_bf16 v[156:159], v[124:127], v[228:231], v[156:159]
    v_mfma_f32_16x16x32_bf16 v[160:163], v[240:243], v[224:227], v[160:163]
    ds_read_b64_tr_b16 v[216:217], v24 offset:45056
    ds_read_b64_tr_b16 v[218:219], v24 offset:45568
    ds_read_b64_tr_b16 v[220:221], v25 offset:45056
    ds_read_b64_tr_b16 v[222:223], v25 offset:45568
    ds_read_b128 v[236:239], v11 offset:640
    v_cmp_gt_u32 vcc, 48, v1
    v_mov_b32 v19, 0x3e8b97f6
    s_nop 0
    v_cndmask_b32 v20, v15, v19, vcc
    v_cndmask_b32 v21, 0, -1, vcc
    v_lshrrev_b32 v12, 4, v1
    v_and_b32 v13, 15, v1
    v_lshlrev_b32 v13, 4, v13
    v_lshl_add_u32 v22, v12, 9, v13
    s_waitcnt lgkmcnt(5)
    v_mfma_f32_16x16x32_bf16 v[144:147], v[72:75], v[208:211], v[144:147]
    v_mfma_f32_16x16x32_bf16 v[148:151], v[72:75], v[212:215], v[148:151]
    v_mfma_f32_16x16x32_bf16 v[152:155], v[128:131], v[208:211], v[152:155]
    v_mfma_f32_16x16x32_bf16 v[156:159], v[128:131], v[212:215], v[156:159]
    v_mfma_f32_16x16x32_bf16 v[160:163], v[232:235], v[208:211], v[160:163]
    ds_read_b64_tr_b16 v[224:225], v24 offset:49152
    ds_read_b64_tr_b16 v[226:227], v24 offset:49664
    ds_read_b64_tr_b16 v[228:229], v25 offset:49152
    ds_read_b64_tr_b16 v[230:231], v25 offset:49664
    ds_read_b128 v[240:243], v10 offset:768
    s_lshl_b32 s79, s61, 2
    s_add_u32 s79, s79, s81
    s_mul_i32 s79, s79, 145
    s_lshl_b32 s83, s62, 1
    s_add_u32 s82, s80, s83
    s_lshl_b32 s82, s82, 1
    s_add_u32 s79, s79, s82
    s_add_u32 s79, s79, 112
    s_lshl_b32 s79, s79, 10
    s_add_u32 s79, s79, 1048576
    s_waitcnt lgkmcnt(5)
    v_mfma_f32_16x16x32_bf16 v[144:147], v[76:79], v[216:219], v[144:147]
    v_mfma_f32_16x16x32_bf16 v[148:151], v[76:79], v[220:223], v[148:151]
    v_mfma_f32_16x16x32_bf16 v[152:155], v[132:135], v[216:219], v[152:155]
    v_mfma_f32_16x16x32_bf16 v[156:159], v[132:135], v[220:223], v[156:159]
    v_mfma_f32_16x16x32_bf16 v[160:163], v[236:239], v[216:219], v[160:163]
    s_waitcnt vmcnt(5)
    s_barrier
    ds_read_b64_tr_b16 v[208:209], v24 offset:53248
    ds_read_b64_tr_b16 v[210:211], v24 offset:53760
    ds_read_b64_tr_b16 v[212:213], v25 offset:53248
    ds_read_b64_tr_b16 v[214:215], v25 offset:53760
    ds_read_b128 v[232:235], v11 offset:768
    s_waitcnt lgkmcnt(5)
    v_mfma_f32_16x16x32_bf16 v[144:147], v[80:83], v[224:227], v[144:147]
    v_mfma_f32_16x16x32_bf16 v[148:151], v[80:83], v[228:231], v[148:151]
    v_mfma_f32_16x16x32_bf16 v[152:155], v[136:139], v[224:227], v[152:155]
    v_mfma_f32_16x16x32_bf16 v[156:159], v[136:139], v[228:231], v[156:159]
    v_mfma_f32_16x16x32_bf16 v[160:163], v[240:243], v[224:227], v[160:163]
    ds_read_b64_tr_b16 v[216:217], v26 offset:24576
    ds_read_b64_tr_b16 v[218:219], v26 offset:25088
    ds_read_b64_tr_b16 v[220:221], v27 offset:24576
    ds_read_b64_tr_b16 v[222:223], v27 offset:25088
    s_waitcnt lgkmcnt(4)
    v_mfma_f32_16x16x32_bf16 v[144:147], v[84:87], v[208:211], v[144:147]
    v_mfma_f32_16x16x32_bf16 v[148:151], v[84:87], v[212:215], v[148:151]
    v_mfma_f32_16x16x32_bf16 v[152:155], v[140:143], v[208:211], v[152:155]
    v_mfma_f32_16x16x32_bf16 v[156:159], v[140:143], v[212:215], v[156:159]
    v_mfma_f32_16x16x32_bf16 v[160:163], v[232:235], v[208:211], v[160:163]
    ds_read_b64_tr_b16 v[224:225], v26 offset:28672
    ds_read_b64_tr_b16 v[226:227], v26 offset:29184
    ds_read_b64_tr_b16 v[228:229], v27 offset:28672
    ds_read_b64_tr_b16 v[230:231], v27 offset:29184
    v_cvt_pk_bf16_f32 v178, v144, v145
    v_cvt_pk_bf16_f32 v179, v146, v147
    v_cvt_pk_bf16_f32 v184, v148, v149
    v_cvt_pk_bf16_f32 v185, v150, v151
    v_cvt_pk_bf16_f32 v180, v152, v153
    v_cvt_pk_bf16_f32 v181, v154, v155
    v_cvt_pk_bf16_f32 v186, v156, v157
    v_cvt_pk_bf16_f32 v187, v158, v159
    ds_write_b64 v29, v[180:181] offset:1024
    ds_write_b64 v29, v[186:187] offset:1032
    v_cvt_pk_bf16_f32 v248, v160, v161
    v_cvt_pk_bf16_f32 v249, v162, v163
    ds_write_b64 v18, v[248:249] offset:1024
    s_waitcnt lgkmcnt(7)
    v_mfma_f32_16x16x32_bf16 v[144:147], v[216:219], v[32:35], 0
    v_mfma_f32_16x16x32_bf16 v[148:151], v[220:223], v[32:35], 0
    v_mfma_f32_16x16x32_bf16 v[152:155], v[216:219], v[88:91], 0
    v_mfma_f32_16x16x32_bf16 v[156:159], v[220:223], v[88:91], 0
    ds_read_b64_tr_b16 v[208:209], v26 offset:32768
    ds_read_b64_tr_b16 v[210:211], v26 offset:33280
    ds_read_b64_tr_b16 v[212:213], v27 offset:32768
    ds_read_b64_tr_b16 v[214:215], v27 offset:33280
    s_waitcnt lgkmcnt(7)
    v_mfma_f32_16x16x32_bf16 v[144:147], v[224:227], v[36:39], v[144:147]
    v_mfma_f32_16x16x32_bf16 v[148:151], v[228:231], v[36:39], v[148:151]
    v_mfma_f32_16x16x32_bf16 v[152:155], v[224:227], v[92:95], v[152:155]
    v_mfma_f32_16x16x32_bf16 v[156:159], v[228:231], v[92:95], v[156:159]
    s_waitcnt vmcnt(2)
    s_waitcnt lgkmcnt(4)
    s_barrier
    ds_read_b128 v[164:167], v28
    ds_read_b64 v[176:177], v28 offset:1024
    ds_read_b64 v[182:183], v28 offset:1032
    ds_read_b64_tr_b16 v[216:217], v26 offset:36864
    ds_read_b64_tr_b16 v[218:219], v26 offset:37376
    ds_read_b64_tr_b16 v[220:221], v27 offset:36864
    ds_read_b64_tr_b16 v[222:223], v27 offset:37376
    s_add_u32 m0, s66, 4096
    s_add_u32 s74, s65, 372736
    buffer_load_dwordx4 v31, s[44:47], s74 offen lds
    s_add_u32 m0, s66, 12288
    s_add_u32 s74, s65, 430080
    buffer_load_dwordx4 v31, s[44:47], s74 offen lds
    s_waitcnt lgkmcnt(7)
    v_mfma_f32_16x16x32_bf16 v[144:147], v[208:211], v[40:43], v[144:147]
    v_mfma_f32_16x16x32_bf16 v[148:151], v[212:215], v[40:43], v[148:151]
    v_mfma_f32_16x16x32_bf16 v[152:155], v[208:211], v[96:99], v[152:155]
    v_mfma_f32_16x16x32_bf16 v[156:159], v[212:215], v[96:99], v[156:159]
    ds_read_b64_tr_b16 v[224:225], v26 offset:40960
    ds_read_b64_tr_b16 v[226:227], v26 offset:41472
    ds_read_b64_tr_b16 v[228:229], v27 offset:40960
    ds_read_b64_tr_b16 v[230:231], v27 offset:41472
    s_add_u32 m0, s66, 20480
    s_add_u32 s74, s65, 888832
    buffer_load_dwordx4 v31, s[44:47], s74 offen lds
    s_waitcnt lgkmcnt(4)
    v_mfma_f32_16x16x32_bf16 v[144:147], v[216:219], v[44:47], v[144:147]
    v_mfma_f32_16x16x32_bf16 v[148:151], v[220:223], v[44:47], v[148:151]
    v_mfma_f32_16x16x32_bf16 v[152:155], v[216:219], v[100:103], v[152:155]
    v_mfma_f32_16x16x32_bf16 v[156:159], v[220:223], v[100:103], v[156:159]
    ds_read_b64_tr_b16 v[208:209], v26 offset:45056
    ds_read_b64_tr_b16 v[210:211], v26 offset:45568
    ds_read_b64_tr_b16 v[212:213], v27 offset:45056
    ds_read_b64_tr_b16 v[214:215], v27 offset:45568
    s_add_u32 m0, s66, 28672
    s_add_u32 s74, s65, 946176
    buffer_load_dwordx4 v31, s[44:47], s74 offen lds
    s_waitcnt lgkmcnt(4)
    v_mfma_f32_16x16x32_bf16 v[144:147], v[224:227], v[48:51], v[144:147]
    v_mfma_f32_16x16x32_bf16 v[148:151], v[228:231], v[48:51], v[148:151]
    v_mfma_f32_16x16x32_bf16 v[152:155], v[224:227], v[104:107], v[152:155]
    v_mfma_f32_16x16x32_bf16 v[156:159], v[228:231], v[104:107], v[156:159]
    ds_read_b64_tr_b16 v[216:217], v26 offset:49152
    ds_read_b64_tr_b16 v[218:219], v26 offset:49664
    ds_read_b64_tr_b16 v[220:221], v27 offset:49152
    ds_read_b64_tr_b16 v[222:223], v27 offset:49664
    s_add_u32 m0, s66, 36864
    s_add_u32 s74, s65, 1404928
    buffer_load_dwordx4 v31, s[44:47], s74 offen lds
    s_waitcnt lgkmcnt(4)
    v_mfma_f32_16x16x32_bf16 v[144:147], v[208:211], v[52:55], v[144:147]
    v_mfma_f32_16x16x32_bf16 v[148:151], v[212:215], v[52:55], v[148:151]
    v_mfma_f32_16x16x32_bf16 v[152:155], v[208:211], v[108:111], v[152:155]
    v_mfma_f32_16x16x32_bf16 v[156:159], v[212:215], v[108:111], v[156:159]
    ds_read_b64_tr_b16 v[224:225], v26 offset:53248
    ds_read_b64_tr_b16 v[226:227], v26 offset:53760
    ds_read_b64_tr_b16 v[228:229], v27 offset:53248
    ds_read_b64_tr_b16 v[230:231], v27 offset:53760
    s_add_u32 m0, s66, 45056
    s_add_u32 s74, s65, 1462272
    buffer_load_dwordx4 v31, s[44:47], s74 offen lds
    s_add_u32 m0, s66, 53248
    s_add_u32 s74, s65, 229376
    buffer_load_dwordx4 v31, s[48:51], s74 offen lds
    s_waitcnt lgkmcnt(4)
    v_mfma_f32_16x16x32_bf16 v[144:147], v[216:219], v[56:59], v[144:147]
    v_mfma_f32_16x16x32_bf16 v[148:151], v[220:223], v[56:59], v[148:151]
    v_mfma_f32_16x16x32_bf16 v[152:155], v[216:219], v[112:115], v[152:155]
    v_mfma_f32_16x16x32_bf16 v[156:159], v[220:223], v[112:115], v[156:159]
    ds_read_b64_tr_b16 v[208:209], v26 offset:0
    ds_read_b64_tr_b16 v[210:211], v26 offset:512
    ds_read_b64_tr_b16 v[212:213], v27 offset:0
    ds_read_b64_tr_b16 v[214:215], v27 offset:512
    s_add_u32 m0, s66, 61440
    s_add_u32 s74, s65, 279552
    buffer_load_dwordx4 v31, s[48:51], s74 offen lds
    s_waitcnt lgkmcnt(4)
    v_mfma_f32_16x16x32_bf16 v[144:147], v[224:227], v[60:63], v[144:147]
    v_mfma_f32_16x16x32_bf16 v[148:151], v[228:231], v[60:63], v[148:151]
    v_mfma_f32_16x16x32_bf16 v[152:155], v[224:227], v[116:119], v[152:155]
    v_mfma_f32_16x16x32_bf16 v[156:159], v[228:231], v[116:119], v[156:159]
    ds_read_b64_tr_b16 v[216:217], v26 offset:4096
    ds_read_b64_tr_b16 v[218:219], v26 offset:4608
    ds_read_b64_tr_b16 v[220:221], v27 offset:4096
    ds_read_b64_tr_b16 v[222:223], v27 offset:4608
    s_add_u32 m0, s66, 69632
    s_add_u32 s74, s65, 487424
    buffer_load_dwordx4 v31, s[44:47], s74 offen lds
    s_waitcnt lgkmcnt(4)
    v_mfma_f32_16x16x32_bf16 v[144:147], v[208:211], v[64:67], v[144:147]
    v_mfma_f32_16x16x32_bf16 v[148:151], v[212:215], v[64:67], v[148:151]
    v_mfma_f32_16x16x32_bf16 v[152:155], v[208:211], v[120:123], v[152:155]
    v_mfma_f32_16x16x32_bf16 v[156:159], v[212:215], v[120:123], v[156:159]
    ds_read_b64_tr_b16 v[224:225], v26 offset:8192
    ds_read_b64_tr_b16 v[226:227], v26 offset:8704
    ds_read_b64_tr_b16 v[228:229], v27 offset:8192
    ds_read_b64_tr_b16 v[230:231], v27 offset:8704
    s_add_u32 m0, s66, 102400
    s_add_u32 s74, s65, 1519616
    buffer_load_dwordx4 v31, s[44:47], s74 offen lds
    s_waitcnt lgkmcnt(4)
    v_mfma_f32_16x16x32_bf16 v[144:147], v[216:219], v[68:71], v[144:147]
    v_mfma_f32_16x16x32_bf16 v[148:151], v[220:223], v[68:71], v[148:151]
    v_mfma_f32_16x16x32_bf16 v[152:155], v[216:219], v[124:127], v[152:155]
    v_mfma_f32_16x16x32_bf16 v[156:159], v[220:223], v[124:127], v[156:159]
    s_barrier
    ds_read_b64_tr_b16 v[208:209], v26 offset:12288
    ds_read_b64_tr_b16 v[210:211], v26 offset:12800
    ds_read_b64_tr_b16 v[212:213], v27 offset:12288
    ds_read_b64_tr_b16 v[214:215], v27 offset:12800
    s_add_u32 m0, s66, 77824
    s_add_u32 s74, s65, 544768
    buffer_load_dwordx4 v31, s[44:47], s74 offen lds
    s_add_u32 m0, s66, 86016
    s_add_u32 s74, s65, 1003520
    buffer_load_dwordx4 v31, s[44:47], s74 offen lds
    s_waitcnt lgkmcnt(4)
    v_mfma_f32_16x16x32_bf16 v[144:147], v[224:227], v[72:75], v[144:147]
    v_mfma_f32_16x16x32_bf16 v[148:151], v[228:231], v[72:75], v[148:151]
    v_mfma_f32_16x16x32_bf16 v[152:155], v[224:227], v[128:131], v[152:155]
    v_mfma_f32_16x16x32_bf16 v[156:159], v[228:231], v[128:131], v[156:159]
    ds_read_b64_tr_b16 v[216:217], v26 offset:16384
    ds_read_b64_tr_b16 v[218:219], v26 offset:16896
    ds_read_b64_tr_b16 v[220:221], v27 offset:16384
    ds_read_b64_tr_b16 v[222:223], v27 offset:16896
    s_add_u32 m0, s66, 94208
    s_add_u32 s74, s65, 1060864
    buffer_load_dwordx4 v31, s[44:47], s74 offen lds
    s_waitcnt lgkmcnt(4)
    v_mfma_f32_16x16x32_bf16 v[144:147], v[208:211], v[76:79], v[144:147]
    v_mfma_f32_16x16x32_bf16 v[148:151], v[212:215], v[76:79], v[148:151]
    v_mfma_f32_16x16x32_bf16 v[152:155], v[208:211], v[132:135], v[152:155]
    v_mfma_f32_16x16x32_bf16 v[156:159], v[212:215], v[132:135], v[156:159]
    ds_read_b64_tr_b16 v[224:225], v26 offset:20480
    ds_read_b64_tr_b16 v[226:227], v26 offset:20992
    ds_read_b64_tr_b16 v[228:229], v27 offset:20480
    ds_read_b64_tr_b16 v[230:231], v27 offset:20992
    s_add_u32 m0, s66, 135168
    s_add_u32 s74, s65, 28672
    buffer_load_dwordx4 v31, s[44:47], s74 offen lds
    s_add_u32 m0, s66, 143360
    s_add_u32 s74, s65, 602112
    buffer_load_dwordx4 v31, s[44:47], s74 offen lds
    s_waitcnt lgkmcnt(4)
    v_mfma_f32_16x16x32_bf16 v[144:147], v[216:219], v[80:83], v[144:147]
    v_mfma_f32_16x16x32_bf16 v[148:151], v[220:223], v[80:83], v[148:151]
    v_mfma_f32_16x16x32_bf16 v[152:155], v[216:219], v[136:139], v[152:155]
    v_mfma_f32_16x16x32_bf16 v[156:159], v[220:223], v[136:139], v[156:159]
    s_add_u32 m0, s66, 151552
    s_add_u32 s74, s65, 1118208
    buffer_load_dwordx4 v31, s[44:47], s74 offen lds
    s_waitcnt lgkmcnt(0)
    v_mfma_f32_16x16x32_bf16 v[144:147], v[224:227], v[84:87], v[144:147]
    v_mfma_f32_16x16x32_bf16 v[148:151], v[228:231], v[84:87], v[148:151]
    v_mfma_f32_16x16x32_bf16 v[152:155], v[224:227], v[140:143], v[152:155]
    v_mfma_f32_16x16x32_bf16 v[156:159], v[228:231], v[140:143], v[156:159]
    s_waitcnt vmcnt(8)
    s_barrier
    s_add_u32 m0, s66, 159744
    s_add_u32 s74, s65, 28672
    buffer_load_dwordx4 v31, s[48:51], s74 offen lds
    v_mul_f32 v144, v19, v144
    v_mul_f32 v145, v19, v145
    v_mul_f32 v146, v19, v146
    v_mul_f32 v147, v19, v147
    v_mul_f32 v148, v20, v148
    v_mul_f32 v149, v20, v149
    v_mul_f32 v150, v20, v150
    v_mul_f32 v151, v20, v151
    v_cvt_pk_bf16_f32 v188, v144, v145
    v_cvt_pk_bf16_f32 v189, v146, v147
    v_cvt_pk_bf16_f32 v190, v148, v149
    v_cvt_pk_bf16_f32 v191, v150, v151
    v_mul_f32 v152, v19, v152
    v_mul_f32 v153, v19, v153
    v_mul_f32 v154, v19, v154
    v_mul_f32 v155, v19, v155
    v_mul_f32 v156, v20, v156
    v_mul_f32 v157, v20, v157
    v_mul_f32 v158, v20, v158
    v_mul_f32 v159, v20, v159
    v_cvt_pk_bf16_f32 v192, v152, v153
    v_cvt_pk_bf16_f32 v193, v154, v155
    v_cvt_pk_bf16_f32 v194, v156, v157
    v_cvt_pk_bf16_f32 v195, v158, v159
    s_waitcnt lgkmcnt(0)
    v_mfma_f32_16x16x32_bf16 v[144:147], v[164:167], v[188:191], v[204:207]
    v_mfma_f32_16x16x32_bf16 v[148:151], v[168:171], v[188:191], v[196:199]
    v_mfma_f32_16x16x32_bf16 v[152:155], v[168:171], v[192:195], v[200:203]
    v_mfma_f32_16x16x32_bf16 v[156:159], v[172:175], v[192:195], v[196:199]
    s_nop 5
    v_max3_f32 v208, v144, v145, v148
    s_nop 0
    v_max3_f32 v212, v152, v153, v156
    v_max3_f32 v209, v146, v147, v150
    v_max3_f32 v213, v154, v155, v158
    v_max_f32 v208, v208, v149
    v_max_f32 v212, v212, v157
    v_max_f32 v209, v209, v151
    v_max_f32 v213, v213, v159
    v_max_f32 v210, v208, v209
    v_max_f32 v214, v212, v213
    v_mov_b32 v211, v210
    v_mov_b32 v215, v214
    s_nop 0
    v_permlane16_swap_b32 v210, v211
    v_permlane16_swap_b32 v214, v215
    v_max_f32 v210, v210, v211
    v_max_f32 v214, v214, v215
    v_mov_b32 v211, v210
    v_mov_b32 v215, v214
    s_nop 0
    v_permlane32_swap_b32 v210, v211
    v_permlane32_swap_b32 v214, v215
    v_max_f32 v210, v210, v211
    v_max_f32 v214, v214, v215
    v_sub_f32 v208, v208, v210
    v_sub_f32 v212, v212, v214
    v_sub_f32 v209, v209, v210
    v_sub_f32 v213, v213, v214
    v_exp_f32 v208, v208
    v_exp_f32 v212, v212
    v_exp_f32 v209, v209
    v_exp_f32 v213, v213
    v_add_f32 v210, v208, v209
    v_add_f32 v214, v212, v213
    v_mov_b32 v211, v210
    v_mov_b32 v215, v214
    s_nop 0
    v_permlane16_swap_b32 v210, v211
    v_permlane16_swap_b32 v214, v215
    v_add_f32 v210, v210, v211
    v_add_f32 v214, v214, v215
    v_mov_b32 v211, v210
    v_mov_b32 v215, v214
    s_nop 0
    v_permlane32_swap_b32 v210, v211
    v_permlane32_swap_b32 v214, v215
    v_add_f32 v210, v210, v211
    v_add_f32 v214, v214, v215
    v_rcp_f32 v210, v210
    v_rcp_f32 v214, v214
    v_mul_f32 v208, v208, v210
    v_mul_f32 v212, v212, v214
    v_mul_f32 v209, v209, v210
    v_mul_f32 v213, v213, v214
    v_cvt_pk_bf16_f32 v208, v208, v208
    v_cvt_pk_bf16_f32 v212, v212, v212
    v_cvt_pk_bf16_f32 v209, v209, v209
    v_cvt_pk_bf16_f32 v213, v213, v213
    v_and_b32 v216, v244, v208
    v_and_b32 v220, v244, v212
    v_and_b32 v217, v245, v209
    v_and_b32 v221, v245, v213
    v_and_b32 v218, v246, v208
    v_and_b32 v222, v246, v212
    v_and_b32 v219, v247, v209
    v_and_b32 v223, v247, v213
    s_nop 0
    v_mfma_f32_16x16x32_bf16 v[144:147], v[176:179], v[216:219], 0
    v_mfma_f32_16x16x32_bf16 v[148:151], v[182:185], v[216:219], 0
    v_mfma_f32_16x16x32_bf16 v[152:155], v[178:181], v[220:223], 0
    v_mfma_f32_16x16x32_bf16 v[156:159], v[184:187], v[220:223], 0
    s_nop 4
    v_cvt_pk_bf16_f32 v224, v144, v145
    v_cvt_pk_bf16_f32 v225, v146, v147
    v_cvt_pk_bf16_f32 v226, v148, v149
    v_cvt_pk_bf16_f32 v227, v150, v151
    v_and_b32 v226, v21, v226
    v_and_b32 v227, v21, v227
    buffer_store_dwordx4 v[224:227], v22, s[36:39], s79 offen offset:0 sc1
    v_cvt_pk_bf16_f32 v228, v152, v153
    v_cvt_pk_bf16_f32 v229, v154, v155
    v_cvt_pk_bf16_f32 v230, v156, v157
    v_cvt_pk_bf16_f32 v231, v158, v159
    v_and_b32 v230, v21, v230
    v_and_b32 v231, v21, v231
    buffer_store_dwordx4 v[228:231], v22, s[36:39], s79 offen offset:256 sc1
    s_lshl_b32 s72, s61, 12
    s_lshl_b32 s73, s63, 8
    s_add_u32 s72, s72, s73
    s_lshl_b32 s73, s62, 5
    s_add_u32 s72, s72, s73
    s_lshl_b32 s73, s60, 2
    s_add_u32 s72, s72, s73
    s_add_u32 s72, s72, 262144
    s_branch L_P2
L_Q3:
    ds_read_b128 v[32:35], v8 offset:0
    ds_read_b128 v[88:91], v8 offset:14336
    ds_read_b64_tr_b16 v[208:209], v26 offset:24576
    ds_read_b64_tr_b16 v[210:211], v26 offset:25088
    ds_read_b64_tr_b16 v[212:213], v27 offset:24576
    ds_read_b64_tr_b16 v[214:215], v27 offset:25088
    ds_read_b128 v[36:39], v9 offset:0
    ds_read_b128 v[92:95], v9 offset:14336
    ds_read_b64_tr_b16 v[216:217], v26 offset:28672
    ds_read_b64_tr_b16 v[218:219], v26 offset:29184
    ds_read_b64_tr_b16 v[220:221], v27 offset:28672
    ds_read_b64_tr_b16 v[222:223], v27 offset:29184
    s_waitcnt lgkmcnt(6)
    v_mfma_f32_16x16x32_bf16 v[144:147], v[208:211], v[32:35], 0
    v_mfma_f32_16x16x32_bf16 v[148:151], v[212:215], v[32:35], 0
    v_mfma_f32_16x16x32_bf16 v[152:155], v[208:211], v[88:91], 0
    v_mfma_f32_16x16x32_bf16 v[156:159], v[212:215], v[88:91], 0
    ds_read_b64_tr_b16 v[224:225], v26 offset:32768
    ds_read_b64_tr_b16 v[226:227], v26 offset:33280
    ds_read_b64_tr_b16 v[228:229], v27 offset:32768
    ds_read_b64_tr_b16 v[230:231], v27 offset:33280
    ds_read_b128 v[40:43], v8 offset:128
    ds_read_b128 v[96:99], v8 offset:14464
    ds_read_b128 v[44:47], v9 offset:128
    ds_read_b128 v[100:103], v9 offset:14464
    ds_read_b128 v[48:51], v8 offset:256
    ds_read_b128 v[104:107], v8 offset:14592
    ds_read_b128 v[52:55], v9 offset:256
    ds_read_b128 v[108:111], v9 offset:14592
    s_waitcnt lgkmcnt(12)
    v_mfma_f32_16x16x32_bf16 v[144:147], v[216:219], v[36:39], v[144:147]
    v_mfma_f32_16x16x32_bf16 v[148:151], v[220:223], v[36:39], v[148:151]
    v_mfma_f32_16x16x32_bf16 v[152:155], v[216:219], v[92:95], v[152:155]
    v_mfma_f32_16x16x32_bf16 v[156:159], v[220:223], v[92:95], v[156:159]
    ds_read_b64_tr_b16 v[208:209], v26 offset:36864
    ds_read_b64_tr_b16 v[210:211], v26 offset:37376
    ds_read_b64_tr_b16 v[212:213], v27 offset:36864
    ds_read_b64_tr_b16 v[214:215], v27 offset:37376
    ds_read_b128 v[56:59], v8 offset:384
    ds_read_b128 v[112:115], v8 offset:14720
    ds_read_b128 v[60:63], v9 offset:384
    ds_read_b128 v[116:119], v9 offset:14720
    ds_read_b128 v[64:67], v8 offset:512
    ds_read_b128 v[120:123], v8 offset:14848
    ds_read_b128 v[68:71], v9 offset:512
    ds_read_b128 v[124:127], v9 offset:14848
    s_waitcnt lgkmcnt(15)
    v_mfma_f32_16x16x32_bf16 v[144:147], v[224:227], v[40:43], v[144:147]
    v_mfma_f32_16x16x32_bf16 v[148:151], v[228:231], v[40:43], v[148:151]
    v_mfma_f32_16x16x32_bf16 v[152:155], v[224:227], v[96:99], v[152:155]
    v_mfma_f32_16x16x32_bf16 v[156:159], v[228:231], v[96:99], v[156:159]
    ds_read_b128 v[72:75], v8 offset:640
    ds_read_b128 v[128:131], v8 offset:14976
    ds_read_b128 v[76:79], v9 offset:640
    ds_read_b128 v[132:135], v9 offset:14976
    ds_read_b128 v[80:83], v8 offset:768
    ds_read_b128 v[136:139], v8 offset:15104
    ds_read_b128 v[84:87], v9 offset:768
    ds_read_b128 v[140:143], v9 offset:15104
    s_waitcnt lgkmcnt(15)
    v_mfma_f32_16x16x32_bf16 v[144:147], v[208:211], v[44:47], v[144:147]
    v_mfma_f32_16x16x32_bf16 v[148:151], v[212:215], v[44:47], v[148:151]
    v_mfma_f32_16x16x32_bf16 v[152:155], v[208:211], v[100:103], v[152:155]
    v_mfma_f32_16x16x32_bf16 v[156:159], v[212:215], v[100:103], v[156:159]
    s_waitcnt lgkmcnt(0)
    s_barrier
    ds_read_b64_tr_b16 v[216:217], v26 offset:40960
    ds_read_b64_tr_b16 v[218:219], v26 offset:41472
    ds_read_b64_tr_b16 v[220:221], v27 offset:40960
    ds_read_b64_tr_b16 v[222:223], v27 offset:41472
    ds_read_b64_tr_b16 v[224:225], v26 offset:45056
    ds_read_b64_tr_b16 v[226:227], v26 offset:45568
    ds_read_b64_tr_b16 v[228:229], v27 offset:45056
    ds_read_b64_tr_b16 v[230:231], v27 offset:45568
    s_waitcnt lgkmcnt(4)
    v_mfma_f32_16x16x32_bf16 v[144:147], v[216:219], v[48:51], v[144:147]
    v_mfma_f32_16x16x32_bf16 v[148:151], v[220:223], v[48:51], v[148:151]
    v_mfma_f32_16x16x32_bf16 v[152:155], v[216:219], v[104:107], v[152:155]
    v_mfma_f32_16x16x32_bf16 v[156:159], v[220:223], v[104:107], v[156:159]
    ds_read_b64_tr_b16 v[208:209], v26 offset:49152
    ds_read_b64_tr_b16 v[210:211], v26 offset:49664
    ds_read_b64_tr_b16 v[212:213], v27 offset:49152
    ds_read_b64_tr_b16 v[214:215], v27 offset:49664
    s_add_u32 m0, s66, 20480
    s_add_u32 s74, s76, 431872
    buffer_load_dwordx4 v4, s[32:35], s74 offen lds
    s_add_u32 m0, s66, 24576
    s_add_u32 s74, s76, 517888
    buffer_load_dwordx4 v4, s[32:35], s74 offen lds
    s_waitcnt lgkmcnt(4)
    v_mfma_f32_16x16x32_bf16 v[144:147], v[224:227], v[52:55], v[144:147]
    v_mfma_f32_16x16x32_bf16 v[148:151], v[228:231], v[52:55], v[148:151]
    v_mfma_f32_16x16x32_bf16 v[152:155], v[224:227], v[108:111], v[152:155]
    v_mfma_f32_16x16x32_bf16 v[156:159], v[228:231], v[108:111], v[156:159]
    ds_read_b64_tr_b16 v[216:217], v26 offset:53248
    ds_read_b64_tr_b16 v[218:219], v26 offset:53760
    ds_read_b64_tr_b16 v[220:221], v27 offset:53248
    ds_read_b64_tr_b16 v[222:223], v27 offset:53760
    s_add_u32 m0, s66, 28672
    s_add_u32 s74, s76, 603904
    buffer_load_dwordx4 v4, s[32:35], s74 offen lds
    s_add_u32 m0, s66, 32768
    s_add_u32 s74, s76, 689920
    buffer_load_dwordx4 v4, s[32:35], s74 offen lds
    s_waitcnt lgkmcnt(4)
    v_mfma_f32_16x16x32_bf16 v[144:147], v[208:211], v[56:59], v[144:147]
    v_mfma_f32_16x16x32_bf16 v[148:151], v[212:215], v[56:59], v[148:151]
    v_mfma_f32_16x16x32_bf16 v[152:155], v[208:211], v[112:115], v[152:155]
    v_mfma_f32_16x16x32_bf16 v[156:159], v[212:215], v[112:115], v[156:159]
    s_barrier
    ds_read_b64_tr_b16 v[224:225], v26 offset:0
    ds_read_b64_tr_b16 v[226:227], v26 offset:512
    ds_read_b64_tr_b16 v[228:229], v27 offset:0
    ds_read_b64_tr_b16 v[230:231], v27 offset:512
    s_add_u32 m0, s66, 36864
    s_add_u32 s74, s76, 775936
    buffer_load_dwordx4 v4, s[32:35], s74 offen lds
    s_add_u32 m0, s66, 40960
    s_add_u32 s74, s76, 861952
    buffer_load_dwordx4 v4, s[32:35], s74 offen lds
    s_waitcnt lgkmcnt(4)
    v_mfma_f32_16x16x32_bf16 v[144:147], v[216:219], v[60:63], v[144:147]
    v_mfma_f32_16x16x32_bf16 v[148:151], v[220:223], v[60:63], v[148:151]
    v_mfma_f32_16x16x32_bf16 v[152:155], v[216:219], v[116:119], v[152:155]
    v_mfma_f32_16x16x32_bf16 v[156:159], v[220:223], v[116:119], v[156:159]
    ds_read_b64_tr_b16 v[208:209], v26 offset:4096
    ds_read_b64_tr_b16 v[210:211], v26 offset:4608
    ds_read_b64_tr_b16 v[212:213], v27 offset:4096
    ds_read_b64_tr_b16 v[214:215], v27 offset:4608
    s_add_u32 m0, s66, 45056
    s_add_u32 s74, s76, 947968
    buffer_load_dwordx4 v4, s[32:35], s74 offen lds
    s_add_u32 m0, s66, 49152
    s_add_u32 s74, s76, 1033984
    buffer_load_dwordx4 v4, s[32:35], s74 offen lds
    s_waitcnt lgkmcnt(4)
    v_mfma_f32_16x16x32_bf16 v[144:147], v[224:227], v[64:67], v[144:147]
    v_mfma_f32_16x16x32_bf16 v[148:151], v[228:231], v[64:67], v[148:151]
    v_mfma_f32_16x16x32_bf16 v[152:155], v[224:227], v[120:123], v[152:155]
    v_mfma_f32_16x16x32_bf16 v[156:159], v[228:231], v[120:123], v[156:159]
    ds_read_b64_tr_b16 v[216:217], v26 offset:8192
    ds_read_b64_tr_b16 v[218:219], v26 offset:8704
    ds_read_b64_tr_b16 v[220:221], v27 offset:8192
    ds_read_b64_tr_b16 v[222:223], v27 offset:8704
    s_add_u32 m0, s66, 53248
    s_add_u32 s74, s76, 1120000
    buffer_load_dwordx4 v4, s[32:35], s74 offen lds
    s_waitcnt lgkmcnt(4)
    v_mfma_f32_16x16x32_bf16 v[144:147], v[208:211], v[68:71], v[144:147]
    v_mfma_f32_16x16x32_bf16 v[148:151], v[212:215], v[68:71], v[148:151]
    v_mfma_f32_16x16x32_bf16 v[152:155], v[208:211], v[124:127], v[152:155]
    v_mfma_f32_16x16x32_bf16 v[156:159], v[212:215], v[124:127], v[156:159]
    ds_read_b64_tr_b16 v[224:225], v26 offset:12288
    ds_read_b64_tr_b16 v[226:227], v26 offset:12800
    ds_read_b64_tr_b16 v[228:229], v27 offset:12288
    ds_read_b64_tr_b16 v[230:231], v27 offset:12800
    s_waitcnt lgkmcnt(4)
    v_mfma_f32_16x16x32_bf16 v[144:147], v[216:219], v[72:75], v[144:147]
    v_mfma_f32_16x16x32_bf16 v[148:151], v[220:223], v[72:75], v[148:151]
    v_mfma_f32_16x16x32_bf16 v[152:155], v[216:219], v[128:131], v[152:155]
    v_mfma_f32_16x16x32_bf16 v[156:159], v[220:223], v[128:131], v[156:159]
    ds_read_b64_tr_b16 v[208:209], v26 offset:16384
    ds_read_b64_tr_b16 v[210:211], v26 offset:16896
    ds_read_b64_tr_b16 v[212:213], v27 offset:16384
    ds_read_b64_tr_b16 v[214:215], v27 offset:16896
    s_waitcnt lgkmcnt(4)
    v_mfma_f32_16x16x32_bf16 v[144:147], v[224:227], v[76:79], v[144:147]
    v_mfma_f32_16x16x32_bf16 v[148:151], v[228:231], v[76:79], v[148:151]
    v_mfma_f32_16x16x32_bf16 v[152:155], v[224:227], v[132:135], v[152:155]
    v_mfma_f32_16x16x32_bf16 v[156:159], v[228:231], v[132:135], v[156:159]
    s_waitcnt vmcnt(8)
    s_barrier
    ds_read_b64_tr_b16 v[216:217], v26 offset:20480
    ds_read_b64_tr_b16 v[218:219], v26 offset:20992
    ds_read_b64_tr_b16 v[220:221], v27 offset:20480
    ds_read_b64_tr_b16 v[222:223], v27 offset:20992
    s_add_u32 m0, s66, 135168
    s_add_u32 s74, s76, 86016
    buffer_load_dwordx4 v4, s[32:35], s74 offen lds
    s_add_u32 m0, s66, 143360
    s_add_u32 s74, s76, 258048
    buffer_load_dwordx4 v4, s[32:35], s74 offen lds
    s_waitcnt lgkmcnt(4)
    v_mfma_f32_16x16x32_bf16 v[144:147], v[208:211], v[80:83], v[144:147]
    v_mfma_f32_16x16x32_bf16 v[148:151], v[212:215], v[80:83], v[148:151]
    v_mfma_f32_16x16x32_bf16 v[152:155], v[208:211], v[136:139], v[152:155]
    v_mfma_f32_16x16x32_bf16 v[156:159], v[212:215], v[136:139], v[156:159]
    ds_read_b64_tr_b16 v[224:225], v24 offset:0
    ds_read_b64_tr_b16 v[226:227], v24 offset:512
    ds_read_b64_tr_b16 v[228:229], v25 offset:0
    ds_read_b64_tr_b16 v[230:231], v25 offset:512
    ds_read_b128 v[240:243], v10 offset:0
    s_add_u32 m0, s66, 151552
    s_add_u32 s74, s76, 430080
    buffer_load_dwordx4 v4, s[32:35], s74 offen lds
    v_and_b32 v12, 15, v1
    v_lshrrev_b32 v13, 4, v1
    v_lshlrev_b32 v13, 2, v13
    v_sub_u32 v12, v12, v13
    v_mov_b32 v14, 0xf149f2ca
    v_mov_b32 v15, 0
    s_or_b32 s82, s81, s61
    s_cmp_eq_u32 s82, 0
    s_cselect_b32 s78, 0xf149f2ca, 0
    s_waitcnt lgkmcnt(5)
    v_mfma_f32_16x16x32_bf16 v[144:147], v[216:219], v[84:87], v[144:147]
    v_mfma_f32_16x16x32_bf16 v[148:151], v[220:223], v[84:87], v[148:151]
    v_mfma_f32_16x16x32_bf16 v[152:155], v[216:219], v[140:143], v[152:155]
    v_mfma_f32_16x16x32_bf16 v[156:159], v[220:223], v[140:143], v[156:159]
    ds_read_b64_tr_b16 v[208:209], v24 offset:4096
    ds_read_b64_tr_b16 v[210:211], v24 offset:4608
    ds_read_b64_tr_b16 v[212:213], v25 offset:4096
    ds_read_b64_tr_b16 v[214:215], v25 offset:4608
    ds_read_b128 v[232:235], v11 offset:0
    s_add_u32 m0, s66, 159744
    s_add_u32 s74, s76, 602112
    buffer_load_dwordx4 v4, s[32:35], s74 offen lds
    v_subrev_u32 v13, 0, v12
    v_and_b32 v19, 0x80000001, v13
    v_cmp_eq_u32 vcc, 0, v19
    v_mov_b32 v20, 0x0000ffff
    s_nop 0
    v_cndmask_b32 v196, v14, v15, vcc
    v_cndmask_b32 v21, v15, v20, vcc
    v_cvt_pk_bf16_f32 v168, v144, v145
    v_cvt_pk_bf16_f32 v169, v146, v147
    v_cvt_pk_bf16_f32 v170, v148, v149
    v_cvt_pk_bf16_f32 v171, v150, v151
    v_cvt_pk_bf16_f32 v172, v152, v153
    v_cvt_pk_bf16_f32 v173, v154, v155
    v_cvt_pk_bf16_f32 v174, v156, v157
    v_cvt_pk_bf16_f32 v175, v158, v159
    ds_write_b128 v29, v[172:175]
    s_waitcnt lgkmcnt(6)
    v_mfma_f32_16x16x32_bf16 v[144:147], v[32:35], v[224:227], 0
    v_mfma_f32_16x16x32_bf16 v[148:151], v[32:35], v[228:231], 0
    v_mfma_f32_16x16x32_bf16 v[152:155], v[88:91], v[224:227], 0
    v_mfma_f32_16x16x32_bf16 v[156:159], v[88:91], v[228:231], 0
    v_mfma_f32_16x16x32_bf16 v[160:163], v[240:243], v[228:231], 0
    s_barrier
    ds_read_b64_tr_b16 v[216:217], v24 offset:8192
    ds_read_b64_tr_b16 v[218:219], v24 offset:8704
    ds_read_b64_tr_b16 v[220:221], v25 offset:8192
    ds_read_b64_tr_b16 v[222:223], v25 offset:8704
    ds_read_b128 v[236:239], v10 offset:128
    s_add_u32 m0, s66, 110592
    s_add_u32 s74, s76, 774144
    buffer_load_dwordx4 v4, s[32:35], s74 offen lds
    v_cmp_eq_u32 vcc, 0x80000000, v19
    s_nop 1
    v_cndmask_b32 v200, v14, v15, vcc
    v_cndmask_b32 v252, v15, v20, vcc
    v_min_f32 v204, s78, v200
    s_waitcnt lgkmcnt(6)
    v_mfma_f32_16x16x32_bf16 v[144:147], v[36:39], v[208:211], v[144:147]
    v_mfma_f32_16x16x32_bf16 v[148:151], v[36:39], v[212:215], v[148:151]
    v_mfma_f32_16x16x32_bf16 v[152:155], v[92:95], v[208:211], v[152:155]
    v_mfma_f32_16x16x32_bf16 v[156:159], v[92:95], v[212:215], v[156:159]
    v_mfma_f32_16x16x32_bf16 v[160:163], v[232:235], v[212:215], v[160:163]
    ds_read_b64_tr_b16 v[224:225], v24 offset:12288
    ds_read_b64_tr_b16 v[226:227], v24 offset:12800
    ds_read_b64_tr_b16 v[228:229], v25 offset:12288
    ds_read_b64_tr_b16 v[230:231], v25 offset:12800
    ds_read_b128 v[240:243], v11 offset:128
    s_add_u32 m0, s66, 118784
    s_add_u32 s74, s76, 946176
    buffer_load_dwordx4 v4, s[32:35], s74 offen lds
    v_subrev_u32 v13, 1, v12
    v_and_b32 v19, 0x80000001, v13
    v_cmp_eq_u32 vcc, 0, v19
    v_mov_b32 v20, 0xffff0000
    s_nop 0
    v_cndmask_b32 v197, v14, v15, vcc
    v_cndmask_b32 v22, v15, v20, vcc
    s_waitcnt lgkmcnt(5)
    v_mfma_f32_16x16x32_bf16 v[144:147], v[40:43], v[216:219], v[144:147]
    v_mfma_f32_16x16x32_bf16 v[148:151], v[40:43], v[220:223], v[148:151]
    v_mfma_f32_16x16x32_bf16 v[152:155], v[96:99], v[216:219], v[152:155]
    v_mfma_f32_16x16x32_bf16 v[156:159], v[96:99], v[220:223], v[156:159]
    v_mfma_f32_16x16x32_bf16 v[160:163], v[236:239], v[220:223], v[160:163]
    ds_read_b64_tr_b16 v[208:209], v24 offset:16384
    ds_read_b64_tr_b16 v[210:211], v24 offset:16896
    ds_read_b64_tr_b16 v[212:213], v25 offset:16384
    ds_read_b64_tr_b16 v[214:215], v25 offset:16896
    ds_read_b128 v[232:235], v10 offset:256
    s_add_u32 m0, s66, 126976
    s_add_u32 s74, s76, 1118208
    buffer_load_dwordx4 v4, s[32:35], s74 offen lds
    v_cmp_eq_u32 vcc, 0x80000000, v19
    v_or_b32 v246, v21, v22
    s_waitcnt lgkmcnt(5)
    v_mfma_f32_16x16x32_bf16 v[144:147], v[44:47], v[224:227], v[144:147]
    v_mfma_f32_16x16x32_bf16 v[148:151], v[44:47], v[228:231], v[148:151]
    v_mfma_f32_16x16x32_bf16 v[152:155], v[100:103], v[224:227], v[152:155]
    v_mfma_f32_16x16x32_bf16 v[156:159], v[100:103], v[228:231], v[156:159]
    v_mfma_f32_16x16x32_bf16 v[160:163], v[240:243], v[228:231], v[160:163]
    s_waitcnt vmcnt(7)
    s_barrier
    ds_read_b64_tr_b16 v[216:217], v24 offset:20480
    ds_read_b64_tr_b16 v[218:219], v24 offset:20992
    ds_read_b64_tr_b16 v[220:221], v25 offset:20480
    ds_read_b64_tr_b16 v[222:223], v25 offset:20992
    ds_read_b128 v[236:239], v11 offset:256
    v_cndmask_b32 v201, v14, v15, vcc
    v_cndmask_b32 v253, v15, v20, vcc
    v_or_b32 v244, v252, v253
    v_min_f32 v205, s78, v201
    s_waitcnt lgkmcnt(5)
    v_mfma_f32_16x16x32_bf16 v[144:147], v[48:51], v[208:211], v[144:147]
    v_mfma_f32_16x16x32_bf16 v[148:151], v[48:51], v[212:215], v[148:151]
    v_mfma_f32_16x16x32_bf16 v[152:155], v[104:107], v[208:211], v[152:155]
    v_mfma_f32_16x16x32_bf16 v[156:159], v[104:107], v[212:215], v[156:159]
    v_mfma_f32_16x16x32_bf16 v[160:163], v[232:235], v[212:215], v[160:163]
    ds_read_b64_tr_b16 v[224:225], v24 offset:24576
    ds_read_b64_tr_b16 v[226:227], v24 offset:25088
    ds_read_b64_tr_b16 v[228:229], v25 offset:24576
    ds_read_b64_tr_b16 v[230:231], v25 offset:25088
    ds_read_b128 v[240:243], v10 offset:384
    v_subrev_u32 v13, 2, v12
    v_and_b32 v19, 0x80000001, v13
    v_cmp_eq_u32 vcc, 0, v19
    v_mov_b32 v20, 0x0000ffff
    s_nop 0
    v_cndmask_b32 v198, v14, v15, vcc
    v_cndmask_b32 v21, v15, v20, vcc
    s_waitcnt lgkmcnt(5)
    v_mfma_f32_16x16x32_bf16 v[144:147], v[52:55], v[216:219], v[144:147]
    v_mfma_f32_16x16x32_bf16 v[148:151], v[52:55], v[220:223], v[148:151]
    v_mfma_f32_16x16x32_bf16 v[152:155], v[108:111], v[216:219], v[152:155]
    v_mfma_f32_16x16x32_bf16 v[156:159], v[108:111], v[220:223], v[156:159]
    v_mfma_f32_16x16x32_bf16 v[160:163], v[236:239], v[220:223], v[160:163]
    ds_read_b64_tr_b16 v[208:209], v24 offset:28672
    ds_read_b64_tr_b16 v[210:211], v24 offset:29184
    ds_read_b64_tr_b16 v[212:213], v25 offset:28672
    ds_read_b64_tr_b16 v[214:215], v25 offset:29184
    ds_read_b128 v[232:235], v11 offset:384
    v_mul_u32_u24 v251, 7, v255
    s_and_b32 s75, s64, 3
    s_lshl_b32 s75, s75, 3
    s_add_u32 s75, s75, s60
    s_lshl_b32 s74, s75, 5
    s_cmp_ge_u32 s75, 12
    s_cselect_b32 s73, 256, 0
    s_add_u32 s74, s74, s73
    s_cmp_ge_u32 s75, 22
    s_cselect_b32 s73, 256, 0
    s_add_u32 s74, s74, s73
    s_mul_i32 s74, s74, 896
    s_add_u32 s74, s74, s65
    s_mov_b64 exec, 0xffffffff
    buffer_load_dword v254, v251, s[44:47], s74 offen sc1
    s_mul_i32 s74, s75, 7168
    s_add_u32 s74, s74, s65
    s_mov_b64 exec, 0xff
    buffer_load_dword v254, v251, s[48:51], s74 offen sc1
    s_mov_b64 exec, -1
    v_cmp_eq_u32 vcc, 0x80000000, v19
    s_nop 1
    v_cndmask_b32 v202, v14, v15, vcc
    v_cndmask_b32 v252, v15, v20, vcc
    v_min_f32 v206, s78, v202
    s_waitcnt lgkmcnt(5)
    v_mfma_f32_16x16x32_bf16 v[144:147], v[56:59], v[224:227], v[144:147]
    v_mfma_f32_16x16x32_bf16 v[148:151], v[56:59], v[228:231], v[148:151]
    v_mfma_f32_16x16x32_bf16 v[152:155], v[112:115], v[224:227], v[152:155]
    v_mfma_f32_16x16x32_bf16 v[156:159], v[112:115], v[228:231], v[156:159]
    v_mfma_f32_16x16x32_bf16 v[160:163], v[240:243], v[228:231], v[160:163]
    ds_read_b64_tr_b16 v[216:217], v24 offset:32768
    ds_read_b64_tr_b16 v[218:219], v24 offset:33280
    ds_read_b64_tr_b16 v[220:221], v25 offset:32768
    ds_read_b64_tr_b16 v[222:223], v25 offset:33280
    ds_read_b128 v[236:239], v10 offset:512
    v_subrev_u32 v13, 3, v12
    v_and_b32 v19, 0x80000001, v13
    v_cmp_eq_u32 vcc, 0, v19
    v_mov_b32 v20, 0xffff0000
    s_nop 0
    v_cndmask_b32 v199, v14, v15, vcc
    v_cndmask_b32 v22, v15, v20, vcc
    s_waitcnt lgkmcnt(5)
    v_mfma_f32_16x16x32_bf16 v[144:147], v[60:63], v[208:211], v[144:147]
    v_mfma_f32_16x16x32_bf16 v[148:151], v[60:63], v[212:215], v[148:151]
    v_mfma_f32_16x16x32_bf16 v[152:155], v[116:119], v[208:211], v[152:155]
    v_mfma_f32_16x16x32_bf16 v[156:159], v[116:119], v[212:215], v[156:159]
    v_mfma_f32_16x16x32_bf16 v[160:163], v[232:235], v[212:215], v[160:163]
    ds_read_b64_tr_b16 v[224:225], v24 offset:36864
    ds_read_b64_tr_b16 v[226:227], v24 offset:37376
    ds_read_b64_tr_b16 v[228:229], v25 offset:36864
    ds_read_b64_tr_b16 v[230:231], v25 offset:37376
    ds_read_b128 v[240:243], v11 offset:512
    v_cmp_eq_u32 vcc, 0x80000000, v19
    v_or_b32 v247, v21, v22
    s_waitcnt lgkmcnt(5)
    v_mfma_f32_16x16x32_bf16 v[144:147], v[64:67], v[216:219], v[144:147]
    v_mfma_f32_16x16x32_bf16 v[148:151], v[64:67], v[220:223], v[148:151]
    v_mfma_f32_16x16x32_bf16 v[152:155], v[120:123], v[216:219], v[152:155]
    v_mfma_f32_16x16x32_bf16 v[156:159], v[120:123], v[220:223], v[156:159]
    v_mfma_f32_16x16x32_bf16 v[160:163], v[236:239], v[220:223], v[160:163]
    ds_read_b64_tr_b16 v[208:209], v24 offset:40960
    ds_read_b64_tr_b16 v[210:211], v24 offset:41472
    ds_read_b64_tr_b16 v[212:213], v25 offset:40960
    ds_read_b64_tr_b16 v[214:215], v25 offset:41472
    ds_read_b128 v[232:235], v10 offset:640
    v_cndmask_b32 v203, v14, v15, vcc
    v_cndmask_b32 v253, v15, v20, vcc
    v_or_b32 v245, v252, v253
    v_min_f32 v207, s78, v203
    s_waitcnt lgkmcnt(5)
    v_mfma_f32_16x16x32_bf16 v[144:147], v[68:71], v[224:227], v[144:147]
    v_mfma_f32_16x16x32_bf16 v[148:151], v[68:71], v[228:231], v[148:151]
    v_mfma_f32_16x16x32_bf16 v[152:155], v[124:127], v[224:227], v[152:155]
    v_mfma_f32_16x16x32_bf16 v[156:159], v[124:127], v[228:231], v[156:159]
    v_mfma_f32_16x16x32_bf16 v[160:163], v[240:243], v[228:231], v[160:163]
    ds_read_b64_tr_b16 v[216:217], v24 offset:45056
    ds_read_b64_tr_b16 v[218:219], v24 offset:45568
    ds_read_b64_tr_b16 v[220:221], v25 offset:45056
    ds_read_b64_tr_b16 v[222:223], v25 offset:45568
    ds_read_b128 v[236:239], v11 offset:640
    v_cmp_gt_u32 vcc, 48, v1
    v_mov_b32 v19, 0x3e8b97f6
    s_nop 0
    v_cndmask_b32 v20, v15, v19, vcc
    v_cndmask_b32 v21, 0, -1, vcc
    v_lshrrev_b32 v12, 4, v1
    v_and_b32 v13, 15, v1
    v_lshlrev_b32 v13, 4, v13
    v_lshl_add_u32 v22, v12, 9, v13
    s_waitcnt lgkmcnt(5)
    v_mfma_f32_16x16x32_bf16 v[144:147], v[72:75], v[208:211], v[144:147]
    v_mfma_f32_16x16x32_bf16 v[148:151], v[72:75], v[212:215], v[148:151]
    v_mfma_f32_16x16x32_bf16 v[152:155], v[128:131], v[208:211], v[152:155]
    v_mfma_f32_16x16x32_bf16 v[156:159], v[128:131], v[212:215], v[156:159]
    v_mfma_f32_16x16x32_bf16 v[160:163], v[232:235], v[212:215], v[160:163]
    ds_read_b64_tr_b16 v[224:225], v24 offset:49152
    ds_read_b64_tr_b16 v[226:227], v24 offset:49664
    ds_read_b64_tr_b16 v[228:229], v25 offset:49152
    ds_read_b64_tr_b16 v[230:231], v25 offset:49664
    ds_read_b128 v[240:243], v10 offset:768
    s_lshl_b32 s79, s61, 2
    s_add_u32 s79, s79, s81
    s_mul_i32 s79, s79, 145
    s_lshl_b32 s83, s62, 1
    s_add_u32 s82, s80, s83
    s_lshl_b32 s82, s82, 1
    s_add_u32 s79, s79, s82
    s_add_u32 s79, s79, 112
    s_lshl_b32 s79, s79, 10
    s_add_u32 s79, s79, 1048576
    s_waitcnt lgkmcnt(5)
    v_mfma_f32_16x16x32_bf16 v[144:147], v[76:79], v[216:219], v[144:147]
    v_mfma_f32_16x16x32_bf16 v[148:151], v[76:79], v[220:223], v[148:151]
    v_mfma_f32_16x16x32_bf16 v[152:155], v[132:135], v[216:219], v[152:155]
    v_mfma_f32_16x16x32_bf16 v[156:159], v[132:135], v[220:223], v[156:159]
    v_mfma_f32_16x16x32_bf16 v[160:163], v[236:239], v[220:223], v[160:163]
    s_waitcnt vmcnt(5)
    s_barrier
    ds_read_b64_tr_b16 v[208:209], v24 offset:53248
    ds_read_b64_tr_b16 v[210:211], v24 offset:53760
    ds_read_b64_tr_b16 v[212:213], v25 offset:53248
    ds_read_b64_tr_b16 v[214:215], v25 offset:53760
    ds_read_b128 v[232:235], v11 offset:768
    s_waitcnt lgkmcnt(5)
    v_mfma_f32_16x16x32_bf16 v[144:147], v[80:83], v[224:227], v[144:147]
    v_mfma_f32_16x16x32_bf16 v[148:151], v[80:83], v[228:231], v[148:151]
    v_mfma_f32_16x16x32_bf16 v[152:155], v[136:139], v[224:227], v[152:155]
    v_mfma_f32_16x16x32_bf16 v[156:159], v[136:139], v[228:231], v[156:159]
    v_mfma_f32_16x16x32_bf16 v[160:163], v[240:243], v[228:231], v[160:163]
    ds_read_b64_tr_b16 v[216:217], v26 offset:24576
    ds_read_b64_tr_b16 v[218:219], v26 offset:25088
    ds_read_b64_tr_b16 v[220:221], v27 offset:24576
    ds_read_b64_tr_b16 v[222:223], v27 offset:25088
    s_waitcnt lgkmcnt(4)
    v_mfma_f32_16x16x32_bf16 v[144:147], v[84:87], v[208:211], v[144:147]
    v_mfma_f32_16x16x32_bf16 v[148:151], v[84:87], v[212:215], v[148:151]
    v_mfma_f32_16x16x32_bf16 v[152:155], v[140:143], v[208:211], v[152:155]
    v_mfma_f32_16x16x32_bf16 v[156:159], v[140:143], v[212:215], v[156:159]
    v_mfma_f32_16x16x32_bf16 v[160:163], v[232:235], v[212:215], v[160:163]
    ds_read_b64_tr_b16 v[224:225], v26 offset:28672
    ds_read_b64_tr_b16 v[226:227], v26 offset:29184
    ds_read_b64_tr_b16 v[228:229], v27 offset:28672
    ds_read_b64_tr_b16 v[230:231], v27 offset:29184
    v_cvt_pk_bf16_f32 v178, v144, v145
    v_cvt_pk_bf16_f32 v179, v146, v147
    v_cvt_pk_bf16_f32 v184, v148, v149
    v_cvt_pk_bf16_f32 v185, v150, v151
    v_cvt_pk_bf16_f32 v180, v152, v153
    v_cvt_pk_bf16_f32 v181, v154, v155
    v_cvt_pk_bf16_f32 v186, v156, v157
    v_cvt_pk_bf16_f32 v187, v158, v159
    ds_write_b64 v29, v[180:181] offset:1024
    ds_write_b64 v29, v[186:187] offset:1032
    v_cvt_pk_bf16_f32 v248, v160, v161
    v_cvt_pk_bf16_f32 v249, v162, v163
    ds_write_b64 v18, v[248:249] offset:1032
    s_waitcnt lgkmcnt(7)
    v_mfma_f32_16x16x32_bf16 v[144:147], v[216:219], v[32:35], 0
    v_mfma_f32_16x16x32_bf16 v[148:151], v[220:223], v[32:35], 0
    v_mfma_f32_16x16x32_bf16 v[152:155], v[216:219], v[88:91], 0
    v_mfma_f32_16x16x32_bf16 v[156:159], v[220:223], v[88:91], 0
    ds_read_b64_tr_b16 v[208:209], v26 offset:32768
    ds_read_b64_tr_b16 v[210:211], v26 offset:33280
    ds_read_b64_tr_b16 v[212:213], v27 offset:32768
    ds_read_b64_tr_b16 v[214:215], v27 offset:33280
    s_waitcnt lgkmcnt(7)
    v_mfma_f32_16x16x32_bf16 v[144:147], v[224:227], v[36:39], v[144:147]
    v_mfma_f32_16x16x32_bf16 v[148:151], v[228:231], v[36:39], v[148:151]
    v_mfma_f32_16x16x32_bf16 v[152:155], v[224:227], v[92:95], v[152:155]
    v_mfma_f32_16x16x32_bf16 v[156:159], v[228:231], v[92:95], v[156:159]
    s_waitcnt vmcnt(2)
    s_waitcnt lgkmcnt(4)
    s_barrier
    ds_read_b128 v[164:167], v28
    ds_read_b64 v[176:177], v28 offset:1024
    ds_read_b64 v[182:183], v28 offset:1032
    ds_read_b64_tr_b16 v[216:217], v26 offset:36864
    ds_read_b64_tr_b16 v[218:219], v26 offset:37376
    ds_read_b64_tr_b16 v[220:221], v27 offset:36864
    ds_read_b64_tr_b16 v[222:223], v27 offset:37376
    s_add_u32 m0, s66, 4096
    s_add_u32 s74, s65, 372736
    buffer_load_dwordx4 v31, s[44:47], s74 offen lds
    s_add_u32 m0, s66, 12288
    s_add_u32 s74, s65, 430080
    buffer_load_dwordx4 v31, s[44:47], s74 offen lds
    s_waitcnt lgkmcnt(7)
    v_mfma_f32_16x16x32_bf16 v[144:147], v[208:211], v[40:43], v[144:147]
    v_mfma_f32_16x16x32_bf16 v[148:151], v[212:215], v[40:43], v[148:151]
    v_mfma_f32_16x16x32_bf16 v[152:155], v[208:211], v[96:99], v[152:155]
    v_mfma_f32_16x16x32_bf16 v[156:159], v[212:215], v[96:99], v[156:159]
    ds_read_b64_tr_b16 v[224:225], v26 offset:40960
    ds_read_b64_tr_b16 v[226:227], v26 offset:41472
    ds_read_b64_tr_b16 v[228:229], v27 offset:40960
    ds_read_b64_tr_b16 v[230:231], v27 offset:41472
    s_add_u32 m0, s66, 20480
    s_add_u32 s74, s65, 888832
    buffer_load_dwordx4 v31, s[44:47], s74 offen lds
    s_waitcnt lgkmcnt(4)
    v_mfma_f32_16x16x32_bf16 v[144:147], v[216:219], v[44:47], v[144:147]
    v_mfma_f32_16x16x32_bf16 v[148:151], v[220:223], v[44:47], v[148:151]
    v_mfma_f32_16x16x32_bf16 v[152:155], v[216:219], v[100:103], v[152:155]
    v_mfma_f32_16x16x32_bf16 v[156:159], v[220:223], v[100:103], v[156:159]
    ds_read_b64_tr_b16 v[208:209], v26 offset:45056
    ds_read_b64_tr_b16 v[210:211], v26 offset:45568
    ds_read_b64_tr_b16 v[212:213], v27 offset:45056
    ds_read_b64_tr_b16 v[214:215], v27 offset:45568
    s_add_u32 m0, s66, 28672
    s_add_u32 s74, s65, 946176
    buffer_load_dwordx4 v31, s[44:47], s74 offen lds
    s_waitcnt lgkmcnt(4)
    v_mfma_f32_16x16x32_bf16 v[144:147], v[224:227], v[48:51], v[144:147]
    v_mfma_f32_16x16x32_bf16 v[148:151], v[228:231], v[48:51], v[148:151]
    v_mfma_f32_16x16x32_bf16 v[152:155], v[224:227], v[104:107], v[152:155]
    v_mfma_f32_16x16x32_bf16 v[156:159], v[228:231], v[104:107], v[156:159]
    ds_read_b64_tr_b16 v[216:217], v26 offset:49152
    ds_read_b64_tr_b16 v[218:219], v26 offset:49664
    ds_read_b64_tr_b16 v[220:221], v27 offset:49152
    ds_read_b64_tr_b16 v[222:223], v27 offset:49664
    s_add_u32 m0, s66, 36864
    s_add_u32 s74, s65, 1404928
    buffer_load_dwordx4 v31, s[44:47], s74 offen lds
    s_waitcnt lgkmcnt(4)
    v_mfma_f32_16x16x32_bf16 v[144:147], v[208:211], v[52:55], v[144:147]
    v_mfma_f32_16x16x32_bf16 v[148:151], v[212:215], v[52:55], v[148:151]
    v_mfma_f32_16x16x32_bf16 v[152:155], v[208:211], v[108:111], v[152:155]
    v_mfma_f32_16x16x32_bf16 v[156:159], v[212:215], v[108:111], v[156:159]
    ds_read_b64_tr_b16 v[224:225], v26 offset:53248
    ds_read_b64_tr_b16 v[226:227], v26 offset:53760
    ds_read_b64_tr_b16 v[228:229], v27 offset:53248
    ds_read_b64_tr_b16 v[230:231], v27 offset:53760
    s_add_u32 m0, s66, 45056
    s_add_u32 s74, s65, 1462272
    buffer_load_dwordx4 v31, s[44:47], s74 offen lds
    s_add_u32 m0, s66, 53248
    s_add_u32 s74, s65, 229376
    buffer_load_dwordx4 v31, s[48:51], s74 offen lds
    s_waitcnt lgkmcnt(4)
    v_mfma_f32_16x16x32_bf16 v[144:147], v[216:219], v[56:59], v[144:147]
    v_mfma_f32_16x16x32_bf16 v[148:151], v[220:223], v[56:59], v[148:151]
    v_mfma_f32_16x16x32_bf16 v[152:155], v[216:219], v[112:115], v[152:155]
    v_mfma_f32_16x16x32_bf16 v[156:159], v[220:223], v[112:115], v[156:159]
    ds_read_b64_tr_b16 v[208:209], v26 offset:0
    ds_read_b64_tr_b16 v[210:211], v26 offset:512
    ds_read_b64_tr_b16 v[212:213], v27 offset:0
    ds_read_b64_tr_b16 v[214:215], v27 offset:512
    s_add_u32 m0, s66, 61440
    s_add_u32 s74, s65, 279552
    buffer_load_dwordx4 v31, s[48:51], s74 offen lds
    s_waitcnt lgkmcnt(4)
    v_mfma_f32_16x16x32_bf16 v[144:147], v[224:227], v[60:63], v[144:147]
    v_mfma_f32_16x16x32_bf16 v[148:151], v[228:231], v[60:63], v[148:151]
    v_mfma_f32_16x16x32_bf16 v[152:155], v[224:227], v[116:119], v[152:155]
    v_mfma_f32_16x16x32_bf16 v[156:159], v[228:231], v[116:119], v[156:159]
    ds_read_b64_tr_b16 v[216:217], v26 offset:4096
    ds_read_b64_tr_b16 v[218:219], v26 offset:4608
    ds_read_b64_tr_b16 v[220:221], v27 offset:4096
    ds_read_b64_tr_b16 v[222:223], v27 offset:4608
    s_add_u32 m0, s66, 69632
    s_add_u32 s74, s65, 487424
    buffer_load_dwordx4 v31, s[44:47], s74 offen lds
    s_waitcnt lgkmcnt(4)
    v_mfma_f32_16x16x32_bf16 v[144:147], v[208:211], v[64:67], v[144:147]
    v_mfma_f32_16x16x32_bf16 v[148:151], v[212:215], v[64:67], v[148:151]
    v_mfma_f32_16x16x32_bf16 v[152:155], v[208:211], v[120:123], v[152:155]
    v_mfma_f32_16x16x32_bf16 v[156:159], v[212:215], v[120:123], v[156:159]
    ds_read_b64_tr_b16 v[224:225], v26 offset:8192
    ds_read_b64_tr_b16 v[226:227], v26 offset:8704
    ds_read_b64_tr_b16 v[228:229], v27 offset:8192
    ds_read_b64_tr_b16 v[230:231], v27 offset:8704
    s_add_u32 m0, s66, 102400
    s_add_u32 s74, s65, 1519616
    buffer_load_dwordx4 v31, s[44:47], s74 offen lds
    s_waitcnt lgkmcnt(4)
    v_mfma_f32_16x16x32_bf16 v[144:147], v[216:219], v[68:71], v[144:147]
    v_mfma_f32_16x16x32_bf16 v[148:151], v[220:223], v[68:71], v[148:151]
    v_mfma_f32_16x16x32_bf16 v[152:155], v[216:219], v[124:127], v[152:155]
    v_mfma_f32_16x16x32_bf16 v[156:159], v[220:223], v[124:127], v[156:159]
    s_barrier
    ds_read_b64_tr_b16 v[208:209], v26 offset:12288
    ds_read_b64_tr_b16 v[210:211], v26 offset:12800
    ds_read_b64_tr_b16 v[212:213], v27 offset:12288
    ds_read_b64_tr_b16 v[214:215], v27 offset:12800
    s_add_u32 m0, s66, 77824
    s_add_u32 s74, s65, 544768
    buffer_load_dwordx4 v31, s[44:47], s74 offen lds
    s_add_u32 m0, s66, 86016
    s_add_u32 s74, s65, 1003520
    buffer_load_dwordx4 v31, s[44:47], s74 offen lds
    s_waitcnt lgkmcnt(4)
    v_mfma_f32_16x16x32_bf16 v[144:147], v[224:227], v[72:75], v[144:147]
    v_mfma_f32_16x16x32_bf16 v[148:151], v[228:231], v[72:75], v[148:151]
    v_mfma_f32_16x16x32_bf16 v[152:155], v[224:227], v[128:131], v[152:155]
    v_mfma_f32_16x16x32_bf16 v[156:159], v[228:231], v[128:131], v[156:159]
    ds_read_b64_tr_b16 v[216:217], v26 offset:16384
    ds_read_b64_tr_b16 v[218:219], v26 offset:16896
    ds_read_b64_tr_b16 v[220:221], v27 offset:16384
    ds_read_b64_tr_b16 v[222:223], v27 offset:16896
    s_add_u32 m0, s66, 94208
    s_add_u32 s74, s65, 1060864
    buffer_load_dwordx4 v31, s[44:47], s74 offen lds
    s_waitcnt lgkmcnt(4)
    v_mfma_f32_16x16x32_bf16 v[144:147], v[208:211], v[76:79], v[144:147]
    v_mfma_f32_16x16x32_bf16 v[148:151], v[212:215], v[76:79], v[148:151]
    v_mfma_f32_16x16x32_bf16 v[152:155], v[208:211], v[132:135], v[152:155]
    v_mfma_f32_16x16x32_bf16 v[156:159], v[212:215], v[132:135], v[156:159]
    ds_read_b64_tr_b16 v[224:225], v26 offset:20480
    ds_read_b64_tr_b16 v[226:227], v26 offset:20992
    ds_read_b64_tr_b16 v[228:229], v27 offset:20480
    ds_read_b64_tr_b16 v[230:231], v27 offset:20992
    s_add_u32 m0, s66, 135168
    s_add_u32 s74, s65, 28672
    buffer_load_dwordx4 v31, s[44:47], s74 offen lds
    s_add_u32 m0, s66, 143360
    s_add_u32 s74, s65, 602112
    buffer_load_dwordx4 v31, s[44:47], s74 offen lds
    s_waitcnt lgkmcnt(4)
    v_mfma_f32_16x16x32_bf16 v[144:147], v[216:219], v[80:83], v[144:147]
    v_mfma_f32_16x16x32_bf16 v[148:151], v[220:223], v[80:83], v[148:151]
    v_mfma_f32_16x16x32_bf16 v[152:155], v[216:219], v[136:139], v[152:155]
    v_mfma_f32_16x16x32_bf16 v[156:159], v[220:223], v[136:139], v[156:159]
    s_add_u32 m0, s66, 151552
    s_add_u32 s74, s65, 1118208
    buffer_load_dwordx4 v31, s[44:47], s74 offen lds
    s_waitcnt lgkmcnt(0)
    v_mfma_f32_16x16x32_bf16 v[144:147], v[224:227], v[84:87], v[144:147]
    v_mfma_f32_16x16x32_bf16 v[148:151], v[228:231], v[84:87], v[148:151]
    v_mfma_f32_16x16x32_bf16 v[152:155], v[224:227], v[140:143], v[152:155]
    v_mfma_f32_16x16x32_bf16 v[156:159], v[228:231], v[140:143], v[156:159]
    s_waitcnt vmcnt(8)
    s_barrier
    s_add_u32 m0, s66, 159744
    s_add_u32 s74, s65, 28672
    buffer_load_dwordx4 v31, s[48:51], s74 offen lds
    v_mul_f32 v144, v19, v144
    v_mul_f32 v145, v19, v145
    v_mul_f32 v146, v19, v146
    v_mul_f32 v147, v19, v147
    v_mul_f32 v148, v20, v148
    v_mul_f32 v149, v20, v149
    v_mul_f32 v150, v20, v150
    v_mul_f32 v151, v20, v151
    v_cvt_pk_bf16_f32 v188, v144, v145
    v_cvt_pk_bf16_f32 v189, v146, v147
    v_cvt_pk_bf16_f32 v190, v148, v149
    v_cvt_pk_bf16_f32 v191, v150, v151
    v_mul_f32 v152, v19, v152
    v_mul_f32 v153, v19, v153
    v_mul_f32 v154, v19, v154
    v_mul_f32 v155, v19, v155
    v_mul_f32 v156, v20, v156
    v_mul_f32 v157, v20, v157
    v_mul_f32 v158, v20, v158
    v_mul_f32 v159, v20, v159
    v_cvt_pk_bf16_f32 v192, v152, v153
    v_cvt_pk_bf16_f32 v193, v154, v155
    v_cvt_pk_bf16_f32 v194, v156, v157
    v_cvt_pk_bf16_f32 v195, v158, v159
    s_waitcnt lgkmcnt(0)
    v_mfma_f32_16x16x32_bf16 v[144:147], v[164:167], v[188:191], v[204:207]
    v_mfma_f32_16x16x32_bf16 v[148:151], v[168:171], v[188:191], v[196:199]
    v_mfma_f32_16x16x32_bf16 v[152:155], v[168:171], v[192:195], v[200:203]
    v_mfma_f32_16x16x32_bf16 v[156:159], v[172:175], v[192:195], v[196:199]
    s_nop 5
    v_max3_f32 v208, v144, v145, v148
    s_nop 0
    v_max3_f32 v212, v152, v153, v156
    v_max3_f32 v209, v146, v147, v150
    v_max3_f32 v213, v154, v155, v158
    v_max_f32 v208, v208, v149
    v_max_f32 v212, v212, v157
    v_max_f32 v209, v209, v151
    v_max_f32 v213, v213, v159
    v_max_f32 v210, v208, v209
    v_max_f32 v214, v212, v213
    v_mov_b32 v211, v210
    v_mov_b32 v215, v214
    s_nop 0
    v_permlane16_swap_b32 v210, v211
    v_permlane16_swap_b32 v214, v215
    v_max_f32 v210, v210, v211
    v_max_f32 v214, v214, v215
    v_mov_b32 v211, v210
    v_mov_b32 v215, v214
    s_nop 0
    v_permlane32_swap_b32 v210, v211
    v_permlane32_swap_b32 v214, v215
    v_max_f32 v210, v210, v211
    v_max_f32 v214, v214, v215
    v_sub_f32 v208, v208, v210
    v_sub_f32 v212, v212, v214
    v_sub_f32 v209, v209, v210
    v_sub_f32 v213, v213, v214
    v_exp_f32 v208, v208
    v_exp_f32 v212, v212
    v_exp_f32 v209, v209
    v_exp_f32 v213, v213
    v_add_f32 v210, v208, v209
    v_add_f32 v214, v212, v213
    v_mov_b32 v211, v210
    v_mov_b32 v215, v214
    s_nop 0
    v_permlane16_swap_b32 v210, v211
    v_permlane16_swap_b32 v214, v215
    v_add_f32 v210, v210, v211
    v_add_f32 v214, v214, v215
    v_mov_b32 v211, v210
    v_mov_b32 v215, v214
    s_nop 0
    v_permlane32_swap_b32 v210, v211
    v_permlane32_swap_b32 v214, v215
    v_add_f32 v210, v210, v211
    v_add_f32 v214, v214, v215
    v_rcp_f32 v210, v210
    v_rcp_f32 v214, v214
    v_mul_f32 v208, v208, v210
    v_mul_f32 v212, v212, v214
    v_mul_f32 v209, v209, v210
    v_mul_f32 v213, v213, v214
    v_cvt_pk_bf16_f32 v208, v208, v208
    v_cvt_pk_bf16_f32 v212, v212, v212
    v_cvt_pk_bf16_f32 v209, v209, v209
    v_cvt_pk_bf16_f32 v213, v213, v213
    v_and_b32 v216, v244, v208
    v_and_b32 v220, v244, v212
    v_and_b32 v217, v245, v209
    v_and_b32 v221, v245, v213
    v_and_b32 v218, v246, v208
    v_and_b32 v222, v246, v212
    v_and_b32 v219, v247, v209
    v_and_b32 v223, v247, v213
    s_nop 0
    v_mfma_f32_16x16x32_bf16 v[144:147], v[176:179], v[216:219], 0
    v_mfma_f32_16x16x32_bf16 v[148:151], v[182:185], v[216:219], 0
    v_mfma_f32_16x16x32_bf16 v[152:155], v[178:181], v[220:223], 0
    v_mfma_f32_16x16x32_bf16 v[156:159], v[184:187], v[220:223], 0
    s_nop 4
    v_cvt_pk_bf16_f32 v224, v144, v145
    v_cvt_pk_bf16_f32 v225, v146, v147
    v_cvt_pk_bf16_f32 v226, v148, v149
    v_cvt_pk_bf16_f32 v227, v150, v151
    v_and_b32 v226, v21, v226
    v_and_b32 v227, v21, v227
    buffer_store_dwordx4 v[224:227], v22, s[36:39], s79 offen offset:0 sc1
    v_cvt_pk_bf16_f32 v228, v152, v153
    v_cvt_pk_bf16_f32 v229, v154, v155
    v_cvt_pk_bf16_f32 v230, v156, v157
    v_cvt_pk_bf16_f32 v231, v158, v159
    v_and_b32 v230, v21, v230
    v_and_b32 v231, v21, v231
    buffer_store_dwordx4 v[228:231], v22, s[36:39], s79 offen offset:256 sc1
    s_lshl_b32 s72, s61, 12
    s_lshl_b32 s73, s63, 8
    s_add_u32 s72, s72, s73
    s_lshl_b32 s73, s62, 5
    s_add_u32 s72, s72, s73
    s_lshl_b32 s73, s60, 2
    s_add_u32 s72, s72, s73
    s_add_u32 s72, s72, 262144
    s_branch L_P2
L_P2:
    s_and_b32 s76, s60, 1
    s_mov_b32 s78, 0xbfb8aa3b
    s_mov_b32 s79, 0xbfb8aa3b
    s_mov_b32 s80, 1.0
    s_mov_b32 s81, 1.0
    v_lshrrev_b32 v12, 5, v1
    v_bfe_u32 v13, v1, 2, 2
    v_lshl_add_u32 v14, v12, 2, v13
    v_bfe_u32 v15, v1, 4, 1
    v_lshlrev_b32 v15, 1, v15
    v_bfe_u32 v12, v1, 1, 1
    v_or_b32 v15, v15, v12
    v_lshrrev_b32 v13, 1, v13
    v_lshlrev_b32 v13, 2, v13
    v_xor_b32 v15, v15, v13
    v_lshlrev_b32 v15, 4, v15
    v_and_b32 v12, 1, v1
    v_lshl_or_b32 v15, v12, 3, v15
    v_lshl_add_u32 v5, v14, 7, v15
    v_xor_b32 v8, 64, v5
    v_add_u32 v6, 0x10000, v5
    v_add_u32 v7, 0x20000, v5
    v_add_u32 v9, 0x10000, v8
    v_add_u32 v10, 0x20000, v8
    s_lshl_b32 s70, s64, 1
    s_add_u32 s70, s70, s76
    s_mul_i32 s77, s70, 148480
    s_add_u32 s77, s77, 1048576
    s_lshl_b32 s70, s70, 5
    v_and_b32 v12, 31, v1
    v_add_u32 v12, s70, v12
    v_mul_u32_u24 v3, 896, v12
    v_lshrrev_b32 v12, 5, v1
    v_lshlrev_b32 v12, 4, v12
    v_add3_u32 v3, v3, v12, s65
    s_cmp_ge_u32 s60, 6
    s_cbranch_scc1 L_P2_2
    s_cmp_ge_u32 s60, 4
    s_cbranch_scc1 L_P2_3
    s_cmp_ge_u32 s60, 2
    s_cbranch_scc1 L_P2_1
L_P2_0:
    s_min_u32 s70, s65, 768
    s_load_dwordx16 s[4:19], s[58:59], s70
    s_add_u32 s70, s70, 64
    ds_read_b64_tr_b16 v[128:129], v5 offset:0
    ds_read_b64_tr_b16 v[130:131], v5 offset:1024
    ds_read_b64_tr_b16 v[132:133], v8 offset:0
    ds_read_b64_tr_b16 v[134:135], v8 offset:1024
    ds_read_b64_tr_b16 v[136:137], v5 offset:2048
    ds_read_b64_tr_b16 v[138:139], v5 offset:3072
    ds_read_b64_tr_b16 v[140:141], v8 offset:2048
    ds_read_b64_tr_b16 v[142:143], v8 offset:3072
    ds_read_b64_tr_b16 v[144:145], v5 offset:4096
    ds_read_b64_tr_b16 v[146:147], v5 offset:5120
    ds_read_b64_tr_b16 v[148:149], v8 offset:4096
    ds_read_b64_tr_b16 v[150:151], v8 offset:5120
    ds_read_b64_tr_b16 v[152:153], v5 offset:6144
    ds_read_b64_tr_b16 v[154:155], v5 offset:7168
    ds_read_b64_tr_b16 v[156:157], v8 offset:6144
    ds_read_b64_tr_b16 v[158:159], v8 offset:7168
    ds_read_b64_tr_b16 v[160:161], v5 offset:8192
    ds_read_b64_tr_b16 v[162:163], v5 offset:9216
    ds_read_b64_tr_b16 v[164:165], v8 offset:8192
    ds_read_b64_tr_b16 v[166:167], v8 offset:9216
    ds_read_b64_tr_b16 v[168:169], v5 offset:10240
    ds_read_b64_tr_b16 v[170:171], v5 offset:11264
    ds_read_b64_tr_b16 v[172:173], v8 offset:10240
    ds_read_b64_tr_b16 v[174:175], v8 offset:11264
    ds_read_b64_tr_b16 v[176:177], v5 offset:12288
    ds_read_b64_tr_b16 v[178:179], v5 offset:13312
    ds_read_b64_tr_b16 v[180:181], v8 offset:12288
    ds_read_b64_tr_b16 v[182:183], v8 offset:13312
    ds_read_b64_tr_b16 v[184:185], v5 offset:14336
    ds_read_b64_tr_b16 v[186:187], v5 offset:15360
    ds_read_b64_tr_b16 v[188:189], v8 offset:14336
    ds_read_b64_tr_b16 v[190:191], v8 offset:15360
    s_cmp_eq_u32 s63, 0
    s_cbranch_scc1 L_P2_0h
    s_add_u32 m0, s66, 106496
    s_add_u32 s74, s65, 1548288
    buffer_load_dwordx4 v31, s[44:47], s74 offen lds
    s_add_u32 m0, s66, 114688
    s_add_u32 s74, s65, 301056
    buffer_load_dwordx4 v31, s[48:51], s74 offen lds
    s_add_u32 m0, s66, 122880
    s_add_u32 s74, s65, 351232
    buffer_load_dwordx4 v31, s[48:51], s74 offen lds
    v_mov_b32 v16, 1
    v_mov_b32 v17, 0
    s_mov_b64 exec, 1
    s_waitcnt vmcnt(3)
    buffer_store_dword v16, v17, s[36:39], s72 offen sc1
    s_mov_b64 exec, -1
    s_branch L_P2_0c
L_P2_0h:
    v_mov_b32 v16, 1
    v_mov_b32 v17, 0
    s_mov_b64 exec, 1
    s_waitcnt vmcnt(0)
    buffer_store_dword v16, v17, s[36:39], s72 offen sc1
    s_mov_b64 exec, -1
L_P2_0c:
    v_mov_b32 v29, 0xffff0000
    s_mov_b32 s82, 0
    s_mov_b32 s83, -1
    s_waitcnt lgkmcnt(0)
    v_lshlrev_b32 v96, 16, s4
    v_and_b32 v97, s4, v29
    v_lshlrev_b32 v98, 16, s5
    v_and_b32 v99, s5, v29
    v_lshlrev_b32 v100, 16, s8
    v_and_b32 v101, s8, v29
    v_lshlrev_b32 v102, 16, s9
    v_and_b32 v103, s9, v29
    v_lshlrev_b32 v104, 16, s12
    v_and_b32 v105, s12, v29
    v_lshlrev_b32 v106, 16, s13
    v_and_b32 v107, s13, v29
    v_lshlrev_b32 v108, 16, s16
    v_and_b32 v109, s16, v29
    v_lshlrev_b32 v110, 16, s17
    v_and_b32 v111, s17, v29
    s_mov_b64 exec, s[82:83]
    v_lshlrev_b32 v96, 16, s6
    v_and_b32 v97, s6, v29
    v_lshlrev_b32 v98, 16, s7
    v_and_b32 v99, s7, v29
    v_lshlrev_b32 v100, 16, s10
    v_and_b32 v101, s10, v29
    v_lshlrev_b32 v102, 16, s11
    v_and_b32 v103, s11, v29
    v_lshlrev_b32 v104, 16, s14
    v_and_b32 v105, s14, v29
    v_lshlrev_b32 v106, 16, s15
    v_and_b32 v107, s15, v29
    v_lshlrev_b32 v108, 16, s18
    v_and_b32 v109, s18, v29
    v_lshlrev_b32 v110, 16, s19
    v_and_b32 v111, s19, v29
    s_mov_b64 exec, -1
    s_load_dwordx16 s[4:19], s[58:59], s70
    buffer_load_dwordx4 v[12:15], v3, s[28:31], 0 offen offset:0
    s_waitcnt lgkmcnt(0)
    s_barrier
    s_cmp_ge_u32 s65, 896
    s_cbranch_scc1 L_FIN
    s_add_u32 m0, s66, 0
    s_add_u32 s74, s65, 57344
    buffer_load_dwordx4 v31, s[44:47], s74 offen lds
    s_add_u32 m0, s66, 8192
    s_add_u32 s74, s65, 114688
    buffer_load_dwordx4 v31, s[44:47], s74 offen lds
    s_add_u32 m0, s66, 16384
    s_add_u32 s74, s65, 630784
    buffer_load_dwordx4 v31, s[44:47], s74 offen lds
    s_add_u32 m0, s66, 24576
    s_add_u32 s74, s65, 688128
    buffer_load_dwordx4 v31, s[44:47], s74 offen lds
    s_add_u32 m0, s66, 32768
    s_add_u32 s74, s65, 1146880
    buffer_load_dwordx4 v31, s[44:47], s74 offen lds
    s_add_u32 m0, s66, 40960
    s_add_u32 s74, s65, 1204224
    buffer_load_dwordx4 v31, s[44:47], s74 offen lds
    s_add_u32 m0, s66, 49152
    s_add_u32 s74, s65, 50176
    buffer_load_dwordx4 v31, s[48:51], s74 offen lds
    s_add_u32 m0, s66, 57344
    s_add_u32 s74, s65, 100352
    buffer_load_dwordx4 v31, s[48:51], s74 offen lds
    s_waitcnt vmcnt(9)
    s_barrier
    ds_read_b64_tr_b16 v[192:193], v6 offset:0
    ds_read_b64_tr_b16 v[194:195], v6 offset:1024
    ds_read_b64_tr_b16 v[196:197], v9 offset:0
    ds_read_b64_tr_b16 v[198:199], v9 offset:1024
    ds_read_b64_tr_b16 v[200:201], v6 offset:2048
    ds_read_b64_tr_b16 v[202:203], v6 offset:3072
    ds_read_b64_tr_b16 v[204:205], v9 offset:2048
    ds_read_b64_tr_b16 v[206:207], v9 offset:3072
    ds_read_b64_tr_b16 v[208:209], v6 offset:4096
    ds_read_b64_tr_b16 v[210:211], v6 offset:5120
    ds_read_b64_tr_b16 v[212:213], v9 offset:4096
    ds_read_b64_tr_b16 v[214:215], v9 offset:5120
    ds_read_b64_tr_b16 v[216:217], v6 offset:6144
    ds_read_b64_tr_b16 v[218:219], v6 offset:7168
    ds_read_b64_tr_b16 v[220:221], v9 offset:6144
    ds_read_b64_tr_b16 v[222:223], v9 offset:7168
    ds_read_b64_tr_b16 v[224:225], v6 offset:8192
    ds_read_b64_tr_b16 v[226:227], v6 offset:9216
    ds_read_b64_tr_b16 v[228:229], v9 offset:8192
    ds_read_b64_tr_b16 v[230:231], v9 offset:9216
    ds_read_b64_tr_b16 v[232:233], v6 offset:10240
    ds_read_b64_tr_b16 v[234:235], v6 offset:11264
    ds_read_b64_tr_b16 v[236:237], v9 offset:10240
    ds_read_b64_tr_b16 v[238:239], v9 offset:11264
    ds_read_b64_tr_b16 v[240:241], v6 offset:12288
    ds_read_b64_tr_b16 v[242:243], v6 offset:13312
    ds_read_b64_tr_b16 v[244:245], v9 offset:12288
    ds_read_b64_tr_b16 v[246:247], v9 offset:13312
    ds_read_b64_tr_b16 v[248:249], v6 offset:14336
    ds_read_b64_tr_b16 v[250:251], v6 offset:15360
    ds_read_b64_tr_b16 v[252:253], v9 offset:14336
    ds_read_b64_tr_b16 v[254:255], v9 offset:15360
    v_lshlrev_b32 v112, 16, s4
    v_and_b32 v113, s4, v29
    v_lshlrev_b32 v114, 16, s5
    v_and_b32 v115, s5, v29
    v_lshlrev_b32 v116, 16, s8
    v_and_b32 v117, s8, v29
    v_lshlrev_b32 v118, 16, s9
    v_and_b32 v119, s9, v29
    v_lshlrev_b32 v120, 16, s12
    v_and_b32 v121, s12, v29
    v_lshlrev_b32 v122, 16, s13
    v_and_b32 v123, s13, v29
    v_lshlrev_b32 v124, 16, s16
    v_and_b32 v125, s16, v29
    v_lshlrev_b32 v126, 16, s17
    v_and_b32 v127, s17, v29
    s_mov_b64 exec, s[82:83]
    v_lshlrev_b32 v112, 16, s6
    v_and_b32 v113, s6, v29
    v_lshlrev_b32 v114, 16, s7
    v_and_b32 v115, s7, v29
    v_lshlrev_b32 v116, 16, s10
    v_and_b32 v117, s10, v29
    v_lshlrev_b32 v118, 16, s11
    v_and_b32 v119, s11, v29
    v_lshlrev_b32 v120, 16, s14
    v_and_b32 v121, s14, v29
    v_lshlrev_b32 v122, 16, s15
    v_and_b32 v123, s15, v29
    v_lshlrev_b32 v124, 16, s18
    v_and_b32 v125, s18, v29
    v_lshlrev_b32 v126, 16, s19
    v_and_b32 v127, s19, v29
    s_mov_b64 exec, -1
    s_waitcnt lgkmcnt(0)
    s_barrier
    s_cmp_lg_u32 s60, 0
    s_cbranch_scc1 L_np
    s_mov_b32 s71, 0
    s_lshr_b32 s72, s64, 1
    s_lshl_b32 s72, s72, 12
    s_add_u32 s72, s72, 262144
    v_lshlrev_b32 v11, 3, v1
L_poll:
    buffer_load_dwordx2 v[16:17], v11, s[36:39], s72 offen sc1
    s_waitcnt vmcnt(0)
    v_and_b32 v16, v16, v17
    v_cmp_ne_u32 vcc, 1, v16
    s_nop 1
    s_cbranch_vccz L_got
    s_add_u32 s71, s71, 1
    s_cmp_ge_u32 s71, 0x40000
    s_cbranch_scc1 L_got
    s_sleep 1
    s_branch L_poll
L_got:
    s_barrier
    s_add_u32 m0, s66, 65536
    s_add_u32 s74, s65, 172032
    buffer_load_dwordx4 v31, s[44:47], s74 offen lds
    s_add_u32 m0, s66, 69632
    s_add_u32 s74, s65, 200704
    buffer_load_dwordx4 v31, s[44:47], s74 offen lds
    s_add_u32 m0, s66, 73728
    s_add_u32 s74, s65, 745472
    buffer_load_dwordx4 v31, s[44:47], s74 offen lds
    s_add_u32 m0, s66, 77824
    s_add_u32 s74, s65, 774144
    buffer_load_dwordx4 v31, s[44:47], s74 offen lds
    s_add_u32 m0, s66, 81920
    s_add_u32 s74, s65, 1261568
    buffer_load_dwordx4 v31, s[44:47], s74 offen lds
    s_add_u32 m0, s66, 86016
    s_add_u32 s74, s65, 1290240
    buffer_load_dwordx4 v31, s[44:47], s74 offen lds
    s_add_u32 m0, s66, 90112
    s_add_u32 s74, s65, 150528
    buffer_load_dwordx4 v31, s[48:51], s74 offen lds
    s_add_u32 m0, s66, 94208
    s_add_u32 s74, s65, 179200
    buffer_load_dwordx4 v31, s[48:51], s74 offen lds
    s_add_u32 m0, s66, 98304
    s_add_u32 s74, s65, 229376
    buffer_load_dwordx4 v31, s[44:47], s74 offen lds
    s_add_u32 m0, s66, 102400
    s_add_u32 s74, s65, 258048
    buffer_load_dwordx4 v31, s[44:47], s74 offen lds
    s_add_u32 m0, s66, 106496
    s_add_u32 s74, s65, 802816
    buffer_load_dwordx4 v31, s[44:47], s74 offen lds
    s_add_u32 m0, s66, 110592
    s_add_u32 s74, s65, 831488
    buffer_load_dwordx4 v31, s[44:47], s74 offen lds
    s_add_u32 m0, s66, 114688
    s_add_u32 s74, s65, 1318912
    buffer_load_dwordx4 v31, s[44:47], s74 offen lds
    s_add_u32 m0, s66, 118784
    s_add_u32 s74, s65, 1347584
    buffer_load_dwordx4 v31, s[44:47], s74 offen lds
    s_add_u32 m0, s66, 122880
    s_add_u32 s74, s65, 286720
    buffer_load_dwordx4 v31, s[44:47], s74 offen lds
    s_add_u32 m0, s66, 126976
    s_add_u32 s74, s65, 315392
    buffer_load_dwordx4 v31, s[44:47], s74 offen lds
    s_branch L_u
L_np:
    s_add_u32 m0, s66, 65536
    s_add_u32 s74, s65, 172032
    buffer_load_dwordx4 v31, s[44:47], s74 offen lds
    s_add_u32 m0, s66, 69632
    s_add_u32 s74, s65, 200704
    buffer_load_dwordx4 v31, s[44:47], s74 offen lds
    s_add_u32 m0, s66, 73728
    s_add_u32 s74, s65, 745472
    buffer_load_dwordx4 v31, s[44:47], s74 offen lds
    s_add_u32 m0, s66, 77824
    s_add_u32 s74, s65, 774144
    buffer_load_dwordx4 v31, s[44:47], s74 offen lds
    s_add_u32 m0, s66, 81920
    s_add_u32 s74, s65, 1261568
    buffer_load_dwordx4 v31, s[44:47], s74 offen lds
    s_add_u32 m0, s66, 86016
    s_add_u32 s74, s65, 1290240
    buffer_load_dwordx4 v31, s[44:47], s74 offen lds
    s_add_u32 m0, s66, 90112
    s_add_u32 s74, s65, 150528
    buffer_load_dwordx4 v31, s[48:51], s74 offen lds
    s_add_u32 m0, s66, 94208
    s_add_u32 s74, s65, 179200
    buffer_load_dwordx4 v31, s[48:51], s74 offen lds
    s_add_u32 m0, s66, 98304
    s_add_u32 s74, s65, 229376
    buffer_load_dwordx4 v31, s[44:47], s74 offen lds
    s_add_u32 m0, s66, 102400
    s_add_u32 s74, s65, 258048
    buffer_load_dwordx4 v31, s[44:47], s74 offen lds
    s_add_u32 m0, s66, 106496
    s_add_u32 s74, s65, 802816
    buffer_load_dwordx4 v31, s[44:47], s74 offen lds
    s_add_u32 m0, s66, 110592
    s_add_u32 s74, s65, 831488
    buffer_load_dwordx4 v31, s[44:47], s74 offen lds
    s_add_u32 m0, s66, 114688
    s_add_u32 s74, s65, 1318912
    buffer_load_dwordx4 v31, s[44:47], s74 offen lds
    s_add_u32 m0, s66, 118784
    s_add_u32 s74, s65, 1347584
    buffer_load_dwordx4 v31, s[44:47], s74 offen lds
    s_add_u32 m0, s66, 122880
    s_add_u32 s74, s65, 286720
    buffer_load_dwordx4 v31, s[44:47], s74 offen lds
    s_add_u32 m0, s66, 126976
    s_add_u32 s74, s65, 315392
    buffer_load_dwordx4 v31, s[44:47], s74 offen lds
    s_barrier
L_u:
    s_add_u32 s74, s77, 24576
    buffer_load_dwordx4 v[32:35], v2, s[36:39], s74 offen sc1
    s_add_u32 s74, s77, 25600
    buffer_load_dwordx4 v[36:39], v2, s[36:39], s74 offen sc1
    s_add_u32 s74, s77, 26624
    buffer_load_dwordx4 v[40:43], v2, s[36:39], s74 offen sc1
    s_add_u32 s74, s77, 27648
    buffer_load_dwordx4 v[44:47], v2, s[36:39], s74 offen sc1
    s_add_u32 s74, s77, 28672
    buffer_load_dwordx4 v[48:51], v2, s[36:39], s74 offen sc1
    s_add_u32 s74, s77, 29696
    buffer_load_dwordx4 v[52:55], v2, s[36:39], s74 offen sc1
    s_add_u32 s74, s77, 30720
    buffer_load_dwordx4 v[56:59], v2, s[36:39], s74 offen sc1
    s_add_u32 s74, s77, 31744
    buffer_load_dwordx4 v[60:63], v2, s[36:39], s74 offen sc1
    s_waitcnt vmcnt(7)
    v_mfma_f32_32x32x16_bf16 v[96:111], v[128:131], v[32:35], v[96:111]
    v_mfma_f32_32x32x16_bf16 v[112:127], v[132:135], v[32:35], v[112:127]
    s_barrier
    s_add_u32 s74, s77, 32768
    buffer_load_dwordx4 v[64:67], v2, s[36:39], s74 offen sc1
    s_waitcnt vmcnt(7)
    v_mfma_f32_32x32x16_bf16 v[96:111], v[136:139], v[36:39], v[96:111]
    v_mfma_f32_32x32x16_bf16 v[112:127], v[140:143], v[36:39], v[112:127]
    s_add_u32 s74, s77, 33792
    buffer_load_dwordx4 v[68:71], v2, s[36:39], s74 offen sc1
    s_waitcnt vmcnt(7)
    v_mfma_f32_32x32x16_bf16 v[96:111], v[144:147], v[40:43], v[96:111]
    v_mfma_f32_32x32x16_bf16 v[112:127], v[148:151], v[40:43], v[112:127]
    s_add_u32 s74, s77, 34816
    buffer_load_dwordx4 v[72:75], v2, s[36:39], s74 offen sc1
    s_waitcnt vmcnt(7)
    v_mfma_f32_32x32x16_bf16 v[96:111], v[152:155], v[44:47], v[96:111]
    v_mfma_f32_32x32x16_bf16 v[112:127], v[156:159], v[44:47], v[112:127]
    s_add_u32 s74, s77, 35840
    buffer_load_dwordx4 v[76:79], v2, s[36:39], s74 offen sc1
    s_waitcnt vmcnt(7)
    v_mfma_f32_32x32x16_bf16 v[96:111], v[160:163], v[48:51], v[96:111]
    v_mfma_f32_32x32x16_bf16 v[112:127], v[164:167], v[48:51], v[112:127]
    s_add_u32 s74, s77, 36864
    buffer_load_dwordx4 v[80:83], v2, s[36:39], s74 offen sc1
    s_waitcnt vmcnt(7)
    v_mfma_f32_32x32x16_bf16 v[96:111], v[168:171], v[52:55], v[96:111]
    v_mfma_f32_32x32x16_bf16 v[112:127], v[172:175], v[52:55], v[112:127]
    s_add_u32 s74, s77, 37888
    buffer_load_dwordx4 v[84:87], v2, s[36:39], s74 offen sc1
    s_waitcnt vmcnt(7)
    v_mfma_f32_32x32x16_bf16 v[96:111], v[176:179], v[56:59], v[96:111]
    v_mfma_f32_32x32x16_bf16 v[112:127], v[180:183], v[56:59], v[112:127]
    s_add_u32 s74, s77, 38912
    buffer_load_dwordx4 v[88:91], v2, s[36:39], s74 offen sc1
    s_waitcnt vmcnt(7)
    v_mfma_f32_32x32x16_bf16 v[96:111], v[184:187], v[60:63], v[96:111]
    v_mfma_f32_32x32x16_bf16 v[112:127], v[188:191], v[60:63], v[112:127]
    s_add_u32 s74, s77, 39936
    buffer_load_dwordx4 v[92:95], v2, s[36:39], s74 offen sc1
    s_waitcnt vmcnt(7)
    v_mfma_f32_32x32x16_bf16 v[96:111], v[192:195], v[64:67], v[96:111]
    v_mfma_f32_32x32x16_bf16 v[112:127], v[196:199], v[64:67], v[112:127]
    s_add_u32 s74, s77, 0
    buffer_load_dwordx4 v[32:35], v2, s[36:39], s74 offen sc1
    s_waitcnt vmcnt(7)
    v_mfma_f32_32x32x16_bf16 v[96:111], v[200:203], v[68:71], v[96:111]
    v_mfma_f32_32x32x16_bf16 v[112:127], v[204:207], v[68:71], v[112:127]
    s_add_u32 s74, s77, 1024
    buffer_load_dwordx4 v[128:131], v2, s[36:39], s74 offen sc1
    s_waitcnt vmcnt(7)
    v_mfma_f32_32x32x16_bf16 v[96:111], v[208:211], v[72:75], v[96:111]
    v_mfma_f32_32x32x16_bf16 v[112:127], v[212:215], v[72:75], v[112:127]
    s_add_u32 s74, s77, 2048
    buffer_load_dwordx4 v[132:135], v2, s[36:39], s74 offen sc1
    s_waitcnt vmcnt(7)
    v_mfma_f32_32x32x16_bf16 v[96:111], v[216:219], v[76:79], v[96:111]
    v_mfma_f32_32x32x16_bf16 v[112:127], v[220:223], v[76:79], v[112:127]
    s_add_u32 s74, s77, 3072
    buffer_load_dwordx4 v[36:39], v2, s[36:39], s74 offen sc1
    s_waitcnt vmcnt(7)
    v_mfma_f32_32x32x16_bf16 v[96:111], v[224:227], v[80:83], v[96:111]
    v_mfma_f32_32x32x16_bf16 v[112:127], v[228:231], v[80:83], v[112:127]
    s_add_u32 s74, s77, 4096
    buffer_load_dwordx4 v[136:139], v2, s[36:39], s74 offen sc1
    s_waitcnt vmcnt(7)
    v_mfma_f32_32x32x16_bf16 v[96:111], v[232:235], v[84:87], v[96:111]
    v_mfma_f32_32x32x16_bf16 v[112:127], v[236:239], v[84:87], v[112:127]
    s_add_u32 s74, s77, 5120
    buffer_load_dwordx4 v[140:143], v2, s[36:39], s74 offen sc1
    s_waitcnt vmcnt(7)
    v_mfma_f32_32x32x16_bf16 v[96:111], v[240:243], v[88:91], v[96:111]
    v_mfma_f32_32x32x16_bf16 v[112:127], v[244:247], v[88:91], v[112:127]
    ds_read_b64_tr_b16 v[16:17], v7 offset:0
    ds_read_b64_tr_b16 v[18:19], v7 offset:1024
    ds_read_b64_tr_b16 v[20:21], v10 offset:0
    ds_read_b64_tr_b16 v[22:23], v10 offset:1024
    s_add_u32 s74, s77, 6144
    buffer_load_dwordx4 v[40:43], v2, s[36:39], s74 offen sc1
    s_waitcnt vmcnt(7)
    v_mfma_f32_32x32x16_bf16 v[96:111], v[248:251], v[92:95], v[96:111]
    v_mfma_f32_32x32x16_bf16 v[112:127], v[252:255], v[92:95], v[112:127]
    ds_read_b64_tr_b16 v[24:25], v7 offset:2048
    ds_read_b64_tr_b16 v[26:27], v7 offset:3072
    ds_read_b64_tr_b16 v[28:29], v10 offset:2048
    ds_read_b64_tr_b16 v[30:31], v10 offset:3072
    s_add_u32 s74, s77, 7168
    buffer_load_dwordx4 v[144:147], v2, s[36:39], s74 offen sc1
    s_waitcnt vmcnt(7)
    s_waitcnt lgkmcnt(4)
    v_mfma_f32_32x32x16_bf16 v[96:111], v[16:19], v[32:35], v[96:111]
    v_mfma_f32_32x32x16_bf16 v[112:127], v[20:23], v[32:35], v[112:127]
    ds_read_b64_tr_b16 v[16:17], v7 offset:4096
    ds_read_b64_tr_b16 v[18:19], v7 offset:5120
    ds_read_b64_tr_b16 v[20:21], v10 offset:4096
    ds_read_b64_tr_b16 v[22:23], v10 offset:5120
    s_add_u32 s74, s77, 8192
    buffer_load_dwordx4 v[148:151], v2, s[36:39], s74 offen sc1
    s_waitcnt vmcnt(7)
    s_waitcnt lgkmcnt(4)
    v_mfma_f32_32x32x16_bf16 v[96:111], v[24:27], v[128:131], v[96:111]
    v_mfma_f32_32x32x16_bf16 v[112:127], v[28:31], v[128:131], v[112:127]
    ds_read_b64_tr_b16 v[24:25], v7 offset:6144
    ds_read_b64_tr_b16 v[26:27], v7 offset:7168
    ds_read_b64_tr_b16 v[28:29], v10 offset:6144
    ds_read_b64_tr_b16 v[30:31], v10 offset:7168
    s_add_u32 s74, s77, 9216
    buffer_load_dwordx4 v[44:47], v2, s[36:39], s74 offen sc1
    s_waitcnt vmcnt(7)
    s_waitcnt lgkmcnt(4)
    v_mfma_f32_32x32x16_bf16 v[96:111], v[16:19], v[132:135], v[96:111]
    v_mfma_f32_32x32x16_bf16 v[112:127], v[20:23], v[132:135], v[112:127]
    ds_read_b64_tr_b16 v[16:17], v5 offset:0
    ds_read_b64_tr_b16 v[18:19], v5 offset:1024
    ds_read_b64_tr_b16 v[20:21], v8 offset:0
    ds_read_b64_tr_b16 v[22:23], v8 offset:1024
    s_add_u32 s74, s77, 10240
    buffer_load_dwordx4 v[152:155], v2, s[36:39], s74 offen sc1
    s_waitcnt vmcnt(7)
    s_waitcnt lgkmcnt(4)
    v_mfma_f32_32x32x16_bf16 v[96:111], v[24:27], v[36:39], v[96:111]
    v_mfma_f32_32x32x16_bf16 v[112:127], v[28:31], v[36:39], v[112:127]
    ds_read_b64_tr_b16 v[24:25], v5 offset:2048
    ds_read_b64_tr_b16 v[26:27], v5 offset:3072
    ds_read_b64_tr_b16 v[28:29], v8 offset:2048
    ds_read_b64_tr_b16 v[30:31], v8 offset:3072
    s_add_u32 s74, s77, 11264
    buffer_load_dwordx4 v[156:159], v2, s[36:39], s74 offen sc1
    s_waitcnt vmcnt(7)
    s_waitcnt lgkmcnt(4)
    v_mfma_f32_32x32x16_bf16 v[96:111], v[16:19], v[136:139], v[96:111]
    v_mfma_f32_32x32x16_bf16 v[112:127], v[20:23], v[136:139], v[112:127]
    ds_read_b64_tr_b16 v[16:17], v5 offset:4096
    ds_read_b64_tr_b16 v[18:19], v5 offset:5120
    ds_read_b64_tr_b16 v[20:21], v8 offset:4096
    ds_read_b64_tr_b16 v[22:23], v8 offset:5120
    s_add_u32 s74, s77, 12288
    buffer_load_dwordx4 v[48:51], v2, s[36:39], s74 offen sc1
    s_waitcnt vmcnt(7)
    s_waitcnt lgkmcnt(4)
    v_mfma_f32_32x32x16_bf16 v[96:111], v[24:27], v[140:143], v[96:111]
    v_mfma_f32_32x32x16_bf16 v[112:127], v[28:31], v[140:143], v[112:127]
    ds_read_b64_tr_b16 v[24:25], v5 offset:6144
    ds_read_b64_tr_b16 v[26:27], v5 offset:7168
    ds_read_b64_tr_b16 v[28:29], v8 offset:6144
    ds_read_b64_tr_b16 v[30:31], v8 offset:7168
    s_add_u32 s74, s77, 13312
    buffer_load_dwordx4 v[160:163], v2, s[36:39], s74 offen sc1
    s_waitcnt vmcnt(7)
    s_waitcnt lgkmcnt(4)
    v_mfma_f32_32x32x16_bf16 v[96:111], v[16:19], v[40:43], v[96:111]
    v_mfma_f32_32x32x16_bf16 v[112:127], v[20:23], v[40:43], v[112:127]
    ds_read_b64_tr_b16 v[16:17], v5 offset:8192
    ds_read_b64_tr_b16 v[18:19], v5 offset:9216
    ds_read_b64_tr_b16 v[20:21], v8 offset:8192
    ds_read_b64_tr_b16 v[22:23], v8 offset:9216
    s_add_u32 s74, s77, 14336
    buffer_load_dwordx4 v[164:167], v2, s[36:39], s74 offen sc1
    s_waitcnt vmcnt(7)
    s_waitcnt lgkmcnt(4)
    v_mfma_f32_32x32x16_bf16 v[96:111], v[24:27], v[144:147], v[96:111]
    v_mfma_f32_32x32x16_bf16 v[112:127], v[28:31], v[144:147], v[112:127]
    ds_read_b64_tr_b16 v[24:25], v5 offset:10240
    ds_read_b64_tr_b16 v[26:27], v5 offset:11264
    ds_read_b64_tr_b16 v[28:29], v8 offset:10240
    ds_read_b64_tr_b16 v[30:31], v8 offset:11264
    s_add_u32 s74, s77, 15360
    buffer_load_dwordx4 v[52:55], v2, s[36:39], s74 offen sc1
    s_waitcnt vmcnt(7)
    s_waitcnt lgkmcnt(4)
    v_mfma_f32_32x32x16_bf16 v[96:111], v[16:19], v[148:151], v[96:111]
    v_mfma_f32_32x32x16_bf16 v[112:127], v[20:23], v[148:151], v[112:127]
    ds_read_b64_tr_b16 v[16:17], v5 offset:12288
    ds_read_b64_tr_b16 v[18:19], v5 offset:13312
    ds_read_b64_tr_b16 v[20:21], v8 offset:12288
    ds_read_b64_tr_b16 v[22:23], v8 offset:13312
    s_add_u32 s74, s77, 16384
    buffer_load_dwordx4 v[168:171], v2, s[36:39], s74 offen sc1
    s_waitcnt vmcnt(7)
    s_waitcnt lgkmcnt(4)
    v_mfma_f32_32x32x16_bf16 v[96:111], v[24:27], v[44:47], v[96:111]
    v_mfma_f32_32x32x16_bf16 v[112:127], v[28:31], v[44:47], v[112:127]
    ds_read_b64_tr_b16 v[24:25], v5 offset:14336
    ds_read_b64_tr_b16 v[26:27], v5 offset:15360
    ds_read_b64_tr_b16 v[28:29], v8 offset:14336
    ds_read_b64_tr_b16 v[30:31], v8 offset:15360
    s_add_u32 s74, s77, 17408
    buffer_load_dwordx4 v[172:175], v2, s[36:39], s74 offen sc1
    s_waitcnt vmcnt(7)
    s_waitcnt lgkmcnt(4)
    v_mfma_f32_32x32x16_bf16 v[96:111], v[16:19], v[152:155], v[96:111]
    v_mfma_f32_32x32x16_bf16 v[112:127], v[20:23], v[152:155], v[112:127]
    ds_read_b64_tr_b16 v[16:17], v6 offset:0
    ds_read_b64_tr_b16 v[18:19], v6 offset:1024
    ds_read_b64_tr_b16 v[20:21], v9 offset:0
    ds_read_b64_tr_b16 v[22:23], v9 offset:1024
    s_add_u32 s74, s77, 18432
    buffer_load_dwordx4 v[56:59], v2, s[36:39], s74 offen sc1
    s_waitcnt vmcnt(7)
    s_waitcnt lgkmcnt(4)
    v_mfma_f32_32x32x16_bf16 v[96:111], v[24:27], v[156:159], v[96:111]
    v_mfma_f32_32x32x16_bf16 v[112:127], v[28:31], v[156:159], v[112:127]
    ds_read_b64_tr_b16 v[24:25], v6 offset:2048
    ds_read_b64_tr_b16 v[26:27], v6 offset:3072
    ds_read_b64_tr_b16 v[28:29], v9 offset:2048
    ds_read_b64_tr_b16 v[30:31], v9 offset:3072
    s_add_u32 s74, s77, 19456
    buffer_load_dwordx4 v[176:179], v2, s[36:39], s74 offen sc1
    s_waitcnt vmcnt(7)
    s_waitcnt lgkmcnt(4)
    v_mfma_f32_32x32x16_bf16 v[96:111], v[16:19], v[48:51], v[96:111]
    v_mfma_f32_32x32x16_bf16 v[112:127], v[20:23], v[48:51], v[112:127]
    ds_read_b64_tr_b16 v[16:17], v6 offset:4096
    ds_read_b64_tr_b16 v[18:19], v6 offset:5120
    ds_read_b64_tr_b16 v[20:21], v9 offset:4096
    ds_read_b64_tr_b16 v[22:23], v9 offset:5120
    s_add_u32 s74, s77, 20480
    buffer_load_dwordx4 v[180:183], v2, s[36:39], s74 offen sc1
    s_waitcnt vmcnt(7)
    s_waitcnt lgkmcnt(4)
    v_mfma_f32_32x32x16_bf16 v[96:111], v[24:27], v[160:163], v[96:111]
    v_mfma_f32_32x32x16_bf16 v[112:127], v[28:31], v[160:163], v[112:127]
    ds_read_b64_tr_b16 v[24:25], v6 offset:6144
    ds_read_b64_tr_b16 v[26:27], v6 offset:7168
    ds_read_b64_tr_b16 v[28:29], v9 offset:6144
    ds_read_b64_tr_b16 v[30:31], v9 offset:7168
    s_add_u32 s74, s77, 21504
    buffer_load_dwordx4 v[60:63], v2, s[36:39], s74 offen sc1
    s_waitcnt vmcnt(7)
    s_waitcnt lgkmcnt(4)
    v_mfma_f32_32x32x16_bf16 v[96:111], v[16:19], v[164:167], v[96:111]
    v_mfma_f32_32x32x16_bf16 v[112:127], v[20:23], v[164:167], v[112:127]
    ds_read_b64_tr_b16 v[16:17], v6 offset:32768
    ds_read_b64_tr_b16 v[18:19], v6 offset:33792
    ds_read_b64_tr_b16 v[20:21], v9 offset:32768
    ds_read_b64_tr_b16 v[22:23], v9 offset:33792
    s_add_u32 s74, s77, 22528
    buffer_load_dwordx4 v[184:187], v2, s[36:39], s74 offen sc1
    s_waitcnt vmcnt(7)
    s_waitcnt lgkmcnt(4)
    v_mfma_f32_32x32x16_bf16 v[96:111], v[24:27], v[52:55], v[96:111]
    v_mfma_f32_32x32x16_bf16 v[112:127], v[28:31], v[52:55], v[112:127]
    ds_read_b64_tr_b16 v[24:25], v6 offset:34816
    ds_read_b64_tr_b16 v[26:27], v6 offset:35840
    ds_read_b64_tr_b16 v[28:29], v9 offset:34816
    ds_read_b64_tr_b16 v[30:31], v9 offset:35840
    s_add_u32 s74, s77, 23552
    buffer_load_dwordx4 v[188:191], v2, s[36:39], s74 offen sc1
    s_waitcnt vmcnt(7)
    s_waitcnt lgkmcnt(4)
    v_mfma_f32_32x32x16_bf16 v[96:111], v[16:19], v[168:171], v[96:111]
    v_mfma_f32_32x32x16_bf16 v[112:127], v[20:23], v[168:171], v[112:127]
    ds_read_b64_tr_b16 v[16:17], v6 offset:36864
    ds_read_b64_tr_b16 v[18:19], v6 offset:37888
    ds_read_b64_tr_b16 v[20:21], v9 offset:36864
    ds_read_b64_tr_b16 v[22:23], v9 offset:37888
    s_waitcnt vmcnt(6)
    s_waitcnt lgkmcnt(4)
    v_mfma_f32_32x32x16_bf16 v[96:111], v[24:27], v[172:175], v[96:111]
    v_mfma_f32_32x32x16_bf16 v[112:127], v[28:31], v[172:175], v[112:127]
    ds_read_b64_tr_b16 v[24:25], v6 offset:38912
    ds_read_b64_tr_b16 v[26:27], v6 offset:39936
    ds_read_b64_tr_b16 v[28:29], v9 offset:38912
    ds_read_b64_tr_b16 v[30:31], v9 offset:39936
    s_waitcnt vmcnt(5)
    s_waitcnt lgkmcnt(4)
    v_mfma_f32_32x32x16_bf16 v[96:111], v[16:19], v[56:59], v[96:111]
    v_mfma_f32_32x32x16_bf16 v[112:127], v[20:23], v[56:59], v[112:127]
    ds_read_b64_tr_b16 v[16:17], v6 offset:57344
    ds_read_b64_tr_b16 v[18:19], v6 offset:58368
    ds_read_b64_tr_b16 v[20:21], v9 offset:57344
    ds_read_b64_tr_b16 v[22:23], v9 offset:58368
    s_waitcnt vmcnt(4)
    s_waitcnt lgkmcnt(4)
    v_mfma_f32_32x32x16_bf16 v[96:111], v[24:27], v[176:179], v[96:111]
    v_mfma_f32_32x32x16_bf16 v[112:127], v[28:31], v[176:179], v[112:127]
    ds_read_b64_tr_b16 v[24:25], v6 offset:59392
    ds_read_b64_tr_b16 v[26:27], v6 offset:60416
    ds_read_b64_tr_b16 v[28:29], v9 offset:59392
    ds_read_b64_tr_b16 v[30:31], v9 offset:60416
    s_waitcnt vmcnt(3)
    s_waitcnt lgkmcnt(4)
    v_mfma_f32_32x32x16_bf16 v[96:111], v[16:19], v[180:183], v[96:111]
    v_mfma_f32_32x32x16_bf16 v[112:127], v[20:23], v[180:183], v[112:127]
    ds_read_b64_tr_b16 v[16:17], v6 offset:61440
    ds_read_b64_tr_b16 v[18:19], v6 offset:62464
    ds_read_b64_tr_b16 v[20:21], v9 offset:61440
    ds_read_b64_tr_b16 v[22:23], v9 offset:62464
    s_waitcnt vmcnt(2)
    s_waitcnt lgkmcnt(4)
    v_mfma_f32_32x32x16_bf16 v[96:111], v[24:27], v[60:63], v[96:111]
    v_mfma_f32_32x32x16_bf16 v[112:127], v[28:31], v[60:63], v[112:127]
    ds_read_b64_tr_b16 v[24:25], v6 offset:63488
    ds_read_b64_tr_b16 v[26:27], v6 offset:64512
    ds_read_b64_tr_b16 v[28:29], v9 offset:63488
    ds_read_b64_tr_b16 v[30:31], v9 offset:64512
    s_waitcnt vmcnt(1)
    s_waitcnt lgkmcnt(4)
    v_mfma_f32_32x32x16_bf16 v[96:111], v[16:19], v[184:187], v[96:111]
    v_mfma_f32_32x32x16_bf16 v[112:127], v[20:23], v[184:187], v[112:127]
    s_waitcnt vmcnt(0)
    s_waitcnt lgkmcnt(0)
    v_mfma_f32_32x32x16_bf16 v[96:111], v[24:27], v[188:191], v[96:111]
    v_mfma_f32_32x32x16_bf16 v[112:127], v[28:31], v[188:191], v[112:127]
    s_barrier
    s_lshl_b32 s70, s76, 15
    v_add_u32 v8, s70, v2
    v_permlane32_swap_b32 v12, v14
    v_permlane32_swap_b32 v13, v15
    v_lshlrev_b32 v64, 16, v12
    v_and_b32 v65, 0xffff0000, v12
    v_lshlrev_b32 v66, 16, v13
    v_and_b32 v67, 0xffff0000, v13
    v_lshlrev_b32 v68, 16, v14
    v_and_b32 v69, 0xffff0000, v14
    v_lshlrev_b32 v70, 16, v15
    v_and_b32 v71, 0xffff0000, v15
    ds_write_b128 v8, v[104:107] offset:8192
    ds_write_b128 v8, v[108:111] offset:9216
    ds_write_b128 v8, v[112:115] offset:16384
    ds_write_b128 v8, v[116:119] offset:17408
    ds_write_b128 v8, v[120:123] offset:24576
    ds_write_b128 v8, v[124:127] offset:25600
    s_waitcnt lgkmcnt(0)
    s_barrier
    ds_read_b128 v[32:35], v8 offset:2048
    ds_read_b128 v[36:39], v8 offset:3072
    ds_read_b128 v[40:43], v8 offset:4096
    ds_read_b128 v[44:47], v8 offset:5120
    ds_read_b128 v[48:51], v8 offset:6144
    ds_read_b128 v[52:55], v8 offset:7168
    s_waitcnt lgkmcnt(0)
    v_pk_add_f32 v[72:73], v[96:97], v[32:33]
    v_pk_add_f32 v[74:75], v[98:99], v[34:35]
    v_pk_add_f32 v[76:77], v[100:101], v[36:37]
    v_pk_add_f32 v[78:79], v[102:103], v[38:39]
    v_pk_add_f32 v[72:73], v[72:73], v[40:41]
    v_pk_add_f32 v[74:75], v[74:75], v[42:43]
    v_pk_add_f32 v[76:77], v[76:77], v[44:45]
    v_pk_add_f32 v[78:79], v[78:79], v[46:47]
    v_pk_mul_f32 v[80:81], v[72:73], s[78:79]
    v_pk_mul_f32 v[82:83], v[74:75], s[78:79]
    v_pk_mul_f32 v[84:85], v[76:77], s[78:79]
    v_pk_mul_f32 v[86:87], v[78:79], s[78:79]
    v_exp_f32 v80, v80
    v_exp_f32 v81, v81
    v_exp_f32 v82, v82
    v_exp_f32 v83, v83
    v_exp_f32 v84, v84
    v_exp_f32 v85, v85
    v_exp_f32 v86, v86
    v_exp_f32 v87, v87
    v_pk_mul_f32 v[72:73], v[72:73], v[48:49]
    v_pk_mul_f32 v[74:75], v[74:75], v[50:51]
    v_pk_mul_f32 v[76:77], v[76:77], v[52:53]
    v_pk_mul_f32 v[78:79], v[78:79], v[54:55]
    v_pk_add_f32 v[80:81], v[80:81], s[80:81]
    v_pk_add_f32 v[82:83], v[82:83], s[80:81]
    v_pk_add_f32 v[84:85], v[84:85], s[80:81]
    v_pk_add_f32 v[86:87], v[86:87], s[80:81]
    v_rcp_f32 v80, v80
    v_rcp_f32 v81, v81
    v_rcp_f32 v82, v82
    v_rcp_f32 v83, v83
    v_rcp_f32 v84, v84
    v_rcp_f32 v85, v85
    v_rcp_f32 v86, v86
    v_rcp_f32 v87, v87
    v_pk_fma_f32 v[64:65], v[72:73], v[80:81], v[64:65]
    v_pk_fma_f32 v[66:67], v[74:75], v[82:83], v[66:67]
    v_pk_fma_f32 v[68:69], v[76:77], v[84:85], v[68:69]
    v_pk_fma_f32 v[70:71], v[78:79], v[86:87], v[70:71]
    v_cvt_pk_bf16_f32 v88, v64, v65
    v_cvt_pk_bf16_f32 v89, v66, v67
    v_cvt_pk_bf16_f32 v90, v68, v69
    v_cvt_pk_bf16_f32 v91, v70, v71
    s_nop 0
    v_permlane32_swap_b32 v88, v90
    v_permlane32_swap_b32 v89, v91
    buffer_store_dwordx4 v[88:91], v3, s[52:55], 0 offen offset:0
    s_branch L_FIN
L_P2_1:
    ds_read_b64_tr_b16 v[128:129], v5 offset:16384
    ds_read_b64_tr_b16 v[130:131], v5 offset:17408
    ds_read_b64_tr_b16 v[132:133], v8 offset:16384
    ds_read_b64_tr_b16 v[134:135], v8 offset:17408
    ds_read_b64_tr_b16 v[136:137], v5 offset:18432
    ds_read_b64_tr_b16 v[138:139], v5 offset:19456
    ds_read_b64_tr_b16 v[140:141], v8 offset:18432
    ds_read_b64_tr_b16 v[142:143], v8 offset:19456
    ds_read_b64_tr_b16 v[144:145], v5 offset:20480
    ds_read_b64_tr_b16 v[146:147], v5 offset:21504
    ds_read_b64_tr_b16 v[148:149], v8 offset:20480
    ds_read_b64_tr_b16 v[150:151], v8 offset:21504
    ds_read_b64_tr_b16 v[152:153], v5 offset:22528
    ds_read_b64_tr_b16 v[154:155], v5 offset:23552
    ds_read_b64_tr_b16 v[156:157], v8 offset:22528
    ds_read_b64_tr_b16 v[158:159], v8 offset:23552
    ds_read_b64_tr_b16 v[160:161], v5 offset:24576
    ds_read_b64_tr_b16 v[162:163], v5 offset:25600
    ds_read_b64_tr_b16 v[164:165], v8 offset:24576
    ds_read_b64_tr_b16 v[166:167], v8 offset:25600
    ds_read_b64_tr_b16 v[168:169], v5 offset:26624
    ds_read_b64_tr_b16 v[170:171], v5 offset:27648
    ds_read_b64_tr_b16 v[172:173], v8 offset:26624
    ds_read_b64_tr_b16 v[174:175], v8 offset:27648
    ds_read_b64_tr_b16 v[176:177], v5 offset:28672
    ds_read_b64_tr_b16 v[178:179], v5 offset:29696
    ds_read_b64_tr_b16 v[180:181], v8 offset:28672
    ds_read_b64_tr_b16 v[182:183], v8 offset:29696
    ds_read_b64_tr_b16 v[184:185], v5 offset:30720
    ds_read_b64_tr_b16 v[186:187], v5 offset:31744
    ds_read_b64_tr_b16 v[188:189], v8 offset:30720
    ds_read_b64_tr_b16 v[190:191], v8 offset:31744
    s_cmp_eq_u32 s63, 0
    s_cbranch_scc1 L_P2_1h
    s_add_u32 m0, s66, 106496
    s_add_u32 s74, s65, 1548288
    buffer_load_dwordx4 v31, s[44:47], s74 offen lds
    s_add_u32 m0, s66, 114688
    s_add_u32 s74, s65, 301056
    buffer_load_dwordx4 v31, s[48:51], s74 offen lds
    s_add_u32 m0, s66, 122880
    s_add_u32 s74, s65, 351232
    buffer_load_dwordx4 v31, s[48:51], s74 offen lds
    v_mov_b32 v16, 1
    v_mov_b32 v17, 0
    s_mov_b64 exec, 1
    s_waitcnt vmcnt(3)
    buffer_store_dword v16, v17, s[36:39], s72 offen sc1
    s_mov_b64 exec, -1
    s_branch L_P2_1c
L_P2_1h:
    v_mov_b32 v16, 1
    v_mov_b32 v17, 0
    s_mov_b64 exec, 1
    s_waitcnt vmcnt(0)
    buffer_store_dword v16, v17, s[36:39], s72 offen sc1
    s_mov_b64 exec, -1
L_P2_1c:
    buffer_load_dwordx4 v[12:15], v3, s[28:31], 0 offen offset:32
    s_waitcnt lgkmcnt(0)
    s_barrier
    s_cmp_ge_u32 s65, 896
    s_cbranch_scc1 L_FIN
    s_add_u32 m0, s66, 0
    s_add_u32 s74, s65, 57344
    buffer_load_dwordx4 v31, s[44:47], s74 offen lds
    s_add_u32 m0, s66, 8192
    s_add_u32 s74, s65, 114688
    buffer_load_dwordx4 v31, s[44:47], s74 offen lds
    s_add_u32 m0, s66, 16384
    s_add_u32 s74, s65, 630784
    buffer_load_dwordx4 v31, s[44:47], s74 offen lds
    s_add_u32 m0, s66, 24576
    s_add_u32 s74, s65, 688128
    buffer_load_dwordx4 v31, s[44:47], s74 offen lds
    s_add_u32 m0, s66, 32768
    s_add_u32 s74, s65, 1146880
    buffer_load_dwordx4 v31, s[44:47], s74 offen lds
    s_add_u32 m0, s66, 40960
    s_add_u32 s74, s65, 1204224
    buffer_load_dwordx4 v31, s[44:47], s74 offen lds
    s_add_u32 m0, s66, 49152
    s_add_u32 s74, s65, 50176
    buffer_load_dwordx4 v31, s[48:51], s74 offen lds
    s_add_u32 m0, s66, 57344
    s_add_u32 s74, s65, 100352
    buffer_load_dwordx4 v31, s[48:51], s74 offen lds
    s_waitcnt vmcnt(9)
    s_barrier
    ds_read_b64_tr_b16 v[192:193], v6 offset:16384
    ds_read_b64_tr_b16 v[194:195], v6 offset:17408
    ds_read_b64_tr_b16 v[196:197], v9 offset:16384
    ds_read_b64_tr_b16 v[198:199], v9 offset:17408
    ds_read_b64_tr_b16 v[200:201], v6 offset:18432
    ds_read_b64_tr_b16 v[202:203], v6 offset:19456
    ds_read_b64_tr_b16 v[204:205], v9 offset:18432
    ds_read_b64_tr_b16 v[206:207], v9 offset:19456
    ds_read_b64_tr_b16 v[208:209], v6 offset:20480
    ds_read_b64_tr_b16 v[210:211], v6 offset:21504
    ds_read_b64_tr_b16 v[212:213], v9 offset:20480
    ds_read_b64_tr_b16 v[214:215], v9 offset:21504
    ds_read_b64_tr_b16 v[216:217], v6 offset:22528
    ds_read_b64_tr_b16 v[218:219], v6 offset:23552
    ds_read_b64_tr_b16 v[220:221], v9 offset:22528
    ds_read_b64_tr_b16 v[222:223], v9 offset:23552
    ds_read_b64_tr_b16 v[224:225], v6 offset:24576
    ds_read_b64_tr_b16 v[226:227], v6 offset:25600
    ds_read_b64_tr_b16 v[228:229], v9 offset:24576
    ds_read_b64_tr_b16 v[230:231], v9 offset:25600
    ds_read_b64_tr_b16 v[232:233], v6 offset:26624
    ds_read_b64_tr_b16 v[234:235], v6 offset:27648
    ds_read_b64_tr_b16 v[236:237], v9 offset:26624
    ds_read_b64_tr_b16 v[238:239], v9 offset:27648
    ds_read_b64_tr_b16 v[240:241], v6 offset:28672
    ds_read_b64_tr_b16 v[242:243], v6 offset:29696
    ds_read_b64_tr_b16 v[244:245], v9 offset:28672
    ds_read_b64_tr_b16 v[246:247], v9 offset:29696
    ds_read_b64_tr_b16 v[248:249], v6 offset:30720
    ds_read_b64_tr_b16 v[250:251], v6 offset:31744
    ds_read_b64_tr_b16 v[252:253], v9 offset:30720
    ds_read_b64_tr_b16 v[254:255], v9 offset:31744
    s_waitcnt lgkmcnt(0)
    s_barrier
    s_add_u32 m0, s66, 65536
    s_add_u32 s74, s65, 172032
    buffer_load_dwordx4 v31, s[44:47], s74 offen lds
    s_add_u32 m0, s66, 69632
    s_add_u32 s74, s65, 200704
    buffer_load_dwordx4 v31, s[44:47], s74 offen lds
    s_add_u32 m0, s66, 73728
    s_add_u32 s74, s65, 745472
    buffer_load_dwordx4 v31, s[44:47], s74 offen lds
    s_add_u32 m0, s66, 77824
    s_add_u32 s74, s65, 774144
    buffer_load_dwordx4 v31, s[44:47], s74 offen lds
    s_add_u32 m0, s66, 81920
    s_add_u32 s74, s65, 1261568
    buffer_load_dwordx4 v31, s[44:47], s74 offen lds
    s_add_u32 m0, s66, 86016
    s_add_u32 s74, s65, 1290240
    buffer_load_dwordx4 v31, s[44:47], s74 offen lds
    s_add_u32 m0, s66, 90112
    s_add_u32 s74, s65, 150528
    buffer_load_dwordx4 v31, s[48:51], s74 offen lds
    s_add_u32 m0, s66, 94208
    s_add_u32 s74, s65, 179200
    buffer_load_dwordx4 v31, s[48:51], s74 offen lds
    s_add_u32 m0, s66, 98304
    s_add_u32 s74, s65, 229376
    buffer_load_dwordx4 v31, s[44:47], s74 offen lds
    s_add_u32 m0, s66, 102400
    s_add_u32 s74, s65, 258048
    buffer_load_dwordx4 v31, s[44:47], s74 offen lds
    s_add_u32 m0, s66, 106496
    s_add_u32 s74, s65, 802816
    buffer_load_dwordx4 v31, s[44:47], s74 offen lds
    s_add_u32 m0, s66, 110592
    s_add_u32 s74, s65, 831488
    buffer_load_dwordx4 v31, s[44:47], s74 offen lds
    s_add_u32 m0, s66, 114688
    s_add_u32 s74, s65, 1318912
    buffer_load_dwordx4 v31, s[44:47], s74 offen lds
    s_add_u32 m0, s66, 118784
    s_add_u32 s74, s65, 1347584
    buffer_load_dwordx4 v31, s[44:47], s74 offen lds
    s_add_u32 m0, s66, 122880
    s_add_u32 s74, s65, 286720
    buffer_load_dwordx4 v31, s[44:47], s74 offen lds
    s_add_u32 m0, s66, 126976
    s_add_u32 s74, s65, 315392
    buffer_load_dwordx4 v31, s[44:47], s74 offen lds
    s_barrier
    s_add_u32 s74, s77, 61440
    buffer_load_dwordx4 v[32:35], v2, s[36:39], s74 offen sc1
    s_add_u32 s74, s77, 62464
    buffer_load_dwordx4 v[36:39], v2, s[36:39], s74 offen sc1
    s_add_u32 s74, s77, 63488
    buffer_load_dwordx4 v[40:43], v2, s[36:39], s74 offen sc1
    s_add_u32 s74, s77, 64512
    buffer_load_dwordx4 v[44:47], v2, s[36:39], s74 offen sc1
    s_add_u32 s74, s77, 65536
    buffer_load_dwordx4 v[48:51], v2, s[36:39], s74 offen sc1
    s_add_u32 s74, s77, 66560
    buffer_load_dwordx4 v[52:55], v2, s[36:39], s74 offen sc1
    s_add_u32 s74, s77, 67584
    buffer_load_dwordx4 v[56:59], v2, s[36:39], s74 offen sc1
    s_add_u32 s74, s77, 68608
    buffer_load_dwordx4 v[60:63], v2, s[36:39], s74 offen sc1
    s_waitcnt vmcnt(7)
    v_mfma_f32_32x32x16_bf16 v[96:111], v[128:131], v[32:35], 0
    v_mfma_f32_32x32x16_bf16 v[112:127], v[132:135], v[32:35], 0
    s_barrier
    s_add_u32 s74, s77, 69632
    buffer_load_dwordx4 v[64:67], v2, s[36:39], s74 offen sc1
    s_waitcnt vmcnt(7)
    v_mfma_f32_32x32x16_bf16 v[96:111], v[136:139], v[36:39], v[96:111]
    v_mfma_f32_32x32x16_bf16 v[112:127], v[140:143], v[36:39], v[112:127]
    s_add_u32 s74, s77, 70656
    buffer_load_dwordx4 v[68:71], v2, s[36:39], s74 offen sc1
    s_waitcnt vmcnt(7)
    v_mfma_f32_32x32x16_bf16 v[96:111], v[144:147], v[40:43], v[96:111]
    v_mfma_f32_32x32x16_bf16 v[112:127], v[148:151], v[40:43], v[112:127]
    s_add_u32 s74, s77, 71680
    buffer_load_dwordx4 v[72:75], v2, s[36:39], s74 offen sc1
    s_waitcnt vmcnt(7)
    v_mfma_f32_32x32x16_bf16 v[96:111], v[152:155], v[44:47], v[96:111]
    v_mfma_f32_32x32x16_bf16 v[112:127], v[156:159], v[44:47], v[112:127]
    s_add_u32 s74, s77, 72704
    buffer_load_dwordx4 v[76:79], v2, s[36:39], s74 offen sc1
    s_waitcnt vmcnt(7)
    v_mfma_f32_32x32x16_bf16 v[96:111], v[160:163], v[48:51], v[96:111]
    v_mfma_f32_32x32x16_bf16 v[112:127], v[164:167], v[48:51], v[112:127]
    s_add_u32 s74, s77, 73728
    buffer_load_dwordx4 v[80:83], v2, s[36:39], s74 offen sc1
    s_waitcnt vmcnt(7)
    v_mfma_f32_32x32x16_bf16 v[96:111], v[168:171], v[52:55], v[96:111]
    v_mfma_f32_32x32x16_bf16 v[112:127], v[172:175], v[52:55], v[112:127]
    s_add_u32 s74, s77, 74752
    buffer_load_dwordx4 v[84:87], v2, s[36:39], s74 offen sc1
    s_waitcnt vmcnt(7)
    v_mfma_f32_32x32x16_bf16 v[96:111], v[176:179], v[56:59], v[96:111]
    v_mfma_f32_32x32x16_bf16 v[112:127], v[180:183], v[56:59], v[112:127]
    s_add_u32 s74, s77, 75776
    buffer_load_dwordx4 v[88:91], v2, s[36:39], s74 offen sc1
    s_waitcnt vmcnt(7)
    v_mfma_f32_32x32x16_bf16 v[96:111], v[184:187], v[60:63], v[96:111]
    v_mfma_f32_32x32x16_bf16 v[112:127], v[188:191], v[60:63], v[112:127]
    s_add_u32 s74, s77, 76800
    buffer_load_dwordx4 v[92:95], v2, s[36:39], s74 offen sc1
    s_waitcnt vmcnt(7)
    v_mfma_f32_32x32x16_bf16 v[96:111], v[192:195], v[64:67], v[96:111]
    v_mfma_f32_32x32x16_bf16 v[112:127], v[196:199], v[64:67], v[112:127]
    s_add_u32 s74, s77, 40960
    buffer_load_dwordx4 v[32:35], v2, s[36:39], s74 offen sc1
    s_waitcnt vmcnt(7)
    v_mfma_f32_32x32x16_bf16 v[96:111], v[200:203], v[68:71], v[96:111]
    v_mfma_f32_32x32x16_bf16 v[112:127], v[204:207], v[68:71], v[112:127]
    s_add_u32 s74, s77, 41984
    buffer_load_dwordx4 v[128:131], v2, s[36:39], s74 offen sc1
    s_waitcnt vmcnt(7)
    v_mfma_f32_32x32x16_bf16 v[96:111], v[208:211], v[72:75], v[96:111]
    v_mfma_f32_32x32x16_bf16 v[112:127], v[212:215], v[72:75], v[112:127]
    s_add_u32 s74, s77, 43008
    buffer_load_dwordx4 v[132:135], v2, s[36:39], s74 offen sc1
    s_waitcnt vmcnt(7)
    v_mfma_f32_32x32x16_bf16 v[96:111], v[216:219], v[76:79], v[96:111]
    v_mfma_f32_32x32x16_bf16 v[112:127], v[220:223], v[76:79], v[112:127]
    s_add_u32 s74, s77, 44032
    buffer_load_dwordx4 v[36:39], v2, s[36:39], s74 offen sc1
    s_waitcnt vmcnt(7)
    v_mfma_f32_32x32x16_bf16 v[96:111], v[224:227], v[80:83], v[96:111]
    v_mfma_f32_32x32x16_bf16 v[112:127], v[228:231], v[80:83], v[112:127]
    s_add_u32 s74, s77, 45056
    buffer_load_dwordx4 v[136:139], v2, s[36:39], s74 offen sc1
    s_waitcnt vmcnt(7)
    v_mfma_f32_32x32x16_bf16 v[96:111], v[232:235], v[84:87], v[96:111]
    v_mfma_f32_32x32x16_bf16 v[112:127], v[236:239], v[84:87], v[112:127]
    s_add_u32 s74, s77, 46080
    buffer_load_dwordx4 v[140:143], v2, s[36:39], s74 offen sc1
    s_waitcnt vmcnt(7)
    v_mfma_f32_32x32x16_bf16 v[96:111], v[240:243], v[88:91], v[96:111]
    v_mfma_f32_32x32x16_bf16 v[112:127], v[244:247], v[88:91], v[112:127]
    ds_read_b64_tr_b16 v[16:17], v7 offset:8192
    ds_read_b64_tr_b16 v[18:19], v7 offset:9216
    ds_read_b64_tr_b16 v[20:21], v10 offset:8192
    ds_read_b64_tr_b16 v[22:23], v10 offset:9216
    s_add_u32 s74, s77, 47104
    buffer_load_dwordx4 v[40:43], v2, s[36:39], s74 offen sc1
    s_waitcnt vmcnt(7)
    v_mfma_f32_32x32x16_bf16 v[96:111], v[248:251], v[92:95], v[96:111]
    v_mfma_f32_32x32x16_bf16 v[112:127], v[252:255], v[92:95], v[112:127]
    ds_read_b64_tr_b16 v[24:25], v7 offset:10240
    ds_read_b64_tr_b16 v[26:27], v7 offset:11264
    ds_read_b64_tr_b16 v[28:29], v10 offset:10240
    ds_read_b64_tr_b16 v[30:31], v10 offset:11264
    s_add_u32 s74, s77, 48128
    buffer_load_dwordx4 v[144:147], v2, s[36:39], s74 offen sc1
    s_waitcnt vmcnt(7)
    s_waitcnt lgkmcnt(4)
    v_mfma_f32_32x32x16_bf16 v[96:111], v[16:19], v[32:35], v[96:111]
    v_mfma_f32_32x32x16_bf16 v[112:127], v[20:23], v[32:35], v[112:127]
    ds_read_b64_tr_b16 v[16:17], v7 offset:12288
    ds_read_b64_tr_b16 v[18:19], v7 offset:13312
    ds_read_b64_tr_b16 v[20:21], v10 offset:12288
    ds_read_b64_tr_b16 v[22:23], v10 offset:13312
    s_add_u32 s74, s77, 49152
    buffer_load_dwordx4 v[148:151], v2, s[36:39], s74 offen sc1
    s_waitcnt vmcnt(7)
    s_waitcnt lgkmcnt(4)
    v_mfma_f32_32x32x16_bf16 v[96:111], v[24:27], v[128:131], v[96:111]
    v_mfma_f32_32x32x16_bf16 v[112:127], v[28:31], v[128:131], v[112:127]
    ds_read_b64_tr_b16 v[24:25], v7 offset:14336
    ds_read_b64_tr_b16 v[26:27], v7 offset:15360
    ds_read_b64_tr_b16 v[28:29], v10 offset:14336
    ds_read_b64_tr_b16 v[30:31], v10 offset:15360
    s_add_u32 s74, s77, 50176
    buffer_load_dwordx4 v[44:47], v2, s[36:39], s74 offen sc1
    s_waitcnt vmcnt(7)
    s_waitcnt lgkmcnt(4)
    v_mfma_f32_32x32x16_bf16 v[96:111], v[16:19], v[132:135], v[96:111]
    v_mfma_f32_32x32x16_bf16 v[112:127], v[20:23], v[132:135], v[112:127]
    ds_read_b64_tr_b16 v[16:17], v5 offset:16384
    ds_read_b64_tr_b16 v[18:19], v5 offset:17408
    ds_read_b64_tr_b16 v[20:21], v8 offset:16384
    ds_read_b64_tr_b16 v[22:23], v8 offset:17408
    s_add_u32 s74, s77, 51200
    buffer_load_dwordx4 v[152:155], v2, s[36:39], s74 offen sc1
    s_waitcnt vmcnt(7)
    s_waitcnt lgkmcnt(4)
    v_mfma_f32_32x32x16_bf16 v[96:111], v[24:27], v[36:39], v[96:111]
    v_mfma_f32_32x32x16_bf16 v[112:127], v[28:31], v[36:39], v[112:127]
    ds_read_b64_tr_b16 v[24:25], v5 offset:18432
    ds_read_b64_tr_b16 v[26:27], v5 offset:19456
    ds_read_b64_tr_b16 v[28:29], v8 offset:18432
    ds_read_b64_tr_b16 v[30:31], v8 offset:19456
    s_add_u32 s74, s77, 52224
    buffer_load_dwordx4 v[156:159], v2, s[36:39], s74 offen sc1
    s_waitcnt vmcnt(7)
    s_waitcnt lgkmcnt(4)
    v_mfma_f32_32x32x16_bf16 v[96:111], v[16:19], v[136:139], v[96:111]
    v_mfma_f32_32x32x16_bf16 v[112:127], v[20:23], v[136:139], v[112:127]
    ds_read_b64_tr_b16 v[16:17], v5 offset:20480
    ds_read_b64_tr_b16 v[18:19], v5 offset:21504
    ds_read_b64_tr_b16 v[20:21], v8 offset:20480
    ds_read_b64_tr_b16 v[22:23], v8 offset:21504
    s_add_u32 s74, s77, 53248
    buffer_load_dwordx4 v[48:51], v2, s[36:39], s74 offen sc1
    s_waitcnt vmcnt(7)
    s_waitcnt lgkmcnt(4)
    v_mfma_f32_32x32x16_bf16 v[96:111], v[24:27], v[140:143], v[96:111]
    v_mfma_f32_32x32x16_bf16 v[112:127], v[28:31], v[140:143], v[112:127]
    ds_read_b64_tr_b16 v[24:25], v5 offset:22528
    ds_read_b64_tr_b16 v[26:27], v5 offset:23552
    ds_read_b64_tr_b16 v[28:29], v8 offset:22528
    ds_read_b64_tr_b16 v[30:31], v8 offset:23552
    s_add_u32 s74, s77, 54272
    buffer_load_dwordx4 v[160:163], v2, s[36:39], s74 offen sc1
    s_waitcnt vmcnt(7)
    s_waitcnt lgkmcnt(4)
    v_mfma_f32_32x32x16_bf16 v[96:111], v[16:19], v[40:43], v[96:111]
    v_mfma_f32_32x32x16_bf16 v[112:127], v[20:23], v[40:43], v[112:127]
    ds_read_b64_tr_b16 v[16:17], v5 offset:24576
    ds_read_b64_tr_b16 v[18:19], v5 offset:25600
    ds_read_b64_tr_b16 v[20:21], v8 offset:24576
    ds_read_b64_tr_b16 v[22:23], v8 offset:25600
    s_add_u32 s74, s77, 55296
    buffer_load_dwordx4 v[164:167], v2, s[36:39], s74 offen sc1
    s_waitcnt vmcnt(7)
    s_waitcnt lgkmcnt(4)
    v_mfma_f32_32x32x16_bf16 v[96:111], v[24:27], v[144:147], v[96:111]
    v_mfma_f32_32x32x16_bf16 v[112:127], v[28:31], v[144:147], v[112:127]
    ds_read_b64_tr_b16 v[24:25], v5 offset:26624
    ds_read_b64_tr_b16 v[26:27], v5 offset:27648
    ds_read_b64_tr_b16 v[28:29], v8 offset:26624
    ds_read_b64_tr_b16 v[30:31], v8 offset:27648
    s_add_u32 s74, s77, 56320
    buffer_load_dwordx4 v[52:55], v2, s[36:39], s74 offen sc1
    s_waitcnt vmcnt(7)
    s_waitcnt lgkmcnt(4)
    v_mfma_f32_32x32x16_bf16 v[96:111], v[16:19], v[148:151], v[96:111]
    v_mfma_f32_32x32x16_bf16 v[112:127], v[20:23], v[148:151], v[112:127]
    ds_read_b64_tr_b16 v[16:17], v5 offset:28672
    ds_read_b64_tr_b16 v[18:19], v5 offset:29696
    ds_read_b64_tr_b16 v[20:21], v8 offset:28672
    ds_read_b64_tr_b16 v[22:23], v8 offset:29696
    s_add_u32 s74, s77, 57344
    buffer_load_dwordx4 v[168:171], v2, s[36:39], s74 offen sc1
    s_waitcnt vmcnt(7)
    s_waitcnt lgkmcnt(4)
    v_mfma_f32_32x32x16_bf16 v[96:111], v[24:27], v[44:47], v[96:111]
    v_mfma_f32_32x32x16_bf16 v[112:127], v[28:31], v[44:47], v[112:127]
    ds_read_b64_tr_b16 v[24:25], v5 offset:30720
    ds_read_b64_tr_b16 v[26:27], v5 offset:31744
    ds_read_b64_tr_b16 v[28:29], v8 offset:30720
    ds_read_b64_tr_b16 v[30:31], v8 offset:31744
    s_add_u32 s74, s77, 58368
    buffer_load_dwordx4 v[172:175], v2, s[36:39], s74 offen sc1
    s_waitcnt vmcnt(7)
    s_waitcnt lgkmcnt(4)
    v_mfma_f32_32x32x16_bf16 v[96:111], v[16:19], v[152:155], v[96:111]
    v_mfma_f32_32x32x16_bf16 v[112:127], v[20:23], v[152:155], v[112:127]
    ds_read_b64_tr_b16 v[16:17], v6 offset:8192
    ds_read_b64_tr_b16 v[18:19], v6 offset:9216
    ds_read_b64_tr_b16 v[20:21], v9 offset:8192
    ds_read_b64_tr_b16 v[22:23], v9 offset:9216
    s_add_u32 s74, s77, 59392
    buffer_load_dwordx4 v[56:59], v2, s[36:39], s74 offen sc1
    s_waitcnt vmcnt(7)
    s_waitcnt lgkmcnt(4)
    v_mfma_f32_32x32x16_bf16 v[96:111], v[24:27], v[156:159], v[96:111]
    v_mfma_f32_32x32x16_bf16 v[112:127], v[28:31], v[156:159], v[112:127]
    ds_read_b64_tr_b16 v[24:25], v6 offset:10240
    ds_read_b64_tr_b16 v[26:27], v6 offset:11264
    ds_read_b64_tr_b16 v[28:29], v9 offset:10240
    ds_read_b64_tr_b16 v[30:31], v9 offset:11264
    s_add_u32 s74, s77, 60416
    buffer_load_dwordx4 v[176:179], v2, s[36:39], s74 offen sc1
    s_waitcnt vmcnt(7)
    s_waitcnt lgkmcnt(4)
    v_mfma_f32_32x32x16_bf16 v[96:111], v[16:19], v[48:51], v[96:111]
    v_mfma_f32_32x32x16_bf16 v[112:127], v[20:23], v[48:51], v[112:127]
    ds_read_b64_tr_b16 v[16:17], v6 offset:12288
    ds_read_b64_tr_b16 v[18:19], v6 offset:13312
    ds_read_b64_tr_b16 v[20:21], v9 offset:12288
    ds_read_b64_tr_b16 v[22:23], v9 offset:13312
    s_waitcnt vmcnt(6)
    s_waitcnt lgkmcnt(4)
    v_mfma_f32_32x32x16_bf16 v[96:111], v[24:27], v[160:163], v[96:111]
    v_mfma_f32_32x32x16_bf16 v[112:127], v[28:31], v[160:163], v[112:127]
    ds_read_b64_tr_b16 v[24:25], v6 offset:14336
    ds_read_b64_tr_b16 v[26:27], v6 offset:15360
    ds_read_b64_tr_b16 v[28:29], v9 offset:14336
    ds_read_b64_tr_b16 v[30:31], v9 offset:15360
    s_waitcnt vmcnt(5)
    s_waitcnt lgkmcnt(4)
    v_mfma_f32_32x32x16_bf16 v[96:111], v[16:19], v[164:167], v[96:111]
    v_mfma_f32_32x32x16_bf16 v[112:127], v[20:23], v[164:167], v[112:127]
    ds_read_b64_tr_b16 v[16:17], v6 offset:40960
    ds_read_b64_tr_b16 v[18:19], v6 offset:41984
    ds_read_b64_tr_b16 v[20:21], v9 offset:40960
    ds_read_b64_tr_b16 v[22:23], v9 offset:41984
    s_waitcnt vmcnt(4)
    s_waitcnt lgkmcnt(4)
    v_mfma_f32_32x32x16_bf16 v[96:111], v[24:27], v[52:55], v[96:111]
    v_mfma_f32_32x32x16_bf16 v[112:127], v[28:31], v[52:55], v[112:127]
    ds_read_b64_tr_b16 v[24:25], v6 offset:43008
    ds_read_b64_tr_b16 v[26:27], v6 offset:44032
    ds_read_b64_tr_b16 v[28:29], v9 offset:43008
    ds_read_b64_tr_b16 v[30:31], v9 offset:44032
    s_waitcnt vmcnt(3)
    s_waitcnt lgkmcnt(4)
    v_mfma_f32_32x32x16_bf16 v[96:111], v[16:19], v[168:171], v[96:111]
    v_mfma_f32_32x32x16_bf16 v[112:127], v[20:23], v[168:171], v[112:127]
    ds_read_b64_tr_b16 v[16:17], v6 offset:45056
    ds_read_b64_tr_b16 v[18:19], v6 offset:46080
    ds_read_b64_tr_b16 v[20:21], v9 offset:45056
    ds_read_b64_tr_b16 v[22:23], v9 offset:46080
    s_waitcnt vmcnt(2)
    s_waitcnt lgkmcnt(4)
    v_mfma_f32_32x32x16_bf16 v[96:111], v[24:27], v[172:175], v[96:111]
    v_mfma_f32_32x32x16_bf16 v[112:127], v[28:31], v[172:175], v[112:127]
    ds_read_b64_tr_b16 v[24:25], v6 offset:47104
    ds_read_b64_tr_b16 v[26:27], v6 offset:48128
    ds_read_b64_tr_b16 v[28:29], v9 offset:47104
    ds_read_b64_tr_b16 v[30:31], v9 offset:48128
    s_waitcnt vmcnt(1)
    s_waitcnt lgkmcnt(4)
    v_mfma_f32_32x32x16_bf16 v[96:111], v[16:19], v[56:59], v[96:111]
    v_mfma_f32_32x32x16_bf16 v[112:127], v[20:23], v[56:59], v[112:127]
    s_waitcnt vmcnt(0)
    s_waitcnt lgkmcnt(0)
    v_mfma_f32_32x32x16_bf16 v[96:111], v[24:27], v[176:179], v[96:111]
    v_mfma_f32_32x32x16_bf16 v[112:127], v[28:31], v[176:179], v[112:127]
    s_barrier
    s_lshl_b32 s70, s76, 15
    v_add_u32 v8, s70, v2
    v_permlane32_swap_b32 v12, v14
    v_permlane32_swap_b32 v13, v15
    v_lshlrev_b32 v64, 16, v12
    v_and_b32 v65, 0xffff0000, v12
    v_lshlrev_b32 v66, 16, v13
    v_and_b32 v67, 0xffff0000, v13
    v_lshlrev_b32 v68, 16, v14
    v_and_b32 v69, 0xffff0000, v14
    v_lshlrev_b32 v70, 16, v15
    v_and_b32 v71, 0xffff0000, v15
    ds_write_b128 v8, v[96:99] offset:2048
    ds_write_b128 v8, v[100:103] offset:3072
    ds_write_b128 v8, v[112:115] offset:18432
    ds_write_b128 v8, v[116:119] offset:19456
    ds_write_b128 v8, v[120:123] offset:26624
    ds_write_b128 v8, v[124:127] offset:27648
    s_waitcnt lgkmcnt(0)
    s_barrier
    ds_read_b128 v[32:35], v8 offset:8192
    ds_read_b128 v[36:39], v8 offset:9216
    ds_read_b128 v[40:43], v8 offset:12288
    ds_read_b128 v[44:47], v8 offset:13312
    ds_read_b128 v[48:51], v8 offset:14336
    ds_read_b128 v[52:55], v8 offset:15360
    s_waitcnt lgkmcnt(0)
    v_pk_add_f32 v[72:73], v[32:33], v[104:105]
    v_pk_add_f32 v[74:75], v[34:35], v[106:107]
    v_pk_add_f32 v[76:77], v[36:37], v[108:109]
    v_pk_add_f32 v[78:79], v[38:39], v[110:111]
    v_pk_add_f32 v[72:73], v[72:73], v[40:41]
    v_pk_add_f32 v[74:75], v[74:75], v[42:43]
    v_pk_add_f32 v[76:77], v[76:77], v[44:45]
    v_pk_add_f32 v[78:79], v[78:79], v[46:47]
    v_pk_mul_f32 v[80:81], v[72:73], s[78:79]
    v_pk_mul_f32 v[82:83], v[74:75], s[78:79]
    v_pk_mul_f32 v[84:85], v[76:77], s[78:79]
    v_pk_mul_f32 v[86:87], v[78:79], s[78:79]
    v_exp_f32 v80, v80
    v_exp_f32 v81, v81
    v_exp_f32 v82, v82
    v_exp_f32 v83, v83
    v_exp_f32 v84, v84
    v_exp_f32 v85, v85
    v_exp_f32 v86, v86
    v_exp_f32 v87, v87
    v_pk_mul_f32 v[72:73], v[72:73], v[48:49]
    v_pk_mul_f32 v[74:75], v[74:75], v[50:51]
    v_pk_mul_f32 v[76:77], v[76:77], v[52:53]
    v_pk_mul_f32 v[78:79], v[78:79], v[54:55]
    v_pk_add_f32 v[80:81], v[80:81], s[80:81]
    v_pk_add_f32 v[82:83], v[82:83], s[80:81]
    v_pk_add_f32 v[84:85], v[84:85], s[80:81]
    v_pk_add_f32 v[86:87], v[86:87], s[80:81]
    v_rcp_f32 v80, v80
    v_rcp_f32 v81, v81
    v_rcp_f32 v82, v82
    v_rcp_f32 v83, v83
    v_rcp_f32 v84, v84
    v_rcp_f32 v85, v85
    v_rcp_f32 v86, v86
    v_rcp_f32 v87, v87
    v_pk_fma_f32 v[64:65], v[72:73], v[80:81], v[64:65]
    v_pk_fma_f32 v[66:67], v[74:75], v[82:83], v[66:67]
    v_pk_fma_f32 v[68:69], v[76:77], v[84:85], v[68:69]
    v_pk_fma_f32 v[70:71], v[78:79], v[86:87], v[70:71]
    v_cvt_pk_bf16_f32 v88, v64, v65
    v_cvt_pk_bf16_f32 v89, v66, v67
    v_cvt_pk_bf16_f32 v90, v68, v69
    v_cvt_pk_bf16_f32 v91, v70, v71
    s_nop 0
    v_permlane32_swap_b32 v88, v90
    v_permlane32_swap_b32 v89, v91
    buffer_store_dwordx4 v[88:91], v3, s[52:55], 0 offen offset:32
    s_branch L_FIN
L_P2_2:
    ds_read_b64_tr_b16 v[128:129], v5 offset:32768
    ds_read_b64_tr_b16 v[130:131], v5 offset:33792
    ds_read_b64_tr_b16 v[132:133], v8 offset:32768
    ds_read_b64_tr_b16 v[134:135], v8 offset:33792
    ds_read_b64_tr_b16 v[136:137], v5 offset:34816
    ds_read_b64_tr_b16 v[138:139], v5 offset:35840
    ds_read_b64_tr_b16 v[140:141], v8 offset:34816
    ds_read_b64_tr_b16 v[142:143], v8 offset:35840
    ds_read_b64_tr_b16 v[144:145], v5 offset:36864
    ds_read_b64_tr_b16 v[146:147], v5 offset:37888
    ds_read_b64_tr_b16 v[148:149], v8 offset:36864
    ds_read_b64_tr_b16 v[150:151], v8 offset:37888
    ds_read_b64_tr_b16 v[152:153], v5 offset:38912
    ds_read_b64_tr_b16 v[154:155], v5 offset:39936
    ds_read_b64_tr_b16 v[156:157], v8 offset:38912
    ds_read_b64_tr_b16 v[158:159], v8 offset:39936
    ds_read_b64_tr_b16 v[160:161], v5 offset:40960
    ds_read_b64_tr_b16 v[162:163], v5 offset:41984
    ds_read_b64_tr_b16 v[164:165], v8 offset:40960
    ds_read_b64_tr_b16 v[166:167], v8 offset:41984
    ds_read_b64_tr_b16 v[168:169], v5 offset:43008
    ds_read_b64_tr_b16 v[170:171], v5 offset:44032
    ds_read_b64_tr_b16 v[172:173], v8 offset:43008
    ds_read_b64_tr_b16 v[174:175], v8 offset:44032
    ds_read_b64_tr_b16 v[176:177], v5 offset:45056
    ds_read_b64_tr_b16 v[178:179], v5 offset:46080
    ds_read_b64_tr_b16 v[180:181], v8 offset:45056
    ds_read_b64_tr_b16 v[182:183], v8 offset:46080
    ds_read_b64_tr_b16 v[184:185], v5 offset:47104
    ds_read_b64_tr_b16 v[186:187], v5 offset:48128
    ds_read_b64_tr_b16 v[188:189], v8 offset:47104
    ds_read_b64_tr_b16 v[190:191], v8 offset:48128
    s_cmp_eq_u32 s63, 0
    s_cbranch_scc1 L_P2_2h
    s_add_u32 m0, s66, 110592
    s_add_u32 s74, s65, 1576960
    buffer_load_dwordx4 v31, s[44:47], s74 offen lds
    s_add_u32 m0, s66, 118784
    s_add_u32 s74, s65, 329728
    buffer_load_dwordx4 v31, s[48:51], s74 offen lds
    s_add_u32 m0, s66, 126976
    s_add_u32 s74, s65, 379904
    buffer_load_dwordx4 v31, s[48:51], s74 offen lds
    v_mov_b32 v16, 1
    v_mov_b32 v17, 0
    s_mov_b64 exec, 1
    s_waitcnt vmcnt(3)
    buffer_store_dword v16, v17, s[36:39], s72 offen sc1
    s_mov_b64 exec, -1
    s_branch L_P2_2c
L_P2_2h:
L_P2_2c:
    buffer_load_dwordx4 v[12:15], v3, s[28:31], 0 offen offset:64
    s_waitcnt lgkmcnt(0)
    s_barrier
    s_cmp_ge_u32 s65, 896
    s_cbranch_scc1 L_FIN
    s_add_u32 m0, s66, 4096
    s_add_u32 s74, s65, 86016
    buffer_load_dwordx4 v31, s[44:47], s74 offen lds
    s_add_u32 m0, s66, 12288
    s_add_u32 s74, s65, 143360
    buffer_load_dwordx4 v31, s[44:47], s74 offen lds
    s_add_u32 m0, s66, 20480
    s_add_u32 s74, s65, 659456
    buffer_load_dwordx4 v31, s[44:47], s74 offen lds
    s_add_u32 m0, s66, 28672
    s_add_u32 s74, s65, 716800
    buffer_load_dwordx4 v31, s[44:47], s74 offen lds
    s_add_u32 m0, s66, 36864
    s_add_u32 s74, s65, 1175552
    buffer_load_dwordx4 v31, s[44:47], s74 offen lds
    s_add_u32 m0, s66, 45056
    s_add_u32 s74, s65, 1232896
    buffer_load_dwordx4 v31, s[44:47], s74 offen lds
    s_add_u32 m0, s66, 53248
    s_add_u32 s74, s65, 78848
    buffer_load_dwordx4 v31, s[48:51], s74 offen lds
    s_add_u32 m0, s66, 61440
    s_add_u32 s74, s65, 129024
    buffer_load_dwordx4 v31, s[48:51], s74 offen lds
    s_waitcnt vmcnt(9)
    s_barrier
    ds_read_b64_tr_b16 v[192:193], v6 offset:32768
    ds_read_b64_tr_b16 v[194:195], v6 offset:33792
    ds_read_b64_tr_b16 v[196:197], v9 offset:32768
    ds_read_b64_tr_b16 v[198:199], v9 offset:33792
    ds_read_b64_tr_b16 v[200:201], v6 offset:34816
    ds_read_b64_tr_b16 v[202:203], v6 offset:35840
    ds_read_b64_tr_b16 v[204:205], v9 offset:34816
    ds_read_b64_tr_b16 v[206:207], v9 offset:35840
    ds_read_b64_tr_b16 v[208:209], v6 offset:36864
    ds_read_b64_tr_b16 v[210:211], v6 offset:37888
    ds_read_b64_tr_b16 v[212:213], v9 offset:36864
    ds_read_b64_tr_b16 v[214:215], v9 offset:37888
    ds_read_b64_tr_b16 v[216:217], v6 offset:38912
    ds_read_b64_tr_b16 v[218:219], v6 offset:39936
    ds_read_b64_tr_b16 v[220:221], v9 offset:38912
    ds_read_b64_tr_b16 v[222:223], v9 offset:39936
    ds_read_b64_tr_b16 v[224:225], v6 offset:40960
    ds_read_b64_tr_b16 v[226:227], v6 offset:41984
    ds_read_b64_tr_b16 v[228:229], v9 offset:40960
    ds_read_b64_tr_b16 v[230:231], v9 offset:41984
    ds_read_b64_tr_b16 v[232:233], v6 offset:43008
    ds_read_b64_tr_b16 v[234:235], v6 offset:44032
    ds_read_b64_tr_b16 v[236:237], v9 offset:43008
    ds_read_b64_tr_b16 v[238:239], v9 offset:44032
    ds_read_b64_tr_b16 v[240:241], v6 offset:45056
    ds_read_b64_tr_b16 v[242:243], v6 offset:46080
    ds_read_b64_tr_b16 v[244:245], v9 offset:45056
    ds_read_b64_tr_b16 v[246:247], v9 offset:46080
    ds_read_b64_tr_b16 v[248:249], v6 offset:47104
    ds_read_b64_tr_b16 v[250:251], v6 offset:48128
    ds_read_b64_tr_b16 v[252:253], v9 offset:47104
    ds_read_b64_tr_b16 v[254:255], v9 offset:48128
    s_waitcnt lgkmcnt(0)
    s_barrier
    s_waitcnt vmcnt(0)
    s_barrier
    s_barrier
    s_add_u32 s74, s77, 98304
    buffer_load_dwordx4 v[32:35], v2, s[36:39], s74 offen sc1
    s_add_u32 s74, s77, 99328
    buffer_load_dwordx4 v[36:39], v2, s[36:39], s74 offen sc1
    s_add_u32 s74, s77, 100352
    buffer_load_dwordx4 v[40:43], v2, s[36:39], s74 offen sc1
    s_add_u32 s74, s77, 101376
    buffer_load_dwordx4 v[44:47], v2, s[36:39], s74 offen sc1
    s_add_u32 s74, s77, 102400
    buffer_load_dwordx4 v[48:51], v2, s[36:39], s74 offen sc1
    s_add_u32 s74, s77, 103424
    buffer_load_dwordx4 v[52:55], v2, s[36:39], s74 offen sc1
    s_add_u32 s74, s77, 104448
    buffer_load_dwordx4 v[56:59], v2, s[36:39], s74 offen sc1
    s_add_u32 s74, s77, 105472
    buffer_load_dwordx4 v[60:63], v2, s[36:39], s74 offen sc1
    s_waitcnt vmcnt(7)
    v_mfma_f32_32x32x16_bf16 v[96:111], v[128:131], v[32:35], 0
    v_mfma_f32_32x32x16_bf16 v[112:127], v[132:135], v[32:35], 0
    s_add_u32 s74, s77, 106496
    buffer_load_dwordx4 v[64:67], v2, s[36:39], s74 offen sc1
    s_waitcnt vmcnt(7)
    v_mfma_f32_32x32x16_bf16 v[96:111], v[136:139], v[36:39], v[96:111]
    v_mfma_f32_32x32x16_bf16 v[112:127], v[140:143], v[36:39], v[112:127]
    s_add_u32 s74, s77, 107520
    buffer_load_dwordx4 v[68:71], v2, s[36:39], s74 offen sc1
    s_waitcnt vmcnt(7)
    v_mfma_f32_32x32x16_bf16 v[96:111], v[144:147], v[40:43], v[96:111]
    v_mfma_f32_32x32x16_bf16 v[112:127], v[148:151], v[40:43], v[112:127]
    s_add_u32 s74, s77, 108544
    buffer_load_dwordx4 v[72:75], v2, s[36:39], s74 offen sc1
    s_waitcnt vmcnt(7)
    v_mfma_f32_32x32x16_bf16 v[96:111], v[152:155], v[44:47], v[96:111]
    v_mfma_f32_32x32x16_bf16 v[112:127], v[156:159], v[44:47], v[112:127]
    s_add_u32 s74, s77, 109568
    buffer_load_dwordx4 v[76:79], v2, s[36:39], s74 offen sc1
    s_waitcnt vmcnt(7)
    v_mfma_f32_32x32x16_bf16 v[96:111], v[160:163], v[48:51], v[96:111]
    v_mfma_f32_32x32x16_bf16 v[112:127], v[164:167], v[48:51], v[112:127]
    s_add_u32 s74, s77, 110592
    buffer_load_dwordx4 v[80:83], v2, s[36:39], s74 offen sc1
    s_waitcnt vmcnt(7)
    v_mfma_f32_32x32x16_bf16 v[96:111], v[168:171], v[52:55], v[96:111]
    v_mfma_f32_32x32x16_bf16 v[112:127], v[172:175], v[52:55], v[112:127]
    s_add_u32 s74, s77, 111616
    buffer_load_dwordx4 v[84:87], v2, s[36:39], s74 offen sc1
    s_waitcnt vmcnt(7)
    v_mfma_f32_32x32x16_bf16 v[96:111], v[176:179], v[56:59], v[96:111]
    v_mfma_f32_32x32x16_bf16 v[112:127], v[180:183], v[56:59], v[112:127]
    s_add_u32 s74, s77, 112640
    buffer_load_dwordx4 v[88:91], v2, s[36:39], s74 offen sc1
    s_waitcnt vmcnt(7)
    v_mfma_f32_32x32x16_bf16 v[96:111], v[184:187], v[60:63], v[96:111]
    v_mfma_f32_32x32x16_bf16 v[112:127], v[188:191], v[60:63], v[112:127]
    s_add_u32 s74, s77, 113664
    buffer_load_dwordx4 v[92:95], v2, s[36:39], s74 offen sc1
    s_waitcnt vmcnt(7)
    v_mfma_f32_32x32x16_bf16 v[96:111], v[192:195], v[64:67], v[96:111]
    v_mfma_f32_32x32x16_bf16 v[112:127], v[196:199], v[64:67], v[112:127]
    s_add_u32 s74, s77, 77824
    buffer_load_dwordx4 v[32:35], v2, s[36:39], s74 offen sc1
    s_waitcnt vmcnt(7)
    v_mfma_f32_32x32x16_bf16 v[96:111], v[200:203], v[68:71], v[96:111]
    v_mfma_f32_32x32x16_bf16 v[112:127], v[204:207], v[68:71], v[112:127]
    s_add_u32 s74, s77, 78848
    buffer_load_dwordx4 v[128:131], v2, s[36:39], s74 offen sc1
    s_waitcnt vmcnt(7)
    v_mfma_f32_32x32x16_bf16 v[96:111], v[208:211], v[72:75], v[96:111]
    v_mfma_f32_32x32x16_bf16 v[112:127], v[212:215], v[72:75], v[112:127]
    s_add_u32 s74, s77, 79872
    buffer_load_dwordx4 v[132:135], v2, s[36:39], s74 offen sc1
    s_waitcnt vmcnt(7)
    v_mfma_f32_32x32x16_bf16 v[96:111], v[216:219], v[76:79], v[96:111]
    v_mfma_f32_32x32x16_bf16 v[112:127], v[220:223], v[76:79], v[112:127]
    s_add_u32 s74, s77, 80896
    buffer_load_dwordx4 v[36:39], v2, s[36:39], s74 offen sc1
    s_waitcnt vmcnt(7)
    v_mfma_f32_32x32x16_bf16 v[96:111], v[224:227], v[80:83], v[96:111]
    v_mfma_f32_32x32x16_bf16 v[112:127], v[228:231], v[80:83], v[112:127]
    s_add_u32 s74, s77, 81920
    buffer_load_dwordx4 v[136:139], v2, s[36:39], s74 offen sc1
    s_waitcnt vmcnt(7)
    v_mfma_f32_32x32x16_bf16 v[96:111], v[232:235], v[84:87], v[96:111]
    v_mfma_f32_32x32x16_bf16 v[112:127], v[236:239], v[84:87], v[112:127]
    s_add_u32 s74, s77, 82944
    buffer_load_dwordx4 v[140:143], v2, s[36:39], s74 offen sc1
    s_waitcnt vmcnt(7)
    v_mfma_f32_32x32x16_bf16 v[96:111], v[240:243], v[88:91], v[96:111]
    v_mfma_f32_32x32x16_bf16 v[112:127], v[244:247], v[88:91], v[112:127]
    ds_read_b64_tr_b16 v[16:17], v7 offset:16384
    ds_read_b64_tr_b16 v[18:19], v7 offset:17408
    ds_read_b64_tr_b16 v[20:21], v10 offset:16384
    ds_read_b64_tr_b16 v[22:23], v10 offset:17408
    s_add_u32 s74, s77, 83968
    buffer_load_dwordx4 v[40:43], v2, s[36:39], s74 offen sc1
    s_waitcnt vmcnt(7)
    v_mfma_f32_32x32x16_bf16 v[96:111], v[248:251], v[92:95], v[96:111]
    v_mfma_f32_32x32x16_bf16 v[112:127], v[252:255], v[92:95], v[112:127]
    ds_read_b64_tr_b16 v[24:25], v7 offset:18432
    ds_read_b64_tr_b16 v[26:27], v7 offset:19456
    ds_read_b64_tr_b16 v[28:29], v10 offset:18432
    ds_read_b64_tr_b16 v[30:31], v10 offset:19456
    s_add_u32 s74, s77, 84992
    buffer_load_dwordx4 v[144:147], v2, s[36:39], s74 offen sc1
    s_waitcnt vmcnt(7)
    s_waitcnt lgkmcnt(4)
    v_mfma_f32_32x32x16_bf16 v[96:111], v[16:19], v[32:35], v[96:111]
    v_mfma_f32_32x32x16_bf16 v[112:127], v[20:23], v[32:35], v[112:127]
    ds_read_b64_tr_b16 v[16:17], v7 offset:20480
    ds_read_b64_tr_b16 v[18:19], v7 offset:21504
    ds_read_b64_tr_b16 v[20:21], v10 offset:20480
    ds_read_b64_tr_b16 v[22:23], v10 offset:21504
    s_add_u32 s74, s77, 86016
    buffer_load_dwordx4 v[148:151], v2, s[36:39], s74 offen sc1
    s_waitcnt vmcnt(7)
    s_waitcnt lgkmcnt(4)
    v_mfma_f32_32x32x16_bf16 v[96:111], v[24:27], v[128:131], v[96:111]
    v_mfma_f32_32x32x16_bf16 v[112:127], v[28:31], v[128:131], v[112:127]
    ds_read_b64_tr_b16 v[24:25], v7 offset:22528
    ds_read_b64_tr_b16 v[26:27], v7 offset:23552
    ds_read_b64_tr_b16 v[28:29], v10 offset:22528
    ds_read_b64_tr_b16 v[30:31], v10 offset:23552
    s_add_u32 s74, s77, 87040
    buffer_load_dwordx4 v[44:47], v2, s[36:39], s74 offen sc1
    s_waitcnt vmcnt(7)
    s_waitcnt lgkmcnt(4)
    v_mfma_f32_32x32x16_bf16 v[96:111], v[16:19], v[132:135], v[96:111]
    v_mfma_f32_32x32x16_bf16 v[112:127], v[20:23], v[132:135], v[112:127]
    ds_read_b64_tr_b16 v[16:17], v5 offset:32768
    ds_read_b64_tr_b16 v[18:19], v5 offset:33792
    ds_read_b64_tr_b16 v[20:21], v8 offset:32768
    ds_read_b64_tr_b16 v[22:23], v8 offset:33792
    s_add_u32 s74, s77, 88064
    buffer_load_dwordx4 v[152:155], v2, s[36:39], s74 offen sc1
    s_waitcnt vmcnt(7)
    s_waitcnt lgkmcnt(4)
    v_mfma_f32_32x32x16_bf16 v[96:111], v[24:27], v[36:39], v[96:111]
    v_mfma_f32_32x32x16_bf16 v[112:127], v[28:31], v[36:39], v[112:127]
    ds_read_b64_tr_b16 v[24:25], v5 offset:34816
    ds_read_b64_tr_b16 v[26:27], v5 offset:35840
    ds_read_b64_tr_b16 v[28:29], v8 offset:34816
    ds_read_b64_tr_b16 v[30:31], v8 offset:35840
    s_add_u32 s74, s77, 89088
    buffer_load_dwordx4 v[156:159], v2, s[36:39], s74 offen sc1
    s_waitcnt vmcnt(7)
    s_waitcnt lgkmcnt(4)
    v_mfma_f32_32x32x16_bf16 v[96:111], v[16:19], v[136:139], v[96:111]
    v_mfma_f32_32x32x16_bf16 v[112:127], v[20:23], v[136:139], v[112:127]
    ds_read_b64_tr_b16 v[16:17], v5 offset:36864
    ds_read_b64_tr_b16 v[18:19], v5 offset:37888
    ds_read_b64_tr_b16 v[20:21], v8 offset:36864
    ds_read_b64_tr_b16 v[22:23], v8 offset:37888
    s_add_u32 s74, s77, 90112
    buffer_load_dwordx4 v[48:51], v2, s[36:39], s74 offen sc1
    s_waitcnt vmcnt(7)
    s_waitcnt lgkmcnt(4)
    v_mfma_f32_32x32x16_bf16 v[96:111], v[24:27], v[140:143], v[96:111]
    v_mfma_f32_32x32x16_bf16 v[112:127], v[28:31], v[140:143], v[112:127]
    ds_read_b64_tr_b16 v[24:25], v5 offset:38912
    ds_read_b64_tr_b16 v[26:27], v5 offset:39936
    ds_read_b64_tr_b16 v[28:29], v8 offset:38912
    ds_read_b64_tr_b16 v[30:31], v8 offset:39936
    s_add_u32 s74, s77, 91136
    buffer_load_dwordx4 v[160:163], v2, s[36:39], s74 offen sc1
    s_waitcnt vmcnt(7)
    s_waitcnt lgkmcnt(4)
    v_mfma_f32_32x32x16_bf16 v[96:111], v[16:19], v[40:43], v[96:111]
    v_mfma_f32_32x32x16_bf16 v[112:127], v[20:23], v[40:43], v[112:127]
    ds_read_b64_tr_b16 v[16:17], v5 offset:40960
    ds_read_b64_tr_b16 v[18:19], v5 offset:41984
    ds_read_b64_tr_b16 v[20:21], v8 offset:40960
    ds_read_b64_tr_b16 v[22:23], v8 offset:41984
    s_add_u32 s74, s77, 92160
    buffer_load_dwordx4 v[164:167], v2, s[36:39], s74 offen sc1
    s_waitcnt vmcnt(7)
    s_waitcnt lgkmcnt(4)
    v_mfma_f32_32x32x16_bf16 v[96:111], v[24:27], v[144:147], v[96:111]
    v_mfma_f32_32x32x16_bf16 v[112:127], v[28:31], v[144:147], v[112:127]
    ds_read_b64_tr_b16 v[24:25], v5 offset:43008
    ds_read_b64_tr_b16 v[26:27], v5 offset:44032
    ds_read_b64_tr_b16 v[28:29], v8 offset:43008
    ds_read_b64_tr_b16 v[30:31], v8 offset:44032
    s_add_u32 s74, s77, 93184
    buffer_load_dwordx4 v[52:55], v2, s[36:39], s74 offen sc1
    s_waitcnt vmcnt(7)
    s_waitcnt lgkmcnt(4)
    v_mfma_f32_32x32x16_bf16 v[96:111], v[16:19], v[148:151], v[96:111]
    v_mfma_f32_32x32x16_bf16 v[112:127], v[20:23], v[148:151], v[112:127]
    ds_read_b64_tr_b16 v[16:17], v5 offset:45056
    ds_read_b64_tr_b16 v[18:19], v5 offset:46080
    ds_read_b64_tr_b16 v[20:21], v8 offset:45056
    ds_read_b64_tr_b16 v[22:23], v8 offset:46080
    s_add_u32 s74, s77, 94208
    buffer_load_dwordx4 v[168:171], v2, s[36:39], s74 offen sc1
    s_waitcnt vmcnt(7)
    s_waitcnt lgkmcnt(4)
    v_mfma_f32_32x32x16_bf16 v[96:111], v[24:27], v[44:47], v[96:111]
    v_mfma_f32_32x32x16_bf16 v[112:127], v[28:31], v[44:47], v[112:127]
    ds_read_b64_tr_b16 v[24:25], v5 offset:47104
    ds_read_b64_tr_b16 v[26:27], v5 offset:48128
    ds_read_b64_tr_b16 v[28:29], v8 offset:47104
    ds_read_b64_tr_b16 v[30:31], v8 offset:48128
    s_add_u32 s74, s77, 95232
    buffer_load_dwordx4 v[172:175], v2, s[36:39], s74 offen sc1
    s_waitcnt vmcnt(7)
    s_waitcnt lgkmcnt(4)
    v_mfma_f32_32x32x16_bf16 v[96:111], v[16:19], v[152:155], v[96:111]
    v_mfma_f32_32x32x16_bf16 v[112:127], v[20:23], v[152:155], v[112:127]
    ds_read_b64_tr_b16 v[16:17], v6 offset:16384
    ds_read_b64_tr_b16 v[18:19], v6 offset:17408
    ds_read_b64_tr_b16 v[20:21], v9 offset:16384
    ds_read_b64_tr_b16 v[22:23], v9 offset:17408
    s_add_u32 s74, s77, 96256
    buffer_load_dwordx4 v[56:59], v2, s[36:39], s74 offen sc1
    s_waitcnt vmcnt(7)
    s_waitcnt lgkmcnt(4)
    v_mfma_f32_32x32x16_bf16 v[96:111], v[24:27], v[156:159], v[96:111]
    v_mfma_f32_32x32x16_bf16 v[112:127], v[28:31], v[156:159], v[112:127]
    ds_read_b64_tr_b16 v[24:25], v6 offset:18432
    ds_read_b64_tr_b16 v[26:27], v6 offset:19456
    ds_read_b64_tr_b16 v[28:29], v9 offset:18432
    ds_read_b64_tr_b16 v[30:31], v9 offset:19456
    s_add_u32 s74, s77, 97280
    buffer_load_dwordx4 v[176:179], v2, s[36:39], s74 offen sc1
    s_waitcnt vmcnt(7)
    s_waitcnt lgkmcnt(4)
    v_mfma_f32_32x32x16_bf16 v[96:111], v[16:19], v[48:51], v[96:111]
    v_mfma_f32_32x32x16_bf16 v[112:127], v[20:23], v[48:51], v[112:127]
    ds_read_b64_tr_b16 v[16:17], v6 offset:20480
    ds_read_b64_tr_b16 v[18:19], v6 offset:21504
    ds_read_b64_tr_b16 v[20:21], v9 offset:20480
    ds_read_b64_tr_b16 v[22:23], v9 offset:21504
    s_waitcnt vmcnt(6)
    s_waitcnt lgkmcnt(4)
    v_mfma_f32_32x32x16_bf16 v[96:111], v[24:27], v[160:163], v[96:111]
    v_mfma_f32_32x32x16_bf16 v[112:127], v[28:31], v[160:163], v[112:127]
    ds_read_b64_tr_b16 v[24:25], v6 offset:22528
    ds_read_b64_tr_b16 v[26:27], v6 offset:23552
    ds_read_b64_tr_b16 v[28:29], v9 offset:22528
    ds_read_b64_tr_b16 v[30:31], v9 offset:23552
    s_barrier
    s_waitcnt vmcnt(5)
    s_waitcnt lgkmcnt(4)
    v_mfma_f32_32x32x16_bf16 v[96:111], v[16:19], v[164:167], v[96:111]
    v_mfma_f32_32x32x16_bf16 v[112:127], v[20:23], v[164:167], v[112:127]
    ds_read_b64_tr_b16 v[16:17], v6 offset:49152
    ds_read_b64_tr_b16 v[18:19], v6 offset:50176
    ds_read_b64_tr_b16 v[20:21], v9 offset:49152
    ds_read_b64_tr_b16 v[22:23], v9 offset:50176
    s_waitcnt vmcnt(4)
    s_waitcnt lgkmcnt(4)
    v_mfma_f32_32x32x16_bf16 v[96:111], v[24:27], v[52:55], v[96:111]
    v_mfma_f32_32x32x16_bf16 v[112:127], v[28:31], v[52:55], v[112:127]
    ds_read_b64_tr_b16 v[24:25], v6 offset:51200
    ds_read_b64_tr_b16 v[26:27], v6 offset:52224
    ds_read_b64_tr_b16 v[28:29], v9 offset:51200
    ds_read_b64_tr_b16 v[30:31], v9 offset:52224
    s_waitcnt vmcnt(3)
    s_waitcnt lgkmcnt(4)
    v_mfma_f32_32x32x16_bf16 v[96:111], v[16:19], v[168:171], v[96:111]
    v_mfma_f32_32x32x16_bf16 v[112:127], v[20:23], v[168:171], v[112:127]
    ds_read_b64_tr_b16 v[16:17], v6 offset:53248
    ds_read_b64_tr_b16 v[18:19], v6 offset:54272
    ds_read_b64_tr_b16 v[20:21], v9 offset:53248
    ds_read_b64_tr_b16 v[22:23], v9 offset:54272
    s_waitcnt vmcnt(2)
    s_waitcnt lgkmcnt(4)
    v_mfma_f32_32x32x16_bf16 v[96:111], v[24:27], v[172:175], v[96:111]
    v_mfma_f32_32x32x16_bf16 v[112:127], v[28:31], v[172:175], v[112:127]
    ds_read_b64_tr_b16 v[24:25], v6 offset:55296
    ds_read_b64_tr_b16 v[26:27], v6 offset:56320
    ds_read_b64_tr_b16 v[28:29], v9 offset:55296
    ds_read_b64_tr_b16 v[30:31], v9 offset:56320
    s_waitcnt vmcnt(1)
    s_waitcnt lgkmcnt(4)
    v_mfma_f32_32x32x16_bf16 v[96:111], v[16:19], v[56:59], v[96:111]
    v_mfma_f32_32x32x16_bf16 v[112:127], v[20:23], v[56:59], v[112:127]
    s_waitcnt vmcnt(0)
    s_waitcnt lgkmcnt(0)
    v_mfma_f32_32x32x16_bf16 v[96:111], v[24:27], v[176:179], v[96:111]
    v_mfma_f32_32x32x16_bf16 v[112:127], v[28:31], v[176:179], v[112:127]
    s_lshl_b32 s70, s76, 15
    v_add_u32 v8, s70, v2
    v_permlane32_swap_b32 v12, v14
    v_permlane32_swap_b32 v13, v15
    v_lshlrev_b32 v64, 16, v12
    v_and_b32 v65, 0xffff0000, v12
    v_lshlrev_b32 v66, 16, v13
    v_and_b32 v67, 0xffff0000, v13
    v_lshlrev_b32 v68, 16, v14
    v_and_b32 v69, 0xffff0000, v14
    v_lshlrev_b32 v70, 16, v15
    v_and_b32 v71, 0xffff0000, v15
    ds_write_b128 v8, v[96:99] offset:4096
    ds_write_b128 v8, v[100:103] offset:5120
    ds_write_b128 v8, v[104:107] offset:12288
    ds_write_b128 v8, v[108:111] offset:13312
    ds_write_b128 v8, v[120:123] offset:28672
    ds_write_b128 v8, v[124:127] offset:29696
    s_waitcnt lgkmcnt(0)
    s_barrier
    ds_read_b128 v[32:35], v8 offset:16384
    ds_read_b128 v[36:39], v8 offset:17408
    ds_read_b128 v[40:43], v8 offset:18432
    ds_read_b128 v[44:47], v8 offset:19456
    ds_read_b128 v[48:51], v8 offset:22528
    ds_read_b128 v[52:55], v8 offset:23552
    s_waitcnt lgkmcnt(0)
    v_pk_add_f32 v[72:73], v[32:33], v[40:41]
    v_pk_add_f32 v[74:75], v[34:35], v[42:43]
    v_pk_add_f32 v[76:77], v[36:37], v[44:45]
    v_pk_add_f32 v[78:79], v[38:39], v[46:47]
    v_pk_add_f32 v[72:73], v[72:73], v[112:113]
    v_pk_add_f32 v[74:75], v[74:75], v[114:115]
    v_pk_add_f32 v[76:77], v[76:77], v[116:117]
    v_pk_add_f32 v[78:79], v[78:79], v[118:119]
    v_pk_mul_f32 v[80:81], v[72:73], s[78:79]
    v_pk_mul_f32 v[82:83], v[74:75], s[78:79]
    v_pk_mul_f32 v[84:85], v[76:77], s[78:79]
    v_pk_mul_f32 v[86:87], v[78:79], s[78:79]
    v_exp_f32 v80, v80
    v_exp_f32 v81, v81
    v_exp_f32 v82, v82
    v_exp_f32 v83, v83
    v_exp_f32 v84, v84
    v_exp_f32 v85, v85
    v_exp_f32 v86, v86
    v_exp_f32 v87, v87
    v_pk_mul_f32 v[72:73], v[72:73], v[48:49]
    v_pk_mul_f32 v[74:75], v[74:75], v[50:51]
    v_pk_mul_f32 v[76:77], v[76:77], v[52:53]
    v_pk_mul_f32 v[78:79], v[78:79], v[54:55]
    v_pk_add_f32 v[80:81], v[80:81], s[80:81]
    v_pk_add_f32 v[82:83], v[82:83], s[80:81]
    v_pk_add_f32 v[84:85], v[84:85], s[80:81]
    v_pk_add_f32 v[86:87], v[86:87], s[80:81]
    v_rcp_f32 v80, v80
    v_rcp_f32 v81, v81
    v_rcp_f32 v82, v82
    v_rcp_f32 v83, v83
    v_rcp_f32 v84, v84
    v_rcp_f32 v85, v85
    v_rcp_f32 v86, v86
    v_rcp_f32 v87, v87
    v_pk_fma_f32 v[64:65], v[72:73], v[80:81], v[64:65]
    v_pk_fma_f32 v[66:67], v[74:75], v[82:83], v[66:67]
    v_pk_fma_f32 v[68:69], v[76:77], v[84:85], v[68:69]
    v_pk_fma_f32 v[70:71], v[78:79], v[86:87], v[70:71]
    v_cvt_pk_bf16_f32 v88, v64, v65
    v_cvt_pk_bf16_f32 v89, v66, v67
    v_cvt_pk_bf16_f32 v90, v68, v69
    v_cvt_pk_bf16_f32 v91, v70, v71
    s_nop 0
    v_permlane32_swap_b32 v88, v90
    v_permlane32_swap_b32 v89, v91
    buffer_store_dwordx4 v[88:91], v3, s[52:55], 0 offen offset:64
    s_branch L_FIN
L_P2_3:
    ds_read_b64_tr_b16 v[128:129], v5 offset:49152
    ds_read_b64_tr_b16 v[130:131], v5 offset:51200
    ds_read_b64_tr_b16 v[132:133], v8 offset:49152
    ds_read_b64_tr_b16 v[134:135], v8 offset:51200
    ds_read_b64_tr_b16 v[136:137], v5 offset:50176
    ds_read_b64_tr_b16 v[138:139], v5 offset:52224
    ds_read_b64_tr_b16 v[140:141], v8 offset:50176
    ds_read_b64_tr_b16 v[142:143], v8 offset:52224
    ds_read_b64_tr_b16 v[144:145], v5 offset:52736
    ds_read_b64_tr_b16 v[146:147], v5 offset:54784
    ds_read_b64_tr_b16 v[148:149], v8 offset:52736
    ds_read_b64_tr_b16 v[150:151], v8 offset:54784
    ds_read_b64_tr_b16 v[152:153], v5 offset:53760
    ds_read_b64_tr_b16 v[154:155], v5 offset:55808
    ds_read_b64_tr_b16 v[156:157], v8 offset:53760
    ds_read_b64_tr_b16 v[158:159], v8 offset:55808
    ds_read_b64_tr_b16 v[160:161], v5 offset:57344
    ds_read_b64_tr_b16 v[162:163], v5 offset:59392
    ds_read_b64_tr_b16 v[164:165], v8 offset:57344
    ds_read_b64_tr_b16 v[166:167], v8 offset:59392
    ds_read_b64_tr_b16 v[168:169], v5 offset:58368
    ds_read_b64_tr_b16 v[170:171], v5 offset:60416
    ds_read_b64_tr_b16 v[172:173], v8 offset:58368
    ds_read_b64_tr_b16 v[174:175], v8 offset:60416
    ds_read_b64_tr_b16 v[176:177], v5 offset:60928
    ds_read_b64_tr_b16 v[178:179], v5 offset:62976
    ds_read_b64_tr_b16 v[180:181], v8 offset:60928
    ds_read_b64_tr_b16 v[182:183], v8 offset:62976
    ds_read_b64_tr_b16 v[184:185], v5 offset:61952
    ds_read_b64_tr_b16 v[186:187], v5 offset:64000
    ds_read_b64_tr_b16 v[188:189], v8 offset:61952
    ds_read_b64_tr_b16 v[190:191], v8 offset:64000
    s_cmp_eq_u32 s63, 0
    s_cbranch_scc1 L_P2_3h
    s_add_u32 m0, s66, 110592
    s_add_u32 s74, s65, 1576960
    buffer_load_dwordx4 v31, s[44:47], s74 offen lds
    s_add_u32 m0, s66, 118784
    s_add_u32 s74, s65, 329728
    buffer_load_dwordx4 v31, s[48:51], s74 offen lds
    s_add_u32 m0, s66, 126976
    s_add_u32 s74, s65, 379904
    buffer_load_dwordx4 v31, s[48:51], s74 offen lds
    v_mov_b32 v16, 1
    v_mov_b32 v17, 0
    s_mov_b64 exec, 1
    s_waitcnt vmcnt(3)
    buffer_store_dword v16, v17, s[36:39], s72 offen sc1
    s_mov_b64 exec, -1
    s_branch L_P2_3c
L_P2_3h:
L_P2_3c:
    buffer_load_dwordx4 v[12:15], v3, s[28:31], 0 offen offset:96
    s_waitcnt lgkmcnt(0)
    s_barrier
    s_cmp_ge_u32 s65, 896
    s_cbranch_scc1 L_FIN
    s_add_u32 m0, s66, 4096
    s_add_u32 s74, s65, 86016
    buffer_load_dwordx4 v31, s[44:47], s74 offen lds
    s_add_u32 m0, s66, 12288
    s_add_u32 s74, s65, 143360
    buffer_load_dwordx4 v31, s[44:47], s74 offen lds
    s_add_u32 m0, s66, 20480
    s_add_u32 s74, s65, 659456
    buffer_load_dwordx4 v31, s[44:47], s74 offen lds
    s_add_u32 m0, s66, 28672
    s_add_u32 s74, s65, 716800
    buffer_load_dwordx4 v31, s[44:47], s74 offen lds
    s_add_u32 m0, s66, 36864
    s_add_u32 s74, s65, 1175552
    buffer_load_dwordx4 v31, s[44:47], s74 offen lds
    s_add_u32 m0, s66, 45056
    s_add_u32 s74, s65, 1232896
    buffer_load_dwordx4 v31, s[44:47], s74 offen lds
    s_add_u32 m0, s66, 53248
    s_add_u32 s74, s65, 78848
    buffer_load_dwordx4 v31, s[48:51], s74 offen lds
    s_add_u32 m0, s66, 61440
    s_add_u32 s74, s65, 129024
    buffer_load_dwordx4 v31, s[48:51], s74 offen lds
    s_waitcnt vmcnt(9)
    s_barrier
    ds_read_b64_tr_b16 v[192:193], v6 offset:49152
    ds_read_b64_tr_b16 v[194:195], v6 offset:51200
    ds_read_b64_tr_b16 v[196:197], v9 offset:49152
    ds_read_b64_tr_b16 v[198:199], v9 offset:51200
    ds_read_b64_tr_b16 v[200:201], v6 offset:50176
    ds_read_b64_tr_b16 v[202:203], v6 offset:52224
    ds_read_b64_tr_b16 v[204:205], v9 offset:50176
    ds_read_b64_tr_b16 v[206:207], v9 offset:52224
    ds_read_b64_tr_b16 v[208:209], v6 offset:52736
    ds_read_b64_tr_b16 v[210:211], v6 offset:54784
    ds_read_b64_tr_b16 v[212:213], v9 offset:52736
    ds_read_b64_tr_b16 v[214:215], v9 offset:54784
    ds_read_b64_tr_b16 v[216:217], v6 offset:53760
    ds_read_b64_tr_b16 v[218:219], v6 offset:55808
    ds_read_b64_tr_b16 v[220:221], v9 offset:53760
    ds_read_b64_tr_b16 v[222:223], v9 offset:55808
    ds_read_b64_tr_b16 v[224:225], v6 offset:57344
    ds_read_b64_tr_b16 v[226:227], v6 offset:59392
    ds_read_b64_tr_b16 v[228:229], v9 offset:57344
    ds_read_b64_tr_b16 v[230:231], v9 offset:59392
    ds_read_b64_tr_b16 v[232:233], v6 offset:58368
    ds_read_b64_tr_b16 v[234:235], v6 offset:60416
    ds_read_b64_tr_b16 v[236:237], v9 offset:58368
    ds_read_b64_tr_b16 v[238:239], v9 offset:60416
    ds_read_b64_tr_b16 v[240:241], v6 offset:60928
    ds_read_b64_tr_b16 v[242:243], v6 offset:62976
    ds_read_b64_tr_b16 v[244:245], v9 offset:60928
    ds_read_b64_tr_b16 v[246:247], v9 offset:62976
    ds_read_b64_tr_b16 v[248:249], v6 offset:61952
    ds_read_b64_tr_b16 v[250:251], v6 offset:64000
    ds_read_b64_tr_b16 v[252:253], v9 offset:61952
    ds_read_b64_tr_b16 v[254:255], v9 offset:64000
    s_waitcnt lgkmcnt(0)
    s_barrier
    s_waitcnt vmcnt(0)
    s_barrier
    s_barrier
    s_add_u32 s74, s77, 131072
    buffer_load_dwordx4 v[32:35], v2, s[36:39], s74 offen sc1
    s_add_u32 s74, s77, 132096
    buffer_load_dwordx4 v[36:39], v2, s[36:39], s74 offen sc1
    s_add_u32 s74, s77, 133120
    buffer_load_dwordx4 v[40:43], v2, s[36:39], s74 offen sc1
    s_add_u32 s74, s77, 134144
    buffer_load_dwordx4 v[44:47], v2, s[36:39], s74 offen sc1
    s_add_u32 s74, s77, 135168
    buffer_load_dwordx4 v[48:51], v2, s[36:39], s74 offen sc1
    s_add_u32 s74, s77, 136192
    buffer_load_dwordx4 v[52:55], v2, s[36:39], s74 offen sc1
    s_add_u32 s74, s77, 137216
    buffer_load_dwordx4 v[56:59], v2, s[36:39], s74 offen sc1
    s_add_u32 s74, s77, 138240
    buffer_load_dwordx4 v[60:63], v2, s[36:39], s74 offen sc1
    s_waitcnt vmcnt(7)
    v_mfma_f32_32x32x16_bf16 v[96:111], v[128:131], v[32:35], 0
    v_mfma_f32_32x32x16_bf16 v[112:127], v[132:135], v[32:35], 0
    s_add_u32 s74, s77, 139264
    buffer_load_dwordx4 v[64:67], v2, s[36:39], s74 offen sc1
    s_waitcnt vmcnt(7)
    v_mfma_f32_32x32x16_bf16 v[96:111], v[136:139], v[36:39], v[96:111]
    v_mfma_f32_32x32x16_bf16 v[112:127], v[140:143], v[36:39], v[112:127]
    s_add_u32 s74, s77, 140288
    buffer_load_dwordx4 v[68:71], v2, s[36:39], s74 offen sc1
    s_waitcnt vmcnt(7)
    v_mfma_f32_32x32x16_bf16 v[96:111], v[144:147], v[40:43], v[96:111]
    v_mfma_f32_32x32x16_bf16 v[112:127], v[148:151], v[40:43], v[112:127]
    s_add_u32 s74, s77, 141312
    buffer_load_dwordx4 v[72:75], v2, s[36:39], s74 offen sc1
    s_waitcnt vmcnt(7)
    v_mfma_f32_32x32x16_bf16 v[96:111], v[152:155], v[44:47], v[96:111]
    v_mfma_f32_32x32x16_bf16 v[112:127], v[156:159], v[44:47], v[112:127]
    s_add_u32 s74, s77, 142336
    buffer_load_dwordx4 v[76:79], v2, s[36:39], s74 offen sc1
    s_waitcnt vmcnt(7)
    v_mfma_f32_32x32x16_bf16 v[96:111], v[160:163], v[48:51], v[96:111]
    v_mfma_f32_32x32x16_bf16 v[112:127], v[164:167], v[48:51], v[112:127]
    s_add_u32 s74, s77, 143360
    buffer_load_dwordx4 v[80:83], v2, s[36:39], s74 offen sc1
    s_waitcnt vmcnt(7)
    v_mfma_f32_32x32x16_bf16 v[96:111], v[168:171], v[52:55], v[96:111]
    v_mfma_f32_32x32x16_bf16 v[112:127], v[172:175], v[52:55], v[112:127]
    s_add_u32 s74, s77, 144384
    buffer_load_dwordx4 v[84:87], v2, s[36:39], s74 offen sc1
    s_waitcnt vmcnt(7)
    v_mfma_f32_32x32x16_bf16 v[96:111], v[176:179], v[56:59], v[96:111]
    v_mfma_f32_32x32x16_bf16 v[112:127], v[180:183], v[56:59], v[112:127]
    s_add_u32 s74, s77, 145408
    buffer_load_dwordx4 v[88:91], v2, s[36:39], s74 offen sc1
    s_waitcnt vmcnt(7)
    v_mfma_f32_32x32x16_bf16 v[96:111], v[184:187], v[60:63], v[96:111]
    v_mfma_f32_32x32x16_bf16 v[112:127], v[188:191], v[60:63], v[112:127]
    s_add_u32 s74, s77, 146432
    buffer_load_dwordx4 v[92:95], v2, s[36:39], s74 offen sc1
    s_waitcnt vmcnt(7)
    v_mfma_f32_32x32x16_bf16 v[96:111], v[192:195], v[64:67], v[96:111]
    v_mfma_f32_32x32x16_bf16 v[112:127], v[196:199], v[64:67], v[112:127]
    s_add_u32 s74, s77, 114688
    buffer_load_dwordx4 v[32:35], v2, s[36:39], s74 offen sc1
    s_waitcnt vmcnt(7)
    v_mfma_f32_32x32x16_bf16 v[96:111], v[200:203], v[68:71], v[96:111]
    v_mfma_f32_32x32x16_bf16 v[112:127], v[204:207], v[68:71], v[112:127]
    s_add_u32 s74, s77, 115712
    buffer_load_dwordx4 v[128:131], v2, s[36:39], s74 offen sc1
    s_waitcnt vmcnt(7)
    v_mfma_f32_32x32x16_bf16 v[96:111], v[208:211], v[72:75], v[96:111]
    v_mfma_f32_32x32x16_bf16 v[112:127], v[212:215], v[72:75], v[112:127]
    s_add_u32 s74, s77, 116736
    buffer_load_dwordx4 v[132:135], v2, s[36:39], s74 offen sc1
    s_waitcnt vmcnt(7)
    v_mfma_f32_32x32x16_bf16 v[96:111], v[216:219], v[76:79], v[96:111]
    v_mfma_f32_32x32x16_bf16 v[112:127], v[220:223], v[76:79], v[112:127]
    s_add_u32 s74, s77, 117760
    buffer_load_dwordx4 v[36:39], v2, s[36:39], s74 offen sc1
    s_waitcnt vmcnt(7)
    v_mfma_f32_32x32x16_bf16 v[96:111], v[224:227], v[80:83], v[96:111]
    v_mfma_f32_32x32x16_bf16 v[112:127], v[228:231], v[80:83], v[112:127]
    s_add_u32 s74, s77, 118784
    buffer_load_dwordx4 v[136:139], v2, s[36:39], s74 offen sc1
    s_waitcnt vmcnt(7)
    v_mfma_f32_32x32x16_bf16 v[96:111], v[232:235], v[84:87], v[96:111]
    v_mfma_f32_32x32x16_bf16 v[112:127], v[236:239], v[84:87], v[112:127]
    s_add_u32 s74, s77, 119808
    buffer_load_dwordx4 v[140:143], v2, s[36:39], s74 offen sc1
    s_waitcnt vmcnt(7)
    v_mfma_f32_32x32x16_bf16 v[96:111], v[240:243], v[88:91], v[96:111]
    v_mfma_f32_32x32x16_bf16 v[112:127], v[244:247], v[88:91], v[112:127]
    ds_read_b64_tr_b16 v[16:17], v7 offset:24576
    ds_read_b64_tr_b16 v[18:19], v7 offset:26624
    ds_read_b64_tr_b16 v[20:21], v10 offset:24576
    ds_read_b64_tr_b16 v[22:23], v10 offset:26624
    s_add_u32 s74, s77, 120832
    buffer_load_dwordx4 v[40:43], v2, s[36:39], s74 offen sc1
    s_waitcnt vmcnt(7)
    v_mfma_f32_32x32x16_bf16 v[96:111], v[248:251], v[92:95], v[96:111]
    v_mfma_f32_32x32x16_bf16 v[112:127], v[252:255], v[92:95], v[112:127]
    ds_read_b64_tr_b16 v[24:25], v7 offset:25600
    ds_read_b64_tr_b16 v[26:27], v7 offset:27648
    ds_read_b64_tr_b16 v[28:29], v10 offset:25600
    ds_read_b64_tr_b16 v[30:31], v10 offset:27648
    s_add_u32 s74, s77, 121856
    buffer_load_dwordx4 v[144:147], v2, s[36:39], s74 offen sc1
    s_waitcnt vmcnt(7)
    s_waitcnt lgkmcnt(4)
    v_mfma_f32_32x32x16_bf16 v[96:111], v[16:19], v[32:35], v[96:111]
    v_mfma_f32_32x32x16_bf16 v[112:127], v[20:23], v[32:35], v[112:127]
    ds_read_b64_tr_b16 v[16:17], v7 offset:28160
    ds_read_b64_tr_b16 v[18:19], v7 offset:30208
    ds_read_b64_tr_b16 v[20:21], v10 offset:28160
    ds_read_b64_tr_b16 v[22:23], v10 offset:30208
    s_add_u32 s74, s77, 122880
    buffer_load_dwordx4 v[148:151], v2, s[36:39], s74 offen sc1
    s_waitcnt vmcnt(7)
    s_waitcnt lgkmcnt(4)
    v_mfma_f32_32x32x16_bf16 v[96:111], v[24:27], v[128:131], v[96:111]
    v_mfma_f32_32x32x16_bf16 v[112:127], v[28:31], v[128:131], v[112:127]
    ds_read_b64_tr_b16 v[24:25], v7 offset:29184
    ds_read_b64_tr_b16 v[26:27], v7 offset:31232
    ds_read_b64_tr_b16 v[28:29], v10 offset:29184
    ds_read_b64_tr_b16 v[30:31], v10 offset:31232
    s_add_u32 s74, s77, 123904
    buffer_load_dwordx4 v[44:47], v2, s[36:39], s74 offen sc1
    s_waitcnt vmcnt(7)
    s_waitcnt lgkmcnt(4)
    v_mfma_f32_32x32x16_bf16 v[96:111], v[16:19], v[132:135], v[96:111]
    v_mfma_f32_32x32x16_bf16 v[112:127], v[20:23], v[132:135], v[112:127]
    ds_read_b64_tr_b16 v[16:17], v5 offset:49152
    ds_read_b64_tr_b16 v[18:19], v5 offset:51200
    ds_read_b64_tr_b16 v[20:21], v8 offset:49152
    ds_read_b64_tr_b16 v[22:23], v8 offset:51200
    s_add_u32 s74, s77, 124928
    buffer_load_dwordx4 v[152:155], v2, s[36:39], s74 offen sc1
    s_waitcnt vmcnt(7)
    s_waitcnt lgkmcnt(4)
    v_mfma_f32_32x32x16_bf16 v[96:111], v[24:27], v[36:39], v[96:111]
    v_mfma_f32_32x32x16_bf16 v[112:127], v[28:31], v[36:39], v[112:127]
    ds_read_b64_tr_b16 v[24:25], v5 offset:50176
    ds_read_b64_tr_b16 v[26:27], v5 offset:52224
    ds_read_b64_tr_b16 v[28:29], v8 offset:50176
    ds_read_b64_tr_b16 v[30:31], v8 offset:52224
    s_add_u32 s74, s77, 125952
    buffer_load_dwordx4 v[156:159], v2, s[36:39], s74 offen sc1
    s_waitcnt vmcnt(7)
    s_waitcnt lgkmcnt(4)
    v_mfma_f32_32x32x16_bf16 v[96:111], v[16:19], v[136:139], v[96:111]
    v_mfma_f32_32x32x16_bf16 v[112:127], v[20:23], v[136:139], v[112:127]
    ds_read_b64_tr_b16 v[16:17], v5 offset:52736
    ds_read_b64_tr_b16 v[18:19], v5 offset:54784
    ds_read_b64_tr_b16 v[20:21], v8 offset:52736
    ds_read_b64_tr_b16 v[22:23], v8 offset:54784
    s_add_u32 s74, s77, 126976
    buffer_load_dwordx4 v[48:51], v2, s[36:39], s74 offen sc1
    s_waitcnt vmcnt(7)
    s_waitcnt lgkmcnt(4)
    v_mfma_f32_32x32x16_bf16 v[96:111], v[24:27], v[140:143], v[96:111]
    v_mfma_f32_32x32x16_bf16 v[112:127], v[28:31], v[140:143], v[112:127]
    ds_read_b64_tr_b16 v[24:25], v5 offset:53760
    ds_read_b64_tr_b16 v[26:27], v5 offset:55808
    ds_read_b64_tr_b16 v[28:29], v8 offset:53760
    ds_read_b64_tr_b16 v[30:31], v8 offset:55808
    s_add_u32 s74, s77, 128000
    buffer_load_dwordx4 v[160:163], v2, s[36:39], s74 offen sc1
    s_waitcnt vmcnt(7)
    s_waitcnt lgkmcnt(4)
    v_mfma_f32_32x32x16_bf16 v[96:111], v[16:19], v[40:43], v[96:111]
    v_mfma_f32_32x32x16_bf16 v[112:127], v[20:23], v[40:43], v[112:127]
    ds_read_b64_tr_b16 v[16:17], v5 offset:57344
    ds_read_b64_tr_b16 v[18:19], v5 offset:59392
    ds_read_b64_tr_b16 v[20:21], v8 offset:57344
    ds_read_b64_tr_b16 v[22:23], v8 offset:59392
    s_add_u32 s74, s77, 129024
    buffer_load_dwordx4 v[164:167], v2, s[36:39], s74 offen sc1
    s_waitcnt vmcnt(7)
    s_waitcnt lgkmcnt(4)
    v_mfma_f32_32x32x16_bf16 v[96:111], v[24:27], v[144:147], v[96:111]
    v_mfma_f32_32x32x16_bf16 v[112:127], v[28:31], v[144:147], v[112:127]
    ds_read_b64_tr_b16 v[24:25], v5 offset:58368
    ds_read_b64_tr_b16 v[26:27], v5 offset:60416
    ds_read_b64_tr_b16 v[28:29], v8 offset:58368
    ds_read_b64_tr_b16 v[30:31], v8 offset:60416
    s_add_u32 s74, s77, 130048
    buffer_load_dwordx4 v[52:55], v2, s[36:39], s74 offen sc1
    s_waitcnt vmcnt(7)
    s_waitcnt lgkmcnt(4)
    v_mfma_f32_32x32x16_bf16 v[96:111], v[16:19], v[148:151], v[96:111]
    v_mfma_f32_32x32x16_bf16 v[112:127], v[20:23], v[148:151], v[112:127]
    ds_read_b64_tr_b16 v[16:17], v5 offset:60928
    ds_read_b64_tr_b16 v[18:19], v5 offset:62976
    ds_read_b64_tr_b16 v[20:21], v8 offset:60928
    ds_read_b64_tr_b16 v[22:23], v8 offset:62976
    s_waitcnt vmcnt(6)
    s_waitcnt lgkmcnt(4)
    v_mfma_f32_32x32x16_bf16 v[96:111], v[24:27], v[44:47], v[96:111]
    v_mfma_f32_32x32x16_bf16 v[112:127], v[28:31], v[44:47], v[112:127]
    ds_read_b64_tr_b16 v[24:25], v5 offset:61952
    ds_read_b64_tr_b16 v[26:27], v5 offset:64000
    ds_read_b64_tr_b16 v[28:29], v8 offset:61952
    ds_read_b64_tr_b16 v[30:31], v8 offset:64000
    s_waitcnt vmcnt(5)
    s_waitcnt lgkmcnt(4)
    v_mfma_f32_32x32x16_bf16 v[96:111], v[16:19], v[152:155], v[96:111]
    v_mfma_f32_32x32x16_bf16 v[112:127], v[20:23], v[152:155], v[112:127]
    ds_read_b64_tr_b16 v[16:17], v6 offset:24576
    ds_read_b64_tr_b16 v[18:19], v6 offset:26624
    ds_read_b64_tr_b16 v[20:21], v9 offset:24576
    ds_read_b64_tr_b16 v[22:23], v9 offset:26624
    s_waitcnt vmcnt(4)
    s_waitcnt lgkmcnt(4)
    v_mfma_f32_32x32x16_bf16 v[96:111], v[24:27], v[156:159], v[96:111]
    v_mfma_f32_32x32x16_bf16 v[112:127], v[28:31], v[156:159], v[112:127]
    ds_read_b64_tr_b16 v[24:25], v6 offset:25600
    ds_read_b64_tr_b16 v[26:27], v6 offset:27648
    ds_read_b64_tr_b16 v[28:29], v9 offset:25600
    ds_read_b64_tr_b16 v[30:31], v9 offset:27648
    s_waitcnt vmcnt(3)
    s_waitcnt lgkmcnt(4)
    v_mfma_f32_32x32x16_bf16 v[96:111], v[16:19], v[48:51], v[96:111]
    v_mfma_f32_32x32x16_bf16 v[112:127], v[20:23], v[48:51], v[112:127]
    ds_read_b64_tr_b16 v[16:17], v6 offset:28160
    ds_read_b64_tr_b16 v[18:19], v6 offset:30208
    ds_read_b64_tr_b16 v[20:21], v9 offset:28160
    ds_read_b64_tr_b16 v[22:23], v9 offset:30208
    s_barrier
    s_waitcnt vmcnt(2)
    s_waitcnt lgkmcnt(4)
    v_mfma_f32_32x32x16_bf16 v[96:111], v[24:27], v[160:163], v[96:111]
    v_mfma_f32_32x32x16_bf16 v[112:127], v[28:31], v[160:163], v[112:127]
    ds_read_b64_tr_b16 v[24:25], v6 offset:29184
    ds_read_b64_tr_b16 v[26:27], v6 offset:31232
    ds_read_b64_tr_b16 v[28:29], v9 offset:29184
    ds_read_b64_tr_b16 v[30:31], v9 offset:31232
    s_waitcnt vmcnt(1)
    s_waitcnt lgkmcnt(4)
    v_mfma_f32_32x32x16_bf16 v[96:111], v[16:19], v[164:167], v[96:111]
    v_mfma_f32_32x32x16_bf16 v[112:127], v[20:23], v[164:167], v[112:127]
    s_waitcnt vmcnt(0)
    s_waitcnt lgkmcnt(0)
    v_mfma_f32_32x32x16_bf16 v[96:111], v[24:27], v[52:55], v[96:111]
    v_mfma_f32_32x32x16_bf16 v[112:127], v[28:31], v[52:55], v[112:127]
    s_lshl_b32 s70, s76, 15
    v_add_u32 v8, s70, v2
    v_permlane32_swap_b32 v12, v14
    v_permlane32_swap_b32 v13, v15
    v_lshlrev_b32 v64, 16, v12
    v_and_b32 v65, 0xffff0000, v12
    v_lshlrev_b32 v66, 16, v13
    v_and_b32 v67, 0xffff0000, v13
    v_lshlrev_b32 v68, 16, v14
    v_and_b32 v69, 0xffff0000, v14
    v_lshlrev_b32 v70, 16, v15
    v_and_b32 v71, 0xffff0000, v15
    ds_write_b128 v8, v[96:99] offset:6144
    ds_write_b128 v8, v[100:103] offset:7168
    ds_write_b128 v8, v[104:107] offset:14336
    ds_write_b128 v8, v[108:111] offset:15360
    ds_write_b128 v8, v[112:115] offset:22528
    ds_write_b128 v8, v[116:119] offset:23552
    s_waitcnt lgkmcnt(0)
    s_barrier
    ds_read_b128 v[32:35], v8 offset:24576
    ds_read_b128 v[36:39], v8 offset:25600
    ds_read_b128 v[40:43], v8 offset:26624
    ds_read_b128 v[44:47], v8 offset:27648
    ds_read_b128 v[48:51], v8 offset:28672
    ds_read_b128 v[52:55], v8 offset:29696
    s_waitcnt lgkmcnt(0)
    v_pk_add_f32 v[72:73], v[32:33], v[40:41]
    v_pk_add_f32 v[74:75], v[34:35], v[42:43]
    v_pk_add_f32 v[76:77], v[36:37], v[44:45]
    v_pk_add_f32 v[78:79], v[38:39], v[46:47]
    v_pk_add_f32 v[72:73], v[72:73], v[48:49]
    v_pk_add_f32 v[74:75], v[74:75], v[50:51]
    v_pk_add_f32 v[76:77], v[76:77], v[52:53]
    v_pk_add_f32 v[78:79], v[78:79], v[54:55]
    v_pk_mul_f32 v[80:81], v[72:73], s[78:79]
    v_pk_mul_f32 v[82:83], v[74:75], s[78:79]
    v_pk_mul_f32 v[84:85], v[76:77], s[78:79]
    v_pk_mul_f32 v[86:87], v[78:79], s[78:79]
    v_exp_f32 v80, v80
    v_exp_f32 v81, v81
    v_exp_f32 v82, v82
    v_exp_f32 v83, v83
    v_exp_f32 v84, v84
    v_exp_f32 v85, v85
    v_exp_f32 v86, v86
    v_exp_f32 v87, v87
    v_pk_mul_f32 v[72:73], v[72:73], v[120:121]
    v_pk_mul_f32 v[74:75], v[74:75], v[122:123]
    v_pk_mul_f32 v[76:77], v[76:77], v[124:125]
    v_pk_mul_f32 v[78:79], v[78:79], v[126:127]
    v_pk_add_f32 v[80:81], v[80:81], s[80:81]
    v_pk_add_f32 v[82:83], v[82:83], s[80:81]
    v_pk_add_f32 v[84:85], v[84:85], s[80:81]
    v_pk_add_f32 v[86:87], v[86:87], s[80:81]
    v_rcp_f32 v80, v80
    v_rcp_f32 v81, v81
    v_rcp_f32 v82, v82
    v_rcp_f32 v83, v83
    v_rcp_f32 v84, v84
    v_rcp_f32 v85, v85
    v_rcp_f32 v86, v86
    v_rcp_f32 v87, v87
    v_pk_fma_f32 v[64:65], v[72:73], v[80:81], v[64:65]
    v_pk_fma_f32 v[66:67], v[74:75], v[82:83], v[66:67]
    v_pk_fma_f32 v[68:69], v[76:77], v[84:85], v[68:69]
    v_pk_fma_f32 v[70:71], v[78:79], v[86:87], v[70:71]
    v_cvt_pk_bf16_f32 v88, v64, v65
    v_cvt_pk_bf16_f32 v89, v66, v67
    v_cvt_pk_bf16_f32 v90, v68, v69
    v_cvt_pk_bf16_f32 v91, v70, v71
    s_nop 0
    v_permlane32_swap_b32 v88, v90
    v_permlane32_swap_b32 v89, v91
    buffer_store_dwordx4 v[88:91], v3, s[52:55], 0 offen offset:96
L_FIN:
L_END:
    s_endpgm
.section .rodata,"a"
.p2align 6
.amdhsa_kernel recurrent_scan__sliding_local_dilated__mixer_channel_mlp__prompt_kernel
  .amdhsa_next_free_vgpr 256
  .amdhsa_next_free_sgpr 102
  .amdhsa_accum_offset 256
  .amdhsa_group_segment_fixed_size 0
  .amdhsa_kernarg_size 88
  .amdhsa_user_sgpr_count 2
  .amdhsa_user_sgpr_kernarg_segment_ptr 1
  .amdhsa_system_sgpr_workgroup_id_x 1
.end_amdhsa_kernel
```
